```python
import torch

def _softmax(x, axis=-1):
    return torch.softmax(x, dim=axis)
def _gelu(x):
    return torch.nn.functional.gelu(x, approximate="tanh")
def _silu(x):
    return torch.nn.functional.silu(x)
def _sigmoid(x):
    return torch.sigmoid(x)
def _layernorm(x, axis=-1, eps=1e-5):
    m = x.mean(dim=axis, keepdim=True)
    v = x.var(dim=axis, keepdim=True, unbiased=False)
    return (x - m) / torch.sqrt(v + eps)
def _scatter_add(tgt, idx, src, axis=0):
    return tgt.clone().index_add_(axis, idx, src)
def _segment_sum(src, seg, n):
    out = torch.zeros((n,) + src.shape[1:], dtype=src.dtype)
    return out.index_add_(0, seg, src)
def _pad(x, pw):
    flat = tuple(v for pair in reversed(pw) for v in pair)
    return torch.nn.functional.pad(x, flat)

kernel_name = 'sequential_preLN__ssm_conv_s4d__glu_gated_swiglu__prompt'

def setup_inputs():

    _w = (lambda a: (lambda t: t.to(torch.bfloat16) if t.is_floating_point() else t)(torch.as_tensor(a)))
    def _A_setup():
        Bsz, L, D, N = 1, 2048, 512, 128
        return {
            "u": _w((lambda *s: torch.randn(*s, dtype=torch.bfloat16) * 0.05)(Bsz, L, D)),
            "log_A_real": _w((lambda *s: torch.randn(*s, dtype=torch.bfloat16) * 6.4)(D, N) * 0.5),
            "A_imag": _w((lambda *s: torch.randn(*s, dtype=torch.bfloat16) * 0.05)(D, N) * 3.14),
            "C_real": _w((lambda *s: torch.randn(*s, dtype=torch.bfloat16) * 0.05)(D, N) / N ** 0.5),
            "C_imag": _w((lambda *s: torch.randn(*s, dtype=torch.bfloat16) * 0.05)(D, N) / N ** 0.5),
            "log_dt": _w((lambda *s: torch.randn(*s, dtype=torch.bfloat16) * 0.05)(D) * 0.5 - 4.0),
            "D_skip": _w((lambda *s: torch.randn(*s, dtype=torch.bfloat16) * 0.05)(D)),
        }
    _A_in = _A_setup()

    def _B_setup():
        B, S, D, F = 1, 2048, 512, 1792
        return {
            "x": _w((lambda *s: torch.randn(*s, dtype=torch.bfloat16) * 0.05)(B, S, D)),
            "w1": _w((lambda *s: torch.randn(*s, dtype=torch.bfloat16) * 0.4)(D, F) * (2.0 / D) ** 0.5),
            "w3": _w((lambda *s: torch.randn(*s, dtype=torch.bfloat16) * 0.4)(D, F) * (2.0 / D) ** 0.5),
            "w2": _w((lambda *s: torch.randn(*s, dtype=torch.bfloat16) * 0.4)(F, D) * (2.0 / F) ** 0.5),
        }
    _B_in = _B_setup()

    return {
        "A_u": _A_in["u"],
        "A_log_A_real": _A_in["log_A_real"],
        "A_A_imag": _A_in["A_imag"],
        "A_C_real": _A_in["C_real"],
        "A_C_imag": _A_in["C_imag"],
        "A_log_dt": _A_in["log_dt"],
        "A_D_skip": _A_in["D_skip"],
        "B_x": _B_in["x"],
        "B_w1": _B_in["w1"],
        "B_w3": _B_in["w3"],
        "B_w2": _B_in["w2"],
    }

def reference(A_u, A_log_A_real, A_A_imag, A_C_real, A_C_imag, A_log_dt, A_D_skip, B_x, B_w1, B_w3, B_w2):
    def _A_ref(u, log_A_real, A_imag, C_real, C_imag, log_dt, D_skip):
        L = u.shape[1]
        dt = torch.exp(log_dt)
        A = -torch.exp(log_A_real) + 1j * A_imag
        C = (C_real + 1j * C_imag) * dt[:, None]
        pos = (lambda x, dt: x.to(dt))(torch.arange(L), log_dt.dtype)
        P = torch.exp((A * dt[:, None])[:, :, None] * pos[None, None, :])
        K = 2.0 * torch.einsum("dn,dnl->dl", C, P).real
        L2 = 2 * L
        u_t = (lambda x, *d: x.permute(*d))(u, 0, 2, 1)
        Kf = (lambda x, *a, **k: torch.fft.rfft(x.float(), *a, **k))(K, L2)
        Uf = (lambda x, *a, **k: torch.fft.rfft(x.float(), *a, **k))(u_t, L2)
        y = (lambda x, *a, **k: torch.fft.irfft(x, *a, **k).to(torch.bfloat16))(Uf * Kf[None, :, :], L2)[:, :, :L]
        y = (lambda x, *d: x.permute(*d))(y, 0, 2, 1)
        return y + u * D_skip[None, None, :]

    def _B_ref(x, w1, w3, w2):
        gate = torch.einsum("bsd,df->bsf", x, w1)
        up = torch.einsum("bsd,df->bsf", x, w3)
        h = _silu(gate) * up
        out = torch.einsum("bsf,fd->bsd", h, w2)
        return out

    x = A_u
    h = x + _A_ref(_layernorm(x, axis=-1), A_log_A_real, A_A_imag, A_C_real, A_C_imag, A_log_dt, A_D_skip)
    h2 = h + _B_ref(_layernorm(h, axis=-1), B_w1, B_w3, B_w2)
    return h2
```

```asm
; @launch grid=(256,1,1) block=(512,1,1) lds=163328
.amdgcn_target "amdgcn-amd-amdhsa--gfx950"
.text
.globl sequential_preLN__ssm_conv_s4d__glu_gated_swiglu__prompt_kernel
.p2align 8
.type sequential_preLN__ssm_conv_s4d__glu_gated_swiglu__prompt_kernel,@function
sequential_preLN__ssm_conv_s4d__glu_gated_swiglu__prompt_kernel:
    s_cmp_ge_u32 s2, 256
    s_cbranch_scc1 M_done
    s_load_dwordx16 s[36:51], s[0:1], 0
    s_load_dwordx4 s[60:63], s[0:1], 96
    s_load_dwordx8 s[4:11], s[0:1], 64
    s_getpc_b64 s[14:15]
M_pc:
    v_subrev_u32 v4, 192, v0
    s_lshr_b32 s16, s2, 3
    v_cmp_gt_u32 vcc, 11, v4
    v_lshl_add_u32 v4, v4, 5, s16
    v_lshlrev_b32 v4, 7, v4
    v_min_u32 v4, M_done-M_pc, v4
    v_mov_b32 v5, 0
    v_lshl_add_u64 v[4:5], v[4:5], 0, s[14:15]
    s_and_saveexec_b64 s[16:17], vcc
    s_cbranch_execz M_nocpf
    global_load_dword v255, v[4:5], off
M_nocpf:
    s_mov_b64 exec, -1
    v_lshrrev_b32 v1, 6, v0
    v_and_b32 v2, 63, v0
    v_readfirstlane_b32 s3, v1
    v_and_b32 v45, 31, v0
    v_mov_b32 v44, 0
    v_lshlrev_b32 v45, 2, v45
    v_add_u32 v45, 163200, v45
    ds_write_b32 v45, v44
    s_mov_b32 s68, 0
    s_and_b32 s12, s3, 3
    s_cmp_lt_u32 s3, 4
    s_cbranch_scc0 M_L
    s_and_b32 s16, s2, 7
    s_lshl_b32 s16, s16, 5
    s_lshr_b32 s17, s2, 3
    s_add_u32 s19, s16, s17
    s_lshl_b32 s16, s19, 9
    v_lshl_add_u32 v3, v0, 1, s16
    s_lshr_b32 s52, s3, 1
    s_lshl_b32 s17, s19, 1
    s_add_u32 s17, s17, s52
    s_lshl_b32 s18, s17, 1
    v_mov_b32 v9, s18
    s_mul_i32 s13, s2, 2341
    s_lshr_b32 s13, s13, 16
    s_mul_i32 s14, s13, 28
    s_sub_u32 s14, s2, s14
    v_lshrrev_b32 v25, 2, v2
    v_and_b32 v26, 3, v2
    v_mul_u32_u24 v25, 3584, v25
    v_lshl_add_u32 v25, v26, 4, v25
    s_cmp_ge_u32 s14, 14
    s_cselect_b32 s15, 14, 0
    s_sub_u32 s15, s14, s15
    s_lshl_b32 s15, s15, 8
    s_lshl_b32 s55, s3, 6
    s_add_u32 s55, s55, s15
    s_mul_i32 s54, s13, 229376
    s_add_u32 s55, s55, s54
    s_mov_b32 s58, 1835008
    s_mov_b32 s59, 0x20000
    s_lshl_b32 s53, s2, 3
    s_add_u32 s53, s53, s3
    s_cmp_lg_u32 s53, 1856
    s_waitcnt lgkmcnt(0)
    s_cbranch_scc0 M_z
    s_barrier
    global_load_ushort v10, v9, s[46:47]
    global_load_ushort v11, v3, s[38:39]
    global_load_ushort v12, v3, s[40:41]
    global_load_ushort v13, v3, s[42:43]
    global_load_ushort v14, v3, s[44:45]
    global_load_ushort v208, v9, s[48:49]
M_zr:
    s_cmp_ge_u32 s14, 14
    s_cselect_b32 s56, s6, s4
    s_cselect_b32 s57, s7, s5
    buffer_load_dwordx4 v[232:235], v25, s[56:59], s55 offen
    s_add_u32 s55, s55, 57344
    buffer_load_dwordx4 v[236:239], v25, s[56:59], s55 offen
    s_add_u32 s55, s55, 57344
    buffer_load_dwordx4 v[240:243], v25, s[56:59], s55 offen
    s_add_u32 s55, s55, 57344
    buffer_load_dwordx4 v[244:247], v25, s[56:59], s55 offen
    s_add_u32 s55, s55, 57344
    s_branch M_C
M_z:
    v_mov_b32 v45, 0
    v_mov_b32 v46, 0
    v_mov_b32 v47, 0
    v_lshlrev_b32 v85, 4, v2
    s_add_u32 s20, s62, 8556544
    s_addc_u32 s21, s63, 0
    s_mov_b32 s22, 4096
    s_mov_b32 s23, 0x20000
    buffer_store_dwordx4 v[44:47], v85, s[20:23], 0 offen offset:0 sc1
    buffer_store_dwordx4 v[44:47], v85, s[20:23], 0 offen offset:1024 sc1
    buffer_store_dwordx4 v[44:47], v85, s[20:23], 0 offen offset:2048 sc1
    buffer_store_dwordx4 v[44:47], v85, s[20:23], 0 offen offset:3072 sc1
    s_barrier
    global_load_ushort v10, v9, s[46:47]
    global_load_ushort v11, v3, s[38:39]
    global_load_ushort v12, v3, s[40:41]
    global_load_ushort v13, v3, s[42:43]
    global_load_ushort v14, v3, s[44:45]
    global_load_ushort v208, v9, s[48:49]
    v_mov_b32 v5, 1
    s_waitcnt vmcnt(6)
    s_mov_b64 exec, 1
    global_store_dword v44, v5, s[60:61] sc1
    s_mov_b64 exec, -1
    s_waitcnt vmcnt(1)
    s_branch M_C
M_L:
    v_and_b32 v1, 255, v0
    s_and_b32 s17, s2, 7
    s_lshl_b32 s17, s17, 5
    s_lshr_b32 s21, s2, 3
    s_add_u32 s21, s21, s17
    s_lshl_b32 s17, s21, 13
    v_lshrrev_b32 v5, 5, v1
    v_and_b32 v4, 31, v1
    v_lshlrev_b32 v6, 10, v5
    v_lshl_add_u32 v6, v4, 4, v6
    v_add_u32 v6, s17, v6
    s_lshl_b32 s18, s12, 8
    s_add_u32 s18, s18, s17
    v_lshrrev_b32 v8, 4, v2
    v_and_b32 v9, 15, v2
    v_lshlrev_b32 v3, 10, v8
    v_lshl_add_u32 v3, v9, 4, v3
    v_add_u32 v9, 3072, v3
    s_lshl_b32 s19, s12, 11
    s_add_u32 s19, s19, 99840
    s_mov_b32 m0, s19
    v_mov_b32 v7, 163200
    v_mov_b32 v45, 0
    v_mov_b32 v46, 0
    v_mov_b32 v47, 0
    v_lshlrev_b32 v85, 4, v2
    s_setprio 2
    s_waitcnt lgkmcnt(0)
    s_mov_b32 s38, 0x200000
    s_mov_b32 s39, 0x20000
    buffer_load_dwordx4 v3, s[36:39], s18 offen lds
    buffer_load_dwordx4 v9, s[36:39], s18 offen offset:1024 lds
    global_load_dwordx4 v[16:19], v6, s[36:37]
    global_load_dwordx4 v[20:23], v6, s[36:37] offset:512
    s_barrier
    v_bfe_u32 v9, v2, 2, 2
    v_and_b32 v3, 3, v2
    v_lshlrev_b32 v9, 8, v9
    v_lshl_add_u32 v9, v8, 5, v9
    v_lshl_add_u32 v9, v3, 3, v9
    v_add_u32 v9, s19, v9
    s_mov_b32 s64, s62
    s_mov_b32 s65, s63
    s_mov_b32 s62, 256
    s_mov_b32 s63, 0x20000
    s_add_u32 s40, s64, 8388608
    s_addc_u32 s41, s65, 0
    s_mov_b32 s42, 1048576
    s_mov_b32 s43, 0x20000
    s_mov_b32 s24, s64
    s_mov_b32 s25, s65
    s_mov_b32 s26, 8388608
    s_mov_b32 s27, 0x20000
    s_add_u32 s44, s64, 8519680
    s_addc_u32 s45, s65, 0
    s_mov_b32 s46, 36864
    s_mov_b32 s47, 0x20000
    v_lshlrev_b32 v10, 4, v1
    s_lshl_b32 s19, s2, 12
    v_lshlrev_b32 v5, 2, v5
    s_lshl_b32 s20, s21, 5
    s_add_u32 s20, s20, 172032
    buffer_store_dwordx4 v[44:47], v10, s[44:47], s19 offen sc1
    v_mov_b32 v12, -1
    v_mov_b32 v13, -1
    v_mov_b32 v14, -1
    v_mov_b32 v15, -1
    s_lshl_b32 s34, s12, 11
    s_add_u32 s19, s17, s34
    s_add_u32 s19, s19, 6291456
    buffer_store_dwordx4 v[12:15], v85, s[24:27], s19 offen sc1
    buffer_store_dwordx4 v[12:15], v85, s[24:27], s19 offen offset:1024 sc1
    s_mov_b32 s32, 0xffff0000
    s_mov_b32 s33, 0x3b000000
    s_lshl_b32 s36, s12, 11
    s_add_u32 s36, s36, s17
    s_waitcnt vmcnt(5)
    ds_read_b64_tr_b16 v[64:65], v9
    ds_read_b64_tr_b16 v[66:67], v9 offset:1024
    ds_read_b64_tr_b16 v[68:69], v9 offset:128
    ds_read_b64_tr_b16 v[70:71], v9 offset:1152
    s_waitcnt vmcnt(3)
    v_lshlrev_b32 v24, 16, v16
    v_and_b32 v25, s32, v16
    v_lshlrev_b32 v26, 16, v17
    v_and_b32 v27, s32, v17
    v_lshlrev_b32 v28, 16, v18
    v_and_b32 v29, s32, v18
    v_lshlrev_b32 v30, 16, v19
    v_and_b32 v31, s32, v19
    v_lshlrev_b32 v32, 16, v20
    v_and_b32 v33, s32, v20
    v_lshlrev_b32 v34, 16, v21
    v_and_b32 v35, s32, v21
    v_lshlrev_b32 v36, 16, v22
    v_and_b32 v37, s32, v22
    v_lshlrev_b32 v38, 16, v23
    v_and_b32 v39, s32, v23
    s_waitcnt lgkmcnt(0)
    buffer_store_dwordx4 v[64:67], v85, s[24:27], s36 offen sc1
    buffer_store_dwordx4 v[68:71], v85, s[24:27], s36 offen offset:1024 sc1
    v_add_f32 v40, v24, v28
    v_add_f32 v41, v25, v29
    v_add_f32 v42, v26, v30
    v_add_f32 v43, v27, v31
    v_add_f32 v48, v32, v36
    v_add_f32 v49, v33, v37
    v_add_f32 v50, v34, v38
    v_add_f32 v51, v35, v39
    v_add_f32 v40, v40, v48
    v_add_f32 v41, v41, v49
    v_add_f32 v42, v42, v50
    v_add_f32 v43, v43, v51
    v_add_f32 v40, v40, v41
    v_add_f32 v42, v42, v43
    v_add_f32 v40, v40, v42
    s_nop 1
    v_add_f32_dpp v40, v40, v40 quad_perm:[1,0,3,2] row_mask:0xf bank_mask:0xf
    s_nop 1
    v_add_f32_dpp v40, v40, v40 quad_perm:[2,3,0,1] row_mask:0xf bank_mask:0xf
    s_nop 1
    v_add_f32_dpp v40, v40, v40 row_half_mirror row_mask:0xf bank_mask:0xf
    s_nop 1
    v_add_f32_dpp v40, v40, v40 row_mirror row_mask:0xf bank_mask:0xf
    v_mov_b32 v41, v40
    s_nop 1
    v_permlane16_swap_b32 v40, v41
    v_add_f32 v40, v40, v41
    v_mul_f32 v40, s33, v40
    v_sub_f32 v24, v24, v40
    v_sub_f32 v25, v25, v40
    v_sub_f32 v26, v26, v40
    v_sub_f32 v27, v27, v40
    v_sub_f32 v28, v28, v40
    v_sub_f32 v29, v29, v40
    v_sub_f32 v30, v30, v40
    v_sub_f32 v31, v31, v40
    v_sub_f32 v32, v32, v40
    v_sub_f32 v33, v33, v40
    v_sub_f32 v34, v34, v40
    v_sub_f32 v35, v35, v40
    v_sub_f32 v36, v36, v40
    v_sub_f32 v37, v37, v40
    v_sub_f32 v38, v38, v40
    v_sub_f32 v39, v39, v40
    v_mul_f32 v48, v24, v24
    v_mul_f32 v49, v25, v25
    v_mul_f32 v50, v26, v26
    v_mul_f32 v51, v27, v27
    v_fmac_f32 v48, v28, v28
    v_fmac_f32 v49, v29, v29
    v_fmac_f32 v50, v30, v30
    v_fmac_f32 v51, v31, v31
    v_fmac_f32 v48, v32, v32
    v_fmac_f32 v49, v33, v33
    v_fmac_f32 v50, v34, v34
    v_fmac_f32 v51, v35, v35
    v_fmac_f32 v48, v36, v36
    v_fmac_f32 v49, v37, v37
    v_fmac_f32 v50, v38, v38
    v_fmac_f32 v51, v39, v39
    v_add_f32 v48, v48, v49
    v_add_f32 v50, v50, v51
    v_add_f32 v42, v48, v50
    s_nop 1
    v_add_f32_dpp v42, v42, v42 quad_perm:[1,0,3,2] row_mask:0xf bank_mask:0xf
    s_nop 1
    v_add_f32_dpp v42, v42, v42 quad_perm:[2,3,0,1] row_mask:0xf bank_mask:0xf
    s_nop 1
    v_add_f32_dpp v42, v42, v42 row_half_mirror row_mask:0xf bank_mask:0xf
    s_nop 1
    v_add_f32_dpp v42, v42, v42 row_mirror row_mask:0xf bank_mask:0xf
    v_mov_b32 v43, v42
    s_nop 1
    v_permlane16_swap_b32 v42, v43
    v_add_f32 v42, v42, v43
    v_mul_f32 v42, s33, v42
    v_cvt_pk_bf16_f32 v42, v42, v42
    v_lshlrev_b32 v42, 16, v42
    v_add_f32 v42, 0x3727c5ac, v42
    v_cvt_pk_bf16_f32 v42, v42, v42
    v_lshlrev_b32 v42, 16, v42
    v_sqrt_f32 v42, v42
    v_mov_b32 v43, 1
    v_cvt_pk_bf16_f32 v42, v40, v42
    s_mov_b32 exec_lo, 1
    s_mov_b32 exec_hi, 1
    buffer_store_dword v42, v5, s[40:43], s20 offen sc1
    s_mov_b64 exec, 0
    s_cmp_eq_u32 s12, 1
    s_cbranch_scc1 HOP_1
    s_cmp_eq_u32 s12, 2
    s_cbranch_scc1 HOP_2
    s_cmp_eq_u32 s12, 3
    s_cbranch_scc1 HOP_3
    s_branch HOP_0
HOP_end:
    s_mov_b64 exec, -1
    s_mov_b64 exec, 1
    s_waitcnt vmcnt(2)
    buffer_load_dword v48, v44, s[60:63], 0 offen sc1
    s_lshr_b32 s19, s21, 4
    s_lshl_b32 s19, s19, 8
    s_add_u32 s19, s19, 167936
    s_waitcnt vmcnt(0)
M_zp:
    v_cmp_ne_u32 vcc, 0, v48
    s_add_u32 s68, s68, 1
    s_cmp_gt_u32 s68, 0x100000
    s_cbranch_scc1 M_zok
    s_nop 2
    s_cbranch_vccnz M_zok
    s_sleep 8
    buffer_load_dword v48, v44, s[60:63], 0 offen sc1
    s_waitcnt vmcnt(0)
    s_branch M_zp
M_zok:
    ds_add_rtn_u32 v46, v7, v43 offset:64
    s_waitcnt lgkmcnt(0)
    v_cmp_ne_u32 vcc, 3, v46
    s_nop 4
    s_cbranch_vccnz M_nosig1
    v_mov_b32 v46, 1
    buffer_atomic_add v46, v44, s[40:43], s19 offen sc0 sc1
    s_waitcnt vmcnt(0)
    v_cmp_ne_u32 vcc, 15, v46
    v_mov_b32 v46, 1
    s_nop 3
    s_cbranch_vccnz M_nosig1
    buffer_store_dword v46, v44, s[40:43], s19 offen offset:128 sc1
M_nosig1:
    s_mov_b64 exec, -1
    s_setprio 0
    s_and_b32 s61, s2, 3
    s_bfe_u32 s62, s2, 0x10002
    s_lshr_b32 s66, s2, 3
    s_and_b32 s12, s3, 3
    s_lshl_b32 s16, s61, 2
    s_and_b32 s54, s66, 3
    s_add_u32 s16, s16, s54
    s_mul_i32 s17, s62, 7
    s_lshr_b32 s54, s66, 2
    s_add_u32 s17, s17, s54
    s_lshl_b32 s52, s12, 11
    s_lshl_b32 s48, s16, 8
    s_lshl_b32 s49, s17, 8
    s_add_u32 s20, s64, 6291456
    s_addc_u32 s21, s65, 0
    s_mov_b32 s22, 2097152
    s_mov_b32 s23, 0x20000
    s_mov_b32 s24, s4
    s_mov_b32 s25, s5
    s_mov_b32 s26, 1835008
    s_mov_b32 s27, 0x20000
    s_mov_b32 s28, s6
    s_mov_b32 s29, s7
    s_mov_b32 s30, 1835008
    s_mov_b32 s31, 0x20000
    v_lshrrev_b32 v30, 4, v2
    v_and_b32 v31, 15, v2
    v_and_b32 v29, 1, v30
    s_lshl_b32 s54, s12, 2
    v_lshl_add_u32 v29, v29, 1, s54
    v_xor_b32 v31, v31, v29
    v_lshlrev_b32 v31, 4, v31
    v_lshl_add_u32 v10, v30, 12, v31
    s_lshl_b32 s54, s12, 15
    v_add_u32 v10, s54, v10
    v_add_u32 v11, 15360, v10
    v_lshrrev_b32 v31, 3, v2
    s_lshl_b32 s54, s12, 3
    v_add_u32 v31, s54, v31
    v_mul_u32_u24 v31, 3584, v31
    v_and_b32 v30, 7, v2
    v_lshl_add_u32 v12, v30, 4, v31
    s_and_b32 s61, s2, 3
    s_bfe_u32 s62, s2, 0x10002
    s_lshl_b32 s18, s61, 3
    s_and_b32 s54, s66, 7
    s_add_u32 s18, s18, s54
    s_lshl_b32 s19, s62, 2
    s_lshr_b32 s54, s66, 3
    s_add_u32 s19, s19, s54
    s_lshl_b32 s50, s19, 7
    s_mov_b32 s68, 0
    s_add_u32 s36, s64, 9437184
    s_addc_u32 s37, s65, 0
    s_mov_b32 s38, 7340032
    s_mov_b32 s39, 0x20000
    s_add_u32 s40, s64, 8388608
    s_addc_u32 s41, s65, 0
    s_mov_b32 s42, 1048576
    s_mov_b32 s43, 0x20000
    s_mov_b32 s32, s8
    s_mov_b32 s33, s9
    s_mov_b32 s34, 1835008
    s_mov_b32 s35, 0x20000
    s_mul_i32 s53, s12, 2080
    v_lshrrev_b32 v30, 4, v2
    v_bfe_u32 v29, v2, 3, 1
    v_lshl_add_u32 v30, v30, 3, v29
    s_lshl_b32 s54, s12, 1
    v_add_u32 v30, s54, v30
    v_and_b32 v31, 7, v2
    v_lshlrev_b32 v31, 4, v31
    v_lshl_add_u32 v13, v30, 10, v31
    v_add_u32 v14, 31744, v13
    v_lshl_add_u32 v16, v30, 12, v31
    v_add_u32 v17, 130048, v16
    s_lshl_b32 s55, s19, 18
    s_lshl_b32 s54, s18, 7
    s_add_u32 s55, s55, s54
    v_mov_b32 v28, 0
    s_bfe_u32 s54, s2, 0x10002
    s_mul_i32 s58, s54, 917504
    s_sub_u32 s56, s50, s58
    s_add_u32 s50, s50, s58
    s_mul_i32 s58, s54, 57344
    s_mul_i32 s51, s18, 229376
    s_sub_u32 s57, s51, s58
    s_add_u32 s51, s51, s58
    s_lshr_b32 s54, s12, 1
    s_mul_i32 s54, s54, 114688
    s_and_b32 s58, s12, 1
    s_lshl_b32 s58, s58, 11
    s_add_u32 s54, s54, s58
    v_lshl_add_u32 v15, v2, 4, s54
    s_bfe_u32 s59, s2, 0x10002
    s_lshl_b32 s54, s18, 1
    s_add_u32 s59, s59, s54
    s_lshl_b32 s59, s59, 8
    s_add_u32 s59, s59, 147456
    s_xor_b32 s58, s59, 256
    v_lshl_add_u32 v18, v2, 4, s53
    v_add_u32 v19, 58240, v18
    v_add_u32 v20, 116480, v18
    s_lshl_b32 s13, s17, 8
    s_add_u32 s13, s13, 147584
    s_lshr_b32 s61, s12, 1
    s_mul_i32 s14, s61, 7168
    s_lshl_b32 s61, s17, 9
    s_add_u32 s14, s14, s61
    s_and_b32 s61, s12, 1
    s_lshl_b32 s61, s61, 8
    s_add_u32 s14, s14, s61
    v_lshlrev_b32 v40, 2, v2
    s_lshl_b32 s61, s12, 8
    s_add_u32 s61, s61, 158080
    v_add_u32 v41, s61, v40
    v_bfe_u32 v45, v2, 3, 2
    v_lshl_add_u32 v44, v2, 2, v45
    v_lshl_add_u32 v44, v44, 2, s52
    v_mov_b32 v32, -1
    v_mov_b32 v33, -1
    v_mov_b32 v34, -1
    v_mov_b32 v35, -1
    v_mov_b32 v52, -1
    v_mov_b32 v53, -1
    v_mov_b32 v54, -1
    v_mov_b32 v55, -1
    s_lshl_b32 s15, s16, 2
    s_add_u32 s15, s15, s12
    s_mul_i32 s15, s15, 112
    s_lshl_b32 s54, s17, 3
    s_add_u32 s15, s15, s54
    s_add_u32 s15, s15, 4
    s_lshl_b32 s15, s15, 10
    s_mul_i32 s69, s2, 4682
    s_lshr_b32 s69, s69, 16
    s_mul_i32 s69, s69, 14
    s_sub_u32 s69, s2, s69
    s_lshl_b32 s69, s69, 8
    s_add_u32 s69, s69, 147584
    v_mov_b32 v42, 1
    s_mov_b32 s44, s64
    s_mov_b32 s45, s65
    s_mov_b32 s46, 2097152
    s_mov_b32 s47, 0x20000
    s_and_b32 s54, s2, 7
    s_lshl_b32 s54, s54, 5
    s_add_u32 s54, s54, s66
    s_lshl_b32 s54, s54, 5
    s_lshl_b32 s60, s12, 19
    s_add_u32 s60, s60, s54
    s_add_u32 s61, s60, 0x40000
    s_add_u32 s62, s52, 172032
    s_mov_b32 s63, 0xffff0000
    v_lshrrev_b32 v130, 1, v2
    v_and_b32 v131, 1, v2
    v_lshlrev_b32 v132, 13, v130
    v_lshl_add_u32 v132, v131, 4, v132
    v_mul_u32_u24 v133, 4672, v131
    v_lshl_add_u32 v133, v130, 4, v133
    s_lshl_b32 s54, s12, 10
    s_add_u32 s54, s54, 141952
    v_add_u32 v133, s54, v133
    s_lshl_b32 s67, s12, 10
    s_add_u32 s67, s67, 167936
    v_lshlrev_b32 v128, 8, v2
    s_mov_b64 exec, 15
M_g1_p:
    buffer_load_dword v129, v128, s[40:43], s67 offen offset:128 sc1
    s_add_u32 s68, s68, 1
    s_waitcnt vmcnt(0)
    v_cmp_ne_u32 vcc, 1, v129
    s_cmp_gt_u32 s68, 0x100000
    s_cbranch_scc1 M_g1_d
    s_nop 3
    s_cbranch_vccnz M_g1_p
M_g1_d:
    s_mov_b64 exec, -1
    s_setprio 2
    buffer_load_dwordx4 v[144:147], v85, s[40:43], s62 offen sc1
    buffer_load_dwordx4 v[148:151], v85, s[40:43], s62 offen offset:1024 sc1
    buffer_load_dwordx4 v[136:139], v132, s[44:47], s60 offen sc1
    buffer_load_dwordx4 v[140:143], v132, s[44:47], s61 offen sc1
    s_waitcnt vmcnt(2)
    v_and_b32 v160, s63, v144
    v_lshlrev_b32 v152, 16, v144
    v_rcp_f32 v160, v160
    v_and_b32 v161, s63, v145
    v_lshlrev_b32 v153, 16, v145
    v_rcp_f32 v161, v161
    v_and_b32 v162, s63, v146
    v_lshlrev_b32 v154, 16, v146
    v_rcp_f32 v162, v162
    v_and_b32 v163, s63, v147
    v_lshlrev_b32 v155, 16, v147
    v_rcp_f32 v163, v163
    v_and_b32 v164, s63, v148
    v_lshlrev_b32 v156, 16, v148
    v_rcp_f32 v164, v164
    v_and_b32 v165, s63, v149
    v_lshlrev_b32 v157, 16, v149
    v_rcp_f32 v165, v165
    v_and_b32 v166, s63, v150
    v_lshlrev_b32 v158, 16, v150
    v_rcp_f32 v166, v166
    v_and_b32 v167, s63, v151
    v_lshlrev_b32 v159, 16, v151
    v_rcp_f32 v167, v167
    s_waitcnt vmcnt(1)
    v_lshlrev_b32 v168, 16, v136
    v_and_b32 v169, s63, v136
    v_lshlrev_b32 v170, 16, v137
    v_and_b32 v171, s63, v137
    v_lshlrev_b32 v172, 16, v138
    v_and_b32 v173, s63, v138
    v_lshlrev_b32 v174, 16, v139
    v_and_b32 v175, s63, v139
    ds_write_b128 v133, v[136:139] offset:9344
    v_subrev_f32_dpp v168, v152, v168 quad_perm:[0,0,2,2] row_mask:0xf bank_mask:0xf
    v_subrev_f32_dpp v169, v153, v169 quad_perm:[0,0,2,2] row_mask:0xf bank_mask:0xf
    v_subrev_f32_dpp v170, v154, v170 quad_perm:[0,0,2,2] row_mask:0xf bank_mask:0xf
    v_subrev_f32_dpp v171, v155, v171 quad_perm:[0,0,2,2] row_mask:0xf bank_mask:0xf
    v_subrev_f32_dpp v172, v152, v172 quad_perm:[1,1,3,3] row_mask:0xf bank_mask:0xf
    v_subrev_f32_dpp v173, v153, v173 quad_perm:[1,1,3,3] row_mask:0xf bank_mask:0xf
    v_subrev_f32_dpp v174, v154, v174 quad_perm:[1,1,3,3] row_mask:0xf bank_mask:0xf
    v_subrev_f32_dpp v175, v155, v175 quad_perm:[1,1,3,3] row_mask:0xf bank_mask:0xf
    v_cvt_pk_bf16_f32 v176, v168, v169
    v_cvt_pk_bf16_f32 v177, v170, v171
    v_cvt_pk_bf16_f32 v178, v172, v173
    v_cvt_pk_bf16_f32 v179, v174, v175
    v_lshlrev_b32 v168, 16, v176
    v_and_b32 v169, s63, v176
    v_lshlrev_b32 v170, 16, v177
    v_and_b32 v171, s63, v177
    v_lshlrev_b32 v172, 16, v178
    v_and_b32 v173, s63, v178
    v_lshlrev_b32 v174, 16, v179
    v_and_b32 v175, s63, v179
    v_mul_f32_dpp v168, v160, v168 quad_perm:[0,0,2,2] row_mask:0xf bank_mask:0xf
    v_mul_f32_dpp v169, v161, v169 quad_perm:[0,0,2,2] row_mask:0xf bank_mask:0xf
    v_mul_f32_dpp v170, v162, v170 quad_perm:[0,0,2,2] row_mask:0xf bank_mask:0xf
    v_mul_f32_dpp v171, v163, v171 quad_perm:[0,0,2,2] row_mask:0xf bank_mask:0xf
    v_mul_f32_dpp v172, v160, v172 quad_perm:[1,1,3,3] row_mask:0xf bank_mask:0xf
    v_mul_f32_dpp v173, v161, v173 quad_perm:[1,1,3,3] row_mask:0xf bank_mask:0xf
    v_mul_f32_dpp v174, v162, v174 quad_perm:[1,1,3,3] row_mask:0xf bank_mask:0xf
    v_mul_f32_dpp v175, v163, v175 quad_perm:[1,1,3,3] row_mask:0xf bank_mask:0xf
    v_cvt_pk_bf16_f32 v180, v168, v169
    v_cvt_pk_bf16_f32 v181, v170, v171
    v_cvt_pk_bf16_f32 v182, v172, v173
    v_cvt_pk_bf16_f32 v183, v174, v175
    ds_write_b128 v133, v[180:183] offset:0
    s_waitcnt vmcnt(0)
    v_lshlrev_b32 v168, 16, v140
    v_and_b32 v169, s63, v140
    v_lshlrev_b32 v170, 16, v141
    v_and_b32 v171, s63, v141
    v_lshlrev_b32 v172, 16, v142
    v_and_b32 v173, s63, v142
    v_lshlrev_b32 v174, 16, v143
    v_and_b32 v175, s63, v143
    ds_write_b128 v133, v[140:143] offset:9856
    v_subrev_f32_dpp v168, v156, v168 quad_perm:[0,0,2,2] row_mask:0xf bank_mask:0xf
    v_subrev_f32_dpp v169, v157, v169 quad_perm:[0,0,2,2] row_mask:0xf bank_mask:0xf
    v_subrev_f32_dpp v170, v158, v170 quad_perm:[0,0,2,2] row_mask:0xf bank_mask:0xf
    v_subrev_f32_dpp v171, v159, v171 quad_perm:[0,0,2,2] row_mask:0xf bank_mask:0xf
    v_subrev_f32_dpp v172, v156, v172 quad_perm:[1,1,3,3] row_mask:0xf bank_mask:0xf
    v_subrev_f32_dpp v173, v157, v173 quad_perm:[1,1,3,3] row_mask:0xf bank_mask:0xf
    v_subrev_f32_dpp v174, v158, v174 quad_perm:[1,1,3,3] row_mask:0xf bank_mask:0xf
    v_subrev_f32_dpp v175, v159, v175 quad_perm:[1,1,3,3] row_mask:0xf bank_mask:0xf
    v_cvt_pk_bf16_f32 v176, v168, v169
    v_cvt_pk_bf16_f32 v177, v170, v171
    v_cvt_pk_bf16_f32 v178, v172, v173
    v_cvt_pk_bf16_f32 v179, v174, v175
    v_lshlrev_b32 v168, 16, v176
    v_and_b32 v169, s63, v176
    v_lshlrev_b32 v170, 16, v177
    v_and_b32 v171, s63, v177
    v_lshlrev_b32 v172, 16, v178
    v_and_b32 v173, s63, v178
    v_lshlrev_b32 v174, 16, v179
    v_and_b32 v175, s63, v179
    v_mul_f32_dpp v168, v164, v168 quad_perm:[0,0,2,2] row_mask:0xf bank_mask:0xf
    v_mul_f32_dpp v169, v165, v169 quad_perm:[0,0,2,2] row_mask:0xf bank_mask:0xf
    v_mul_f32_dpp v170, v166, v170 quad_perm:[0,0,2,2] row_mask:0xf bank_mask:0xf
    v_mul_f32_dpp v171, v167, v171 quad_perm:[0,0,2,2] row_mask:0xf bank_mask:0xf
    v_mul_f32_dpp v172, v164, v172 quad_perm:[1,1,3,3] row_mask:0xf bank_mask:0xf
    v_mul_f32_dpp v173, v165, v173 quad_perm:[1,1,3,3] row_mask:0xf bank_mask:0xf
    v_mul_f32_dpp v174, v166, v174 quad_perm:[1,1,3,3] row_mask:0xf bank_mask:0xf
    v_mul_f32_dpp v175, v167, v175 quad_perm:[1,1,3,3] row_mask:0xf bank_mask:0xf
    v_cvt_pk_bf16_f32 v184, v168, v169
    v_cvt_pk_bf16_f32 v185, v170, v171
    v_cvt_pk_bf16_f32 v186, v172, v173
    v_cvt_pk_bf16_f32 v187, v174, v175
    ds_write_b128 v133, v[184:187] offset:512
    s_setprio 0
    s_waitcnt lgkmcnt(0)
    s_barrier
    s_branch M_L2
M_C:
    s_mov_b32 s64, s62
    s_mov_b32 s65, s63
    v_and_b32 v8, 15, v2
    v_lshrrev_b32 v9, 4, v2
    s_add_u32 s15, s15, 147584
    s_mul_i32 s13, s13, 14336
    s_lshl_b32 s14, s14, 9
    s_add_u32 s13, s13, s14
    s_lshl_b32 s14, s3, 7
    s_add_u32 s13, s13, s14
    s_add_u32 s40, s64, 8388608
    s_addc_u32 s41, s65, 0
    s_mov_b32 s42, 1048576
    s_mov_b32 s43, 0x20000
    s_lshl_b32 s44, s3, 14
    v_lshlrev_b32 v5, 5, v2
    v_lshlrev_b32 v6, 2, v2
    v_and_b32 v6, 16, v6
    v_add3_u32 v5, v5, v6, s44
    v_xor_b32 v6, 16, v5
    v_lshrrev_b32 v7, 2, v2
    v_lshlrev_b32 v7, 5, v7
    v_lshlrev_b32 v20, 3, v2
    v_and_b32 v20, 24, v20
    v_and_b32 v21, 16, v2
    v_xor_b32 v20, v20, v21
    v_add3_u32 v7, v7, v20, s44
    s_mul_i32 s45, s52, 12304
    s_add_u32 s45, s45, 65536
    s_and_b32 s47, s3, 1
    s_lshl_b32 s46, s47, 2
    s_add_u32 s46, s46, s45
    s_sub_u32 s48, s46, 130040
    s_sub_u32 s49, s45, 130040
    s_mov_b32 s50, 1065303935
    v_and_b32 v20, 1, v9
    v_lshrrev_b32 v21, 1, v9
    v_lshlrev_b32 v16, 3, v8
    v_lshl_add_u32 v16, v20, 2, v16
    v_lshl_add_u32 v16, v21, 7, v16
    v_cvt_f32_u32 v16, v16
    v_add_f32 v20, 1.0, v16
    v_add_f32 v21, 2.0, v16
    v_add_f32 v22, 0x40400000, v16
    v_cvt_pk_bf16_f32 v16, v16, v20
    v_cvt_pk_bf16_f32 v21, v21, v22
    v_pk_max_u16 v16, v16, s50
    v_mad_u32_u16 v28, v16, 8, s48
    v_mad_u32_u16 v29, v16, 8, s48 op_sel:[1,0,0,0]
    v_mad_u32_u16 v30, v21, 8, s48
    v_mad_u32_u16 v31, v21, 8, s48 op_sel:[1,0,0,0]
    v_cmp_gt_u32 vcc, 2, v9
    v_lshlrev_b32 v17, 1, v8
    v_lshlrev_b32 v18, 2, v8
    v_cndmask_b32 v17, v17, v18, vcc
    v_lshl_add_u32 v17, v9, 6, v17
    v_add_u32 v17, 1025, v17
    v_lshl_add_u32 v17, v17, 3, s46
    v_mov_b32 v18, 256
    v_cndmask_b32 v18, v18, 16, vcc
    v_add_u32 v18, v17, v18
    v_lshl_add_u32 v19, v9, 6, v8
    v_add_u32 v19, 1281, v19
    v_lshl_add_u32 v19, v19, 3, s46
    s_lshl_b32 s51, s47, 10
    s_sub_u32 s51, 2047, s51
    v_lshlrev_b32 v20, 4, v2
    v_sub_u32 v20, s51, v20
    v_cmp_gt_u32 vcc, 16, v20
    v_cvt_f32_u32 v20, v20
    v_mov_b32 v24, 1161577788
    v_subrev_f32 v22, 0x3f800000, v20
    v_cvt_pk_bf16_f32 v23, v20, v22
    v_mad_u32_u16 v212, v23, 8, s49
    v_mad_u32_u16 v213, v23, 8, s49 op_sel:[1,0,0,0]
    v_subrev_f32 v21, 0x40000000, v20
    v_subrev_f32 v22, 0x40400000, v20
    v_cvt_pk_bf16_f32 v23, v21, v22
    v_mad_u32_u16 v214, v23, 8, s49
    v_mad_u32_u16 v215, v23, 8, s49 op_sel:[1,0,0,0]
    v_subrev_f32 v21, 0x40800000, v20
    v_subrev_f32 v22, 0x40a00000, v20
    v_cvt_pk_bf16_f32 v23, v21, v22
    v_mad_u32_u16 v216, v23, 8, s49
    v_mad_u32_u16 v217, v23, 8, s49 op_sel:[1,0,0,0]
    v_subrev_f32 v21, 0x40c00000, v20
    v_subrev_f32 v22, 0x40e00000, v20
    v_cvt_pk_bf16_f32 v23, v21, v22
    v_mad_u32_u16 v218, v23, 8, s49
    v_mad_u32_u16 v219, v23, 8, s49 op_sel:[1,0,0,0]
    v_subrev_f32 v21, 0x41000000, v20
    v_subrev_f32 v22, 0x41100000, v20
    v_cvt_pk_bf16_f32 v23, v21, v22
    v_mad_u32_u16 v220, v23, 8, s49
    v_mad_u32_u16 v221, v23, 8, s49 op_sel:[1,0,0,0]
    v_subrev_f32 v21, 0x41200000, v20
    v_subrev_f32 v22, 0x41300000, v20
    v_cvt_pk_bf16_f32 v23, v21, v22
    v_mad_u32_u16 v222, v23, 8, s49
    v_mad_u32_u16 v223, v23, 8, s49 op_sel:[1,0,0,0]
    v_subrev_f32 v21, 0x41400000, v20
    v_subrev_f32 v22, 0x41500000, v20
    v_cvt_pk_bf16_f32 v23, v21, v22
    v_mad_u32_u16 v224, v23, 8, s49
    v_mad_u32_u16 v225, v23, 8, s49 op_sel:[1,0,0,0]
    v_subrev_f32 v21, 0x41600000, v20
    v_subrev_f32 v22, 0x41700000, v20
    v_cvt_pk_bf16_f32 v23, v21, v22
    v_pk_max_u16 v23, v23, s50
    v_mad_u32_u16 v226, v23, 8, s49
    v_mad_u32_u16 v227, v23, 8, s49 op_sel:[1,0,0,0]
    v_subrev_f32 v21, 0x41800000, v20
    v_subrev_f32 v22, 0x41880000, v20
    v_cvt_pk_bf16_f32 v23, v21, v22
    v_pk_max_u16 v23, v23, s50
    v_cndmask_b32 v23, v23, v24, vcc
    v_mad_u32_u16 v228, v23, 8, s49
    v_mad_u32_u16 v229, v23, 8, s49 op_sel:[1,0,0,0]
    v_subrev_f32 v21, 0x41900000, v20
    v_subrev_f32 v22, 0x41980000, v20
    v_cvt_pk_bf16_f32 v23, v21, v22
    v_pk_max_u16 v23, v23, s50
    v_cndmask_b32 v23, v23, v24, vcc
    v_mad_u32_u16 v230, v23, 8, s49
    s_mov_b32 s50, 0x3fb8aa3b
    s_mov_b32 s51, 0x3e22f983
    s_waitcnt vmcnt(8)
    v_lshlrev_b32 v10, 16, v10
    v_lshlrev_b32 v11, 16, v11
    v_mul_f32 v10, s50, v10
    v_mul_f32 v11, s50, v11
    v_exp_f32 v10, v10
    v_exp_f32 v11, v11
    s_waitcnt vmcnt(4)
    v_lshlrev_b32 v12, 16, v12
    v_cvt_pk_bf16_f32 v20, v10, v11
    v_lshlrev_b32 v13, 16, v13
    v_lshlrev_b32 v14, 16, v14
    v_lshlrev_b32 v10, 16, v20
    v_and_b32 v11, 0xffff0000, v20
    v_mul_f32 v11, v11, v10
    v_mul_f32 v12, v12, v10
    v_mul_f32_e64 v11, -v11, s50
    v_mul_f32 v12, s51, v12
    v_add_f32 v10, v10, v10
    v_lshlrev_b32 v208, 16, v208
    v_mul_f32 v188, 0x41000000, v11
    v_mov_b32 v190, v11
    v_mul_f32 v192, 0x43000000, v11
    v_max_f32_e64 v20, abs(v13), abs(v14)
    v_mul_f32 v189, 0x41000000, v12
    v_mov_b32 v191, v12
    v_mul_f32 v193, 0x43000000, v12
    v_max_f32_dpp v20, v20, v20 quad_perm:[1,0,3,2] row_mask:0xf bank_mask:0xf
    v_exp_f32 v188, v188
    v_exp_f32 v190, v190
    v_exp_f32 v192, v192
    v_max_f32_dpp v20, v20, v20 quad_perm:[2,3,0,1] row_mask:0xf bank_mask:0xf
    v_fract_f32 v189, v189
    v_fract_f32 v191, v191
    v_fract_f32 v193, v193
    v_max_f32_dpp v20, v20, v20 row_half_mirror row_mask:0xf bank_mask:0xf
    v_cos_f32 v154, v189
    v_cos_f32 v74, v191
    v_cos_f32 v88, v193
    v_max_f32_dpp v20, v20, v20 row_mirror row_mask:0xf bank_mask:0xf
    v_sin_f32 v155, v189
    v_sin_f32 v75, v191
    v_sin_f32 v89, v193
    v_mov_b32 v21, v20
    v_mul_f32 v154, v154, v188
    v_mul_f32 v74, v74, v190
    v_mul_f32 v88, v88, v192
    v_permlane16_swap_b32 v20, v21
    v_max_f32 v20, v20, v21
    v_mul_f32_e64 v155, v155, -v188
    v_mul_f32_e64 v75, v75, v190
    v_mul_f32_e64 v89, v89, v192
    v_mov_b32 v21, v20
    v_mov_b32 v72, 1.0
    v_mov_b32 v73, 0
    v_permlane32_swap_b32 v20, v21
    v_max_f32 v20, v20, v21
    v_frexp_exp_i32_f32 v20, v20
    v_add_u32 v20, -14, v20
    v_sub_u32 v21, 0, v20
    v_ldexp_f32 v10, v10, v20
    v_ldexp_f32 v40, v13, v21
    v_ldexp_f32 v41, -v14, v21
    v_pk_mul_f32 v[42:43], v[40:41], v[154:155] op_sel:[0,0] op_sel_hi:[0,1]
    v_pk_mul_f32 v[76:77], v[74:75], v[74:75] op_sel:[0,0] op_sel_hi:[0,1]
    v_pk_fma_f32 v[42:43], v[40:41], v[154:155], v[42:43] op_sel:[1,1,0] op_sel_hi:[1,0,1] neg_lo:[0,1,0]
    v_pk_fma_f32 v[76:77], v[74:75], v[74:75], v[76:77] op_sel:[1,1,0] op_sel_hi:[1,0,1] neg_lo:[0,1,0]
    v_pk_mul_f32 v[44:45], v[42:43], v[154:155] op_sel:[0,0] op_sel_hi:[0,1]
    v_pk_mul_f32 v[78:79], v[76:77], v[74:75] op_sel:[0,0] op_sel_hi:[0,1]
    v_pk_fma_f32 v[44:45], v[42:43], v[154:155], v[44:45] op_sel:[1,1,0] op_sel_hi:[1,0,1] neg_lo:[0,1,0]
    v_pk_fma_f32 v[78:79], v[76:77], v[74:75], v[78:79] op_sel:[1,1,0] op_sel_hi:[1,0,1] neg_lo:[0,1,0]
    v_pk_mul_f32 v[46:47], v[44:45], v[154:155] op_sel:[0,0] op_sel_hi:[0,1]
    v_pk_mul_f32 v[80:81], v[78:79], v[74:75] op_sel:[0,0] op_sel_hi:[0,1]
    v_pk_fma_f32 v[46:47], v[44:45], v[154:155], v[46:47] op_sel:[1,1,0] op_sel_hi:[1,0,1] neg_lo:[0,1,0]
    v_pk_fma_f32 v[80:81], v[78:79], v[74:75], v[80:81] op_sel:[1,1,0] op_sel_hi:[1,0,1] neg_lo:[0,1,0]
    v_pk_mul_f32 v[48:49], v[46:47], v[154:155] op_sel:[0,0] op_sel_hi:[0,1]
    v_pk_mul_f32 v[82:83], v[80:81], v[74:75] op_sel:[0,0] op_sel_hi:[0,1]
    v_pk_fma_f32 v[48:49], v[46:47], v[154:155], v[48:49] op_sel:[1,1,0] op_sel_hi:[1,0,1] neg_lo:[0,1,0]
    v_pk_fma_f32 v[82:83], v[80:81], v[74:75], v[82:83] op_sel:[1,1,0] op_sel_hi:[1,0,1] neg_lo:[0,1,0]
    v_pk_mul_f32 v[50:51], v[48:49], v[154:155] op_sel:[0,0] op_sel_hi:[0,1]
    v_pk_mul_f32 v[84:85], v[82:83], v[74:75] op_sel:[0,0] op_sel_hi:[0,1]
    v_pk_fma_f32 v[50:51], v[48:49], v[154:155], v[50:51] op_sel:[1,1,0] op_sel_hi:[1,0,1] neg_lo:[0,1,0]
    v_pk_fma_f32 v[84:85], v[82:83], v[74:75], v[84:85] op_sel:[1,1,0] op_sel_hi:[1,0,1] neg_lo:[0,1,0]
    v_pk_mul_f32 v[52:53], v[50:51], v[154:155] op_sel:[0,0] op_sel_hi:[0,1]
    v_pk_mul_f32 v[86:87], v[84:85], v[74:75] op_sel:[0,0] op_sel_hi:[0,1]
    v_pk_fma_f32 v[52:53], v[50:51], v[154:155], v[52:53] op_sel:[1,1,0] op_sel_hi:[1,0,1] neg_lo:[0,1,0]
    v_pk_fma_f32 v[86:87], v[84:85], v[74:75], v[86:87] op_sel:[1,1,0] op_sel_hi:[1,0,1] neg_lo:[0,1,0]
    v_pk_mul_f32 v[54:55], v[52:53], v[154:155] op_sel:[0,0] op_sel_hi:[0,1]
    v_pk_mul_f32 v[90:91], v[74:75], v[88:89] op_sel:[0,0] op_sel_hi:[0,1]
    v_pk_fma_f32 v[54:55], v[52:53], v[154:155], v[54:55] op_sel:[1,1,0] op_sel_hi:[1,0,1] neg_lo:[0,1,0]
    v_pk_fma_f32 v[90:91], v[74:75], v[88:89], v[90:91] op_sel:[1,1,0] op_sel_hi:[1,0,1] neg_lo:[0,1,0]
    v_pk_mul_f32 v[56:57], v[54:55], v[154:155] op_sel:[0,0] op_sel_hi:[0,1]
    v_pk_mul_f32 v[92:93], v[76:77], v[88:89] op_sel:[0,0] op_sel_hi:[0,1]
    v_pk_fma_f32 v[56:57], v[54:55], v[154:155], v[56:57] op_sel:[1,1,0] op_sel_hi:[1,0,1] neg_lo:[0,1,0]
    v_pk_fma_f32 v[92:93], v[76:77], v[88:89], v[92:93] op_sel:[1,1,0] op_sel_hi:[1,0,1] neg_lo:[0,1,0]
    v_pk_mul_f32 v[58:59], v[56:57], v[154:155] op_sel:[0,0] op_sel_hi:[0,1]
    v_pk_mul_f32 v[94:95], v[78:79], v[88:89] op_sel:[0,0] op_sel_hi:[0,1]
    v_pk_fma_f32 v[58:59], v[56:57], v[154:155], v[58:59] op_sel:[1,1,0] op_sel_hi:[1,0,1] neg_lo:[0,1,0]
    v_pk_fma_f32 v[94:95], v[78:79], v[88:89], v[94:95] op_sel:[1,1,0] op_sel_hi:[1,0,1] neg_lo:[0,1,0]
    v_pk_mul_f32 v[60:61], v[58:59], v[154:155] op_sel:[0,0] op_sel_hi:[0,1]
    v_pk_mul_f32 v[96:97], v[80:81], v[88:89] op_sel:[0,0] op_sel_hi:[0,1]
    v_pk_fma_f32 v[60:61], v[58:59], v[154:155], v[60:61] op_sel:[1,1,0] op_sel_hi:[1,0,1] neg_lo:[0,1,0]
    v_pk_fma_f32 v[96:97], v[80:81], v[88:89], v[96:97] op_sel:[1,1,0] op_sel_hi:[1,0,1] neg_lo:[0,1,0]
    v_pk_mul_f32 v[62:63], v[60:61], v[154:155] op_sel:[0,0] op_sel_hi:[0,1]
    v_pk_mul_f32 v[98:99], v[82:83], v[88:89] op_sel:[0,0] op_sel_hi:[0,1]
    v_pk_fma_f32 v[62:63], v[60:61], v[154:155], v[62:63] op_sel:[1,1,0] op_sel_hi:[1,0,1] neg_lo:[0,1,0]
    v_pk_fma_f32 v[98:99], v[82:83], v[88:89], v[98:99] op_sel:[1,1,0] op_sel_hi:[1,0,1] neg_lo:[0,1,0]
    v_pk_mul_f32 v[64:65], v[62:63], v[154:155] op_sel:[0,0] op_sel_hi:[0,1]
    v_pk_mul_f32 v[100:101], v[84:85], v[88:89] op_sel:[0,0] op_sel_hi:[0,1]
    v_pk_fma_f32 v[64:65], v[62:63], v[154:155], v[64:65] op_sel:[1,1,0] op_sel_hi:[1,0,1] neg_lo:[0,1,0]
    v_pk_fma_f32 v[100:101], v[84:85], v[88:89], v[100:101] op_sel:[1,1,0] op_sel_hi:[1,0,1] neg_lo:[0,1,0]
    v_pk_mul_f32 v[66:67], v[64:65], v[154:155] op_sel:[0,0] op_sel_hi:[0,1]
    v_pk_mul_f32 v[102:103], v[86:87], v[88:89] op_sel:[0,0] op_sel_hi:[0,1]
    v_pk_fma_f32 v[66:67], v[64:65], v[154:155], v[66:67] op_sel:[1,1,0] op_sel_hi:[1,0,1] neg_lo:[0,1,0]
    v_pk_fma_f32 v[102:103], v[86:87], v[88:89], v[102:103] op_sel:[1,1,0] op_sel_hi:[1,0,1] neg_lo:[0,1,0]
    v_pk_mul_f32 v[68:69], v[66:67], v[154:155] op_sel:[0,0] op_sel_hi:[0,1]
    v_pk_fma_f32 v[68:69], v[66:67], v[154:155], v[68:69] op_sel:[1,1,0] op_sel_hi:[1,0,1] neg_lo:[0,1,0]
    v_pk_mul_f32 v[70:71], v[68:69], v[154:155] op_sel:[0,0] op_sel_hi:[0,1]
    v_pk_fma_f32 v[70:71], v[68:69], v[154:155], v[70:71] op_sel:[1,1,0] op_sel_hi:[1,0,1] neg_lo:[0,1,0]
    v_pk_mul_f32 v[104:105], v[88:89], v[88:89] op_sel:[0,0] op_sel_hi:[0,1]
    v_cvt_pk_f16_f32 v156, v40, v42
    v_pk_fma_f32 v[104:105], v[88:89], v[88:89], v[104:105] op_sel:[1,1,0] op_sel_hi:[1,0,1] neg_lo:[0,1,0]
    v_cvt_pk_f16_f32 v157, v44, v46
    v_pk_mul_f32 v[112:113], v[104:105], v[88:89] op_sel:[0,0] op_sel_hi:[0,1]
    v_cvt_pk_f16_f32 v158, v48, v50
    v_pk_fma_f32 v[112:113], v[104:105], v[88:89], v[112:113] op_sel:[1,1,0] op_sel_hi:[1,0,1] neg_lo:[0,1,0]
    v_cvt_pk_f16_f32 v159, v52, v54
    v_pk_mul_f32 v[120:121], v[112:113], v[88:89] op_sel:[0,0] op_sel_hi:[0,1]
    ds_write_b128 v5, v[156:159] offset:0
    v_pk_fma_f32 v[120:121], v[112:113], v[88:89], v[120:121] op_sel:[1,1,0] op_sel_hi:[1,0,1] neg_lo:[0,1,0]
    v_cvt_pk_f16_f32 v160, v56, v58
    v_pk_mul_f32 v[124:125], v[120:121], v[88:89] op_sel:[0,0] op_sel_hi:[0,1]
    v_cvt_pk_f16_f32 v161, v60, v62
    v_pk_fma_f32 v[124:125], v[120:121], v[88:89], v[124:125] op_sel:[1,1,0] op_sel_hi:[1,0,1] neg_lo:[0,1,0]
    v_cvt_pk_f16_f32 v162, v64, v66
    v_pk_mul_f32 v[128:129], v[124:125], v[88:89] op_sel:[0,0] op_sel_hi:[0,1]
    v_cvt_pk_f16_f32 v163, v68, v70
    v_pk_fma_f32 v[128:129], v[124:125], v[88:89], v[128:129] op_sel:[1,1,0] op_sel_hi:[1,0,1] neg_lo:[0,1,0]
    ds_write_b128 v6, v[160:163] offset:0
    v_pk_mul_f32 v[132:133], v[128:129], v[88:89] op_sel:[0,0] op_sel_hi:[0,1]
    v_cvt_pk_f16_f32 v164, v41, v43
    v_pk_fma_f32 v[132:133], v[128:129], v[88:89], v[132:133] op_sel:[1,1,0] op_sel_hi:[1,0,1] neg_lo:[0,1,0]
    v_cvt_pk_f16_f32 v165, v45, v47
    v_pk_mul_f32 v[136:137], v[132:133], v[88:89] op_sel:[0,0] op_sel_hi:[0,1]
    v_cvt_pk_f16_f32 v166, v49, v51
    v_pk_fma_f32 v[136:137], v[132:133], v[88:89], v[136:137] op_sel:[1,1,0] op_sel_hi:[1,0,1] neg_lo:[0,1,0]
    v_cvt_pk_f16_f32 v167, v53, v55
    v_pk_mul_f32 v[138:139], v[136:137], v[88:89] op_sel:[0,0] op_sel_hi:[0,1]
    ds_write_b128 v5, v[164:167] offset:2048
    v_pk_fma_f32 v[138:139], v[136:137], v[88:89], v[138:139] op_sel:[1,1,0] op_sel_hi:[1,0,1] neg_lo:[0,1,0]
    v_cvt_pk_f16_f32 v168, v57, v59
    v_pk_mul_f32 v[140:141], v[138:139], v[88:89] op_sel:[0,0] op_sel_hi:[0,1]
    v_cvt_pk_f16_f32 v169, v61, v63
    v_pk_fma_f32 v[140:141], v[138:139], v[88:89], v[140:141] op_sel:[1,1,0] op_sel_hi:[1,0,1] neg_lo:[0,1,0]
    v_cvt_pk_f16_f32 v170, v65, v67
    v_pk_mul_f32 v[142:143], v[140:141], v[88:89] op_sel:[0,0] op_sel_hi:[0,1]
    v_cvt_pk_f16_f32 v171, v69, v71
    v_pk_fma_f32 v[142:143], v[140:141], v[88:89], v[142:143] op_sel:[1,1,0] op_sel_hi:[1,0,1] neg_lo:[0,1,0]
    ds_write_b128 v6, v[168:171] offset:2048
    v_pk_mul_f32 v[144:145], v[142:143], v[88:89] op_sel:[0,0] op_sel_hi:[0,1]
    v_cvt_pk_f16_f32 v172, v72, v74
    v_pk_fma_f32 v[144:145], v[142:143], v[88:89], v[144:145] op_sel:[1,1,0] op_sel_hi:[1,0,1] neg_lo:[0,1,0]
    v_cvt_pk_f16_f32 v173, v76, v78
    v_pk_mul_f32 v[146:147], v[144:145], v[88:89] op_sel:[0,0] op_sel_hi:[0,1]
    v_cvt_pk_f16_f32 v174, v80, v82
    v_pk_fma_f32 v[146:147], v[144:145], v[88:89], v[146:147] op_sel:[1,1,0] op_sel_hi:[1,0,1] neg_lo:[0,1,0]
    v_cvt_pk_f16_f32 v175, v84, v86
    v_pk_mul_f32 v[148:149], v[146:147], v[88:89] op_sel:[0,0] op_sel_hi:[0,1]
    ds_write_b128 v5, v[172:175] offset:4096
    v_pk_fma_f32 v[148:149], v[146:147], v[88:89], v[148:149] op_sel:[1,1,0] op_sel_hi:[1,0,1] neg_lo:[0,1,0]
    v_cvt_pk_f16_f32 v176, v88, v90
    v_pk_mul_f32 v[150:151], v[148:149], v[88:89] op_sel:[0,0] op_sel_hi:[0,1]
    v_cvt_pk_f16_f32 v177, v92, v94
    v_pk_fma_f32 v[150:151], v[148:149], v[88:89], v[150:151] op_sel:[1,1,0] op_sel_hi:[1,0,1] neg_lo:[0,1,0]
    v_cvt_pk_f16_f32 v178, v96, v98
    v_pk_mul_f32 v[152:153], v[150:151], v[88:89] op_sel:[0,0] op_sel_hi:[0,1]
    v_cvt_pk_f16_f32 v179, v100, v102
    v_pk_fma_f32 v[152:153], v[150:151], v[88:89], v[152:153] op_sel:[1,1,0] op_sel_hi:[1,0,1] neg_lo:[0,1,0]
    ds_write_b128 v6, v[176:179] offset:4096
    v_cvt_pk_f16_f32 v180, v73, v75
    v_cvt_pk_f16_f32 v181, v77, v79
    v_cvt_pk_f16_f32 v182, v81, v83
    v_cvt_pk_f16_f32 v183, v85, v87
    ds_write_b128 v5, v[180:183] offset:6144
    v_cvt_pk_f16_f32 v184, v89, v91
    v_cvt_pk_f16_f32 v185, v93, v95
    v_cvt_pk_f16_f32 v186, v97, v99
    v_cvt_pk_f16_f32 v187, v101, v103
    ds_write_b128 v6, v[184:187] offset:6144
    v_cvt_pk_f16_f32 v40, v136, v138
    v_pk_mul_f32 v[106:107], v[104:105], v[76:77] op_sel:[0,0] op_sel_hi:[0,1]
    v_cvt_pk_f16_f32 v41, v140, v142
    v_pk_fma_f32 v[106:107], v[104:105], v[76:77], v[106:107] op_sel:[1,1,0] op_sel_hi:[1,0,1] neg_lo:[0,1,0]
    v_cvt_pk_f16_f32 v42, v144, v146
    v_pk_mul_f32 v[108:109], v[104:105], v[80:81] op_sel:[0,0] op_sel_hi:[0,1]
    v_cvt_pk_f16_f32 v43, v148, v150
    v_pk_fma_f32 v[108:109], v[104:105], v[80:81], v[108:109] op_sel:[1,1,0] op_sel_hi:[1,0,1] neg_lo:[0,1,0]
    ds_write_b128 v5, v[40:43] offset:12288
    v_pk_mul_f32 v[110:111], v[104:105], v[84:85] op_sel:[0,0] op_sel_hi:[0,1]
    v_cvt_pk_f16_f32 v44, v152, 0
    v_pk_fma_f32 v[110:111], v[104:105], v[84:85], v[110:111] op_sel:[1,1,0] op_sel_hi:[1,0,1] neg_lo:[0,1,0]
    v_mov_b32 v45, 0
    v_pk_mul_f32 v[122:123], v[120:121], v[80:81] op_sel:[0,0] op_sel_hi:[0,1]
    v_mov_b32 v46, 0
    v_pk_fma_f32 v[122:123], v[120:121], v[80:81], v[122:123] op_sel:[1,1,0] op_sel_hi:[1,0,1] neg_lo:[0,1,0]
    v_mov_b32 v47, 0
    v_pk_mul_f32 v[126:127], v[124:125], v[80:81] op_sel:[0,0] op_sel_hi:[0,1]
    ds_write_b128 v6, v[44:47] offset:12288
    v_pk_fma_f32 v[126:127], v[124:125], v[80:81], v[126:127] op_sel:[1,1,0] op_sel_hi:[1,0,1] neg_lo:[0,1,0]
    v_cvt_pk_f16_f32 v48, v137, v139
    v_pk_mul_f32 v[114:115], v[112:113], v[76:77] op_sel:[0,0] op_sel_hi:[0,1]
    v_cvt_pk_f16_f32 v49, v141, v143
    v_pk_fma_f32 v[114:115], v[112:113], v[76:77], v[114:115] op_sel:[1,1,0] op_sel_hi:[1,0,1] neg_lo:[0,1,0]
    v_cvt_pk_f16_f32 v50, v145, v147
    v_pk_mul_f32 v[116:117], v[112:113], v[80:81] op_sel:[0,0] op_sel_hi:[0,1]
    v_cvt_pk_f16_f32 v51, v149, v151
    v_pk_fma_f32 v[116:117], v[112:113], v[80:81], v[116:117] op_sel:[1,1,0] op_sel_hi:[1,0,1] neg_lo:[0,1,0]
    ds_write_b128 v5, v[48:51] offset:14336
    v_pk_mul_f32 v[118:119], v[112:113], v[84:85] op_sel:[0,0] op_sel_hi:[0,1]
    v_cvt_pk_f16_f32 v52, v153, 0
    v_pk_fma_f32 v[118:119], v[112:113], v[84:85], v[118:119] op_sel:[1,1,0] op_sel_hi:[1,0,1] neg_lo:[0,1,0]
    v_mov_b32 v53, 0
    v_pk_mul_f32 v[130:131], v[128:129], v[80:81] op_sel:[0,0] op_sel_hi:[0,1]
    v_mov_b32 v54, 0
    v_pk_fma_f32 v[130:131], v[128:129], v[80:81], v[130:131] op_sel:[1,1,0] op_sel_hi:[1,0,1] neg_lo:[0,1,0]
    v_mov_b32 v55, 0
    v_pk_mul_f32 v[134:135], v[132:133], v[80:81] op_sel:[0,0] op_sel_hi:[0,1]
    ds_write_b128 v6, v[52:55] offset:14336
    v_pk_fma_f32 v[134:135], v[132:133], v[80:81], v[134:135] op_sel:[1,1,0] op_sel_hi:[1,0,1] neg_lo:[0,1,0]
    v_cvt_pk_f16_f32 v56, v104, v106
    v_cvt_pk_f16_f32 v57, v108, v110
    v_cvt_pk_f16_f32 v58, v112, v114
    v_cvt_pk_f16_f32 v59, v116, v118
    ds_write_b128 v5, v[56:59] offset:8192
    v_cvt_pk_f16_f32 v60, v120, v122
    v_cvt_pk_f16_f32 v61, v124, v126
    v_cvt_pk_f16_f32 v62, v128, v130
    v_cvt_pk_f16_f32 v63, v132, v134
    ds_write_b128 v6, v[60:63] offset:8192
    v_cvt_pk_f16_f32 v64, v105, v107
    v_cvt_pk_f16_f32 v65, v109, v111
    v_cvt_pk_f16_f32 v66, v113, v115
    v_cvt_pk_f16_f32 v67, v117, v119
    ds_write_b128 v5, v[64:67] offset:10240
    v_cvt_pk_f16_f32 v68, v121, v123
    v_cvt_pk_f16_f32 v69, v125, v127
    v_cvt_pk_f16_f32 v70, v129, v131
    v_cvt_pk_f16_f32 v71, v133, v135
    ds_write_b128 v6, v[68:71] offset:10240
    ds_read_b64_tr_b16 v[72:73], v7 offset:0
    ds_read_b64_tr_b16 v[74:75], v7 offset:512
    ds_read_b64_tr_b16 v[76:77], v7 offset:1024
    ds_read_b64_tr_b16 v[78:79], v7 offset:1536
    ds_read_b64_tr_b16 v[80:81], v7 offset:2048
    ds_read_b64_tr_b16 v[82:83], v7 offset:2560
    ds_read_b64_tr_b16 v[84:85], v7 offset:3072
    ds_read_b64_tr_b16 v[86:87], v7 offset:3584
    ds_read_b64_tr_b16 v[88:89], v7 offset:4096
    ds_read_b64_tr_b16 v[90:91], v7 offset:4608
    ds_read_b64_tr_b16 v[92:93], v7 offset:5120
    ds_read_b64_tr_b16 v[94:95], v7 offset:5632
    ds_read_b64_tr_b16 v[96:97], v7 offset:6144
    ds_read_b64_tr_b16 v[98:99], v7 offset:6656
    ds_read_b64_tr_b16 v[100:101], v7 offset:7168
    ds_read_b64_tr_b16 v[102:103], v7 offset:7680
    ds_read_b64_tr_b16 v[120:121], v7 offset:12288
    ds_read_b64_tr_b16 v[122:123], v7 offset:12800
    ds_read_b64_tr_b16 v[124:125], v7 offset:13312
    ds_read_b64_tr_b16 v[126:127], v7 offset:13824
    ds_read_b64_tr_b16 v[128:129], v7 offset:14336
    ds_read_b64_tr_b16 v[130:131], v7 offset:14848
    ds_read_b64_tr_b16 v[132:133], v7 offset:15360
    ds_read_b64_tr_b16 v[134:135], v7 offset:15872
    ds_read_b64_tr_b16 v[104:105], v7 offset:8192
    ds_read_b64_tr_b16 v[106:107], v7 offset:8704
    ds_read_b64_tr_b16 v[108:109], v7 offset:9216
    ds_read_b64_tr_b16 v[110:111], v7 offset:9728
    ds_read_b64_tr_b16 v[112:113], v7 offset:10240
    ds_read_b64_tr_b16 v[114:115], v7 offset:10752
    ds_read_b64_tr_b16 v[116:117], v7 offset:11264
    ds_read_b64_tr_b16 v[118:119], v7 offset:11776
    s_mul_i32 s44, s52, 16640
    s_add_u32 s44, s44, 108160
    s_mul_i32 s45, s52, 4672
    s_add_u32 s45, s45, 141440
    v_sub_u32 v36, 15, v8
    v_and_b32 v37, 3, v36
    v_lshrrev_b32 v36, 2, v36
    v_mul_u32_u24 v200, 4160, v37
    v_lshl_add_u32 v200, v36, 3, v200
    v_lshl_add_u32 v200, v9, 4, v200
    s_lshl_b32 s53, s47, 8
    s_sub_u32 s54, s44, s53
    v_add_u32 v200, s54, v200
    v_lshlrev_b32 v201, 5, v8
    v_lshl_add_u32 v202, v9, 3, v201
    v_lshl_add_u32 v201, v9, 4, v201
    s_sub_u32 s54, s45, s53
    v_add_u32 v201, s54, v201
    s_waitcnt lgkmcnt(15)
    v_mfma_f32_16x16x32_f16 v[144:147], v[88:91], v[72:75], 0
    v_mfma_f32_16x16x32_f16 v[144:147], v[92:95], v[76:79], v[144:147]
    v_mfma_f32_16x16x32_f16 v[144:147], v[96:99], v[80:83], v[144:147]
    v_mfma_f32_16x16x32_f16 v[144:147], v[100:103], v[84:87], v[144:147]
    s_waitcnt lgkmcnt(8)
    v_mfma_f32_16x16x32_f16 v[152:155], v[120:123], v[72:75], 0
    v_mfma_f32_16x16x32_f16 v[152:155], v[124:127], v[76:79], v[152:155]
    v_mfma_f32_16x16x32_f16 v[152:155], v[128:131], v[80:83], v[152:155]
    v_mfma_f32_16x16x32_f16 v[152:155], v[132:135], v[84:87], v[152:155]
    s_waitcnt lgkmcnt(0)
    v_mfma_f32_16x16x32_f16 v[148:151], v[104:107], v[72:75], 0
    v_mfma_f32_16x16x32_f16 v[148:151], v[108:111], v[76:79], v[148:151]
    v_mfma_f32_16x16x32_f16 v[148:151], v[112:115], v[80:83], v[148:151]
    v_mfma_f32_16x16x32_f16 v[148:151], v[116:119], v[84:87], v[148:151]
    v_pk_mul_f32 v[144:145], v[144:145], v[10:11] op_sel_hi:[1,0]
    v_pk_mul_f32 v[146:147], v[146:147], v[10:11] op_sel_hi:[1,0]
    ds_write_b32 v28, v144
    ds_write_b32 v29, v145
    ds_write_b32 v30, v146
    ds_write_b32 v31, v147
    v_pk_mul_f32 v[152:153], v[152:153], v[10:11] op_sel_hi:[1,0]
    v_pk_mul_f32 v[154:155], v[154:155], v[10:11] op_sel_hi:[1,0]
    ds_write_b32 v19, v152 offset:0
    ds_write_b32 v19, v153 offset:128
    ds_write_b32 v19, v154 offset:256
    ds_write_b32 v19, v155 offset:384
    v_pk_mul_f32 v[148:149], v[148:149], v[10:11] op_sel_hi:[1,0]
    v_pk_mul_f32 v[150:151], v[150:151], v[10:11] op_sel_hi:[1,0]
    ds_write_b32 v17, v148 offset:0
    ds_write_b32 v17, v149 offset:8
    ds_write_b32 v18, v150 offset:0
    ds_write_b32 v18, v151 offset:8
    s_lshl_b32 s54, s52, 2
    s_add_u32 s54, s54, 163200
    v_mov_b32 v207, s54
    v_mov_b32 v211, 1
    s_mov_b64 exec, 1
    ds_add_u32 v207, v211 offset:88
    s_mov_b64 exec, -1
    s_lshl_b32 s53, s47, 11
    s_add_u32 s54, s53, s44
    v_lshl_add_u32 v203, v2, 5, s54
    s_lshl_b32 s53, s47, 9
    s_add_u32 s54, s53, s45
    s_add_u32 s54, s54, 512
    v_add_u32 v202, s54, v202
    s_lshl_b32 s54, s47, 10
    s_sub_u32 s54, 1536, s54
    v_and_b32 v36, 1, v9
    v_lshrrev_b32 v37, 1, v9
    v_mul_u32_u24 v36, s54, v36
    v_lshl_add_u32 v204, v8, 5, v36
    v_lshl_add_u32 v204, v37, 4, v204
    v_add_u32 v231, s54, v202
    v_mov_b32 v32, 0
    v_mov_b32 v33, 0
    v_mov_b32 v34, 0
    v_mov_b32 v35, 0
    v_lshl_add_u32 v36, v2, 4, s45
    v_subrev_u32 v37, 32, v2
    v_lshrrev_b32 v38, 1, v37
    v_and_b32 v37, 1, v37
    v_mul_u32_u24 v38, 4160, v38
    v_lshl_add_u32 v38, v37, 4, v38
    s_add_u32 s54, s44, 4096
    v_add_u32 v38, s54, v38
    v_cmp_gt_u32 vcc, 32, v2
    s_nop 1
    v_cndmask_b32 v36, v38, v36, vcc
    s_mov_b32 exec_hi, 0xff
    ds_write_b128 v36, v[32:35]
    s_mov_b64 exec, -1
M_pairT:
    ds_read_b32 v39, v207 offset:88
    s_add_u32 s68, s68, 1
    s_waitcnt lgkmcnt(0)
    v_cmp_ne_u32 vcc, 2, v39
    s_cmp_gt_u32 s68, 0x100000
    s_cbranch_scc1 M_pairT_x
    s_nop 3
    s_cbranch_vccnz M_pairT
M_pairT_x:
    ds_read_b64 v[40:41], v212
    ds_read_b64 v[42:43], v213
    ds_read_b64 v[44:45], v214
    ds_read_b64 v[46:47], v215
    ds_read_b64 v[48:49], v216
    ds_read_b64 v[50:51], v217
    ds_read_b64 v[52:53], v218
    ds_read_b64 v[54:55], v219
    ds_read_b64 v[56:57], v220
    ds_read_b64 v[58:59], v221
    ds_read_b64 v[60:61], v222
    ds_read_b64 v[62:63], v223
    ds_read_b64 v[64:65], v224
    ds_read_b64 v[66:67], v225
    s_waitcnt lgkmcnt(3)
    v_add_f32 v40, v40, v41
    v_add_f32 v42, v42, v43
    v_add_f32 v44, v44, v45
    v_add_f32 v46, v46, v47
    v_add_f32 v48, v48, v49
    v_add_f32 v50, v50, v51
    v_add_f32 v52, v52, v53
    v_add_f32 v54, v54, v55
    v_add_f32 v56, v56, v57
    v_add_f32 v58, v58, v59
    v_add_f32 v60, v60, v61
    ds_read_b64 v[68:69], v226
    ds_read_b64 v[70:71], v227
    ds_read_b64 v[72:73], v228
    ds_read_b64 v[74:75], v229
    ds_read_b64 v[76:77], v230
    v_cvt_pk_bf16_f32 v80, v40, v42
    v_cvt_pk_bf16_f32 v81, v44, v46
    v_cvt_pk_bf16_f32 v82, v48, v50
    v_cvt_pk_bf16_f32 v83, v52, v54
    ds_write_b128 v203, v[80:83] offset:0
    v_cvt_pk_bf16_f32 v84, v42, v44
    v_cvt_pk_bf16_f32 v85, v46, v48
    v_cvt_pk_bf16_f32 v86, v50, v52
    v_cvt_pk_bf16_f32 v87, v54, v56
    ds_write_b128 v203, v[84:87] offset:4160
    v_cvt_pk_bf16_f32 v88, v44, v46
    v_cvt_pk_bf16_f32 v89, v48, v50
    v_cvt_pk_bf16_f32 v90, v52, v54
    v_cvt_pk_bf16_f32 v91, v56, v58
    ds_write_b128 v203, v[88:91] offset:8320
    v_cvt_pk_bf16_f32 v92, v46, v48
    v_cvt_pk_bf16_f32 v93, v50, v52
    v_cvt_pk_bf16_f32 v94, v54, v56
    v_cvt_pk_bf16_f32 v95, v58, v60
    ds_write_b128 v203, v[92:95] offset:12480
    s_waitcnt lgkmcnt(4)
    v_add_f32 v62, v62, v63
    v_add_f32 v64, v64, v65
    v_add_f32 v66, v66, v67
    v_add_f32 v68, v68, v69
    v_add_f32 v70, v70, v71
    v_add_f32 v72, v72, v73
    v_add_f32 v74, v74, v75
    v_add_f32 v76, v76, v77
    v_cvt_pk_bf16_f32 v96, v56, v58
    v_cvt_pk_bf16_f32 v97, v60, v62
    v_cvt_pk_bf16_f32 v98, v64, v66
    v_cvt_pk_bf16_f32 v99, v68, v70
    ds_write_b128 v203, v[96:99] offset:16
    v_cvt_pk_bf16_f32 v100, v58, v60
    v_cvt_pk_bf16_f32 v101, v62, v64
    v_cvt_pk_bf16_f32 v102, v66, v68
    v_cvt_pk_bf16_f32 v103, v70, v72
    ds_write_b128 v203, v[100:103] offset:4176
    v_cvt_pk_bf16_f32 v104, v60, v62
    v_cvt_pk_bf16_f32 v105, v64, v66
    v_cvt_pk_bf16_f32 v106, v68, v70
    v_cvt_pk_bf16_f32 v107, v72, v74
    ds_write_b128 v203, v[104:107] offset:8336
    v_cvt_pk_bf16_f32 v108, v62, v64
    v_cvt_pk_bf16_f32 v109, v66, v68
    v_cvt_pk_bf16_f32 v110, v70, v72
    v_cvt_pk_bf16_f32 v111, v74, v76
    ds_write_b128 v203, v[108:111] offset:12496
    s_mov_b64 exec, 1
    ds_add_u32 v207, v211 offset:96
    s_mov_b64 exec, -1
    s_add_u32 s24, s64, 6291456
    s_addc_u32 s25, s65, 0
    s_mov_b32 s26, 2097152
    s_mov_b32 s27, 0x20000
    s_mov_b32 s28, 0xffff0000
    v_lshlrev_b32 v209, 3, v2
    s_lshl_b32 s51, s17, 12
    s_add_u32 s51, s51, s53
    s_lshr_b32 s50, s19, 4
    s_lshl_b32 s50, s50, 8
    s_add_u32 s50, s50, 163840
    s_lshl_b32 s54, s3, 12
    s_add_u32 s54, s54, 83200
    v_lshl_add_u32 v205, v2, 4, s54
    s_xor_b32 s54, s3, 1
    s_lshl_b32 s54, s54, 12
    s_add_u32 s54, s54, 83200
    v_lshl_add_u32 v206, v2, 4, s54
    v_mov_b32 v210, 163200
    s_waitcnt lgkmcnt(0)
    s_mov_b32 s29, s47
    s_cmp_ge_u32 s2, 224
    s_cbranch_scc1 M_nocs
    s_waitcnt vmcnt(0)
    v_lshlrev_b32 v40, 16, v232
    v_and_b32 v41, s28, v232
    v_lshlrev_b32 v42, 16, v233
    v_and_b32 v43, s28, v233
    v_lshlrev_b32 v44, 16, v234
    v_and_b32 v45, s28, v234
    v_lshlrev_b32 v46, 16, v235
    v_and_b32 v47, s28, v235
    v_lshlrev_b32 v48, 16, v236
    v_and_b32 v49, s28, v236
    v_lshlrev_b32 v50, 16, v237
    v_and_b32 v51, s28, v237
    v_lshlrev_b32 v52, 16, v238
    v_and_b32 v53, s28, v238
    v_lshlrev_b32 v54, 16, v239
    v_and_b32 v55, s28, v239
    v_pk_add_f32 v[40:41], v[40:41], v[48:49]
    v_pk_add_f32 v[42:43], v[42:43], v[50:51]
    v_pk_add_f32 v[44:45], v[44:45], v[52:53]
    v_pk_add_f32 v[46:47], v[46:47], v[54:55]
    v_lshlrev_b32 v48, 16, v240
    v_and_b32 v49, s28, v240
    v_lshlrev_b32 v50, 16, v241
    v_and_b32 v51, s28, v241
    v_lshlrev_b32 v52, 16, v242
    v_and_b32 v53, s28, v242
    v_lshlrev_b32 v54, 16, v243
    v_and_b32 v55, s28, v243
    v_pk_add_f32 v[40:41], v[40:41], v[48:49]
    v_pk_add_f32 v[42:43], v[42:43], v[50:51]
    v_pk_add_f32 v[44:45], v[44:45], v[52:53]
    v_pk_add_f32 v[46:47], v[46:47], v[54:55]
    v_lshlrev_b32 v48, 16, v244
    v_and_b32 v49, s28, v244
    v_lshlrev_b32 v50, 16, v245
    v_and_b32 v51, s28, v245
    v_lshlrev_b32 v52, 16, v246
    v_and_b32 v53, s28, v246
    v_lshlrev_b32 v54, 16, v247
    v_and_b32 v55, s28, v247
    v_pk_add_f32 v[40:41], v[40:41], v[48:49]
    v_pk_add_f32 v[42:43], v[42:43], v[50:51]
    v_pk_add_f32 v[44:45], v[44:45], v[52:53]
    v_pk_add_f32 v[46:47], v[46:47], v[54:55]
    s_nop 0
    v_permlane32_swap_b32 v40, v44
    v_permlane32_swap_b32 v41, v45
    v_permlane32_swap_b32 v42, v46
    v_permlane32_swap_b32 v43, v47
    v_pk_add_f32 v[40:41], v[40:41], v[44:45]
    v_pk_add_f32 v[42:43], v[42:43], v[46:47]
    s_nop 1
    v_permlane16_swap_b32 v40, v42
    v_permlane16_swap_b32 v41, v43
    v_pk_add_f32 v[40:41], v[40:41], v[42:43]
    v_and_b32 v48, 3, v2
    v_lshlrev_b32 v48, 5, v48
    v_add_f32_dpp v40, v40, v40 row_ror:8 row_mask:0xf bank_mask:0xf
    v_add_f32_dpp v41, v41, v41 row_ror:8 row_mask:0xf bank_mask:0xf
    v_lshl_add_u32 v48, v9, 3, v48
    v_add_f32_dpp v40, v40, v40 row_ror:4 row_mask:0xf bank_mask:0xf
    v_add_f32_dpp v41, v41, v41 row_ror:4 row_mask:0xf bank_mask:0xf
    s_mov_b32 exec_lo, 0x000f000f
    s_mov_b32 exec_hi, 0x000f000f
    buffer_store_dwordx2 v[40:41], v48, s[40:43], s13 offen sc1
    s_mov_b64 exec, -1
M_nocs:
    s_and_b32 s61, s2, 3
    s_bfe_u32 s62, s2, 0x10002
    s_lshr_b32 s66, s2, 3
    s_and_b32 s12, s3, 3
    s_lshl_b32 s16, s61, 2
    s_and_b32 s54, s66, 3
    s_add_u32 s16, s16, s54
    s_mul_i32 s17, s62, 7
    s_lshr_b32 s54, s66, 2
    s_add_u32 s17, s17, s54
    s_lshl_b32 s52, s12, 11
    s_lshl_b32 s48, s16, 8
    s_lshl_b32 s49, s17, 8
    s_and_b32 s61, s2, 3
    s_bfe_u32 s62, s2, 0x10002
    s_lshl_b32 s18, s61, 3
    s_and_b32 s54, s66, 7
    s_add_u32 s18, s18, s54
    s_lshl_b32 s19, s62, 2
    s_lshr_b32 s54, s66, 3
    s_add_u32 s19, s19, s54
    s_lshl_b32 s50, s19, 7
    s_mov_b32 s68, 0
    s_add_u32 s36, s64, 9437184
    s_addc_u32 s37, s65, 0
    s_mov_b32 s38, 7340032
    s_mov_b32 s39, 0x20000
    s_add_u32 s40, s64, 8388608
    s_addc_u32 s41, s65, 0
    s_mov_b32 s42, 1048576
    s_mov_b32 s43, 0x20000
    s_mov_b32 s44, s10
    s_mov_b32 s45, s11
    s_mov_b32 s46, 2097152
    s_mov_b32 s47, 0x20000
    v_bfe_u32 v25, v2, 4, 1
    v_bfe_u32 v26, v2, 3, 1
    v_lshl_add_u32 v25, v25, 1, v26
    v_bfe_u32 v26, v2, 2, 1
    v_lshrrev_b32 v27, 5, v2
    v_and_b32 v28, 3, v2
    v_mul_u32_u24 v29, 2080, v25
    v_lshl_add_u32 v29, v26, 7, v29
    v_lshl_add_u32 v29, v28, 3, v29
    s_lshr_b32 s62, s12, 1
    s_and_b32 s61, s12, 1
    s_lshl_b32 s54, s61, 10
    v_lshl_add_u32 v13, v27, 8, v29
    v_add_u32 v13, s54, v13
    s_lshl_b32 s30, s61, 6
    s_xor_b32 s31, s30, 64
    s_lshl_b32 s54, s62, 6
    s_add_u32 s54, s54, 83200
    v_add_u32 v20, s54, v13
    s_mul_i32 s63, s62, -91520
    s_add_u32 s63, s63, 99840
    s_lshl_b32 s54, s61, 12
    s_add_u32 s58, s63, s54
    v_lshl_add_u32 v22, v2, 4, s58
    s_xor_b32 s54, s54, 4096
    s_add_u32 s58, s63, s54
    v_lshl_add_u32 v23, v2, 4, s58
    v_and_b32 v24, 15, v2
    v_lshlrev_b32 v24, 10, v24
    v_lshl_add_u32 v24, v27, 4, v24
    v_bfe_u32 v30, v2, 4, 1
    v_lshl_add_u32 v24, v30, 5, v24
    s_lshl_b32 s63, s18, 16
    s_lshl_b32 s54, s62, 15
    s_add_u32 s63, s63, s54
    s_add_u32 s63, s63, s50
    s_add_u32 s63, s63, s30
    s_bfe_u32 s59, s2, 0x10002
    s_mul_i32 s58, s59, 57344
    s_mul_i32 s60, s18, 229376
    s_sub_u32 s53, s60, s58
    s_add_u32 s60, s60, s58
    s_mul_i32 s54, s62, 114688
    s_lshl_b32 s58, s61, 11
    s_add_u32 s54, s54, s58
    v_lshl_add_u32 v21, v2, 4, s54
    s_lshl_b32 s54, s18, 1
    s_add_u32 s59, s59, s54
    s_lshl_b32 s59, s59, 8
    s_add_u32 s59, s59, 147456
    s_xor_b32 s55, s59, 256
    s_mov_b32 s67, s63
    v_lshlrev_b32 v3, 4, v2
    v_lshl_add_u32 v10, v27, 9, v29
    v_lshl_add_u32 v30, v25, 1, v27
    v_lshl_add_u32 v30, v30, 2, v26
    v_lshl_add_u32 v31, v25, 1, v26
    s_lshl_b32 s54, s12, 1
    v_xor_b32 v31, s54, v31
    v_lshlrev_b32 v4, 8, v30
    v_lshl_add_u32 v4, v31, 5, v4
    v_lshl_add_u32 v4, v28, 3, v4
    v_xor_b32 v7, 32, v4
    v_add_u32 v5, 58240, v4
    v_add_u32 v6, 116480, v4
    v_add_u32 v8, 58240, v7
    v_add_u32 v9, 116480, v7
    v_add_u32 v11, 58240, v10
    v_add_u32 v12, 116480, v10
    v_and_b32 v27, 48, v2
    v_add_u32 v27, 158080, v27
    v_and_b32 v26, 15, v2
    v_lshlrev_b32 v26, 3, v26
    v_mov_b32 v25, 1
    v_mov_b32 v28, 0
    s_lshl_b32 s54, s16, 2
    s_add_u32 s54, s54, s12
    s_lshl_b32 s56, s54, 8
    s_add_u32 s56, s56, 131072
    s_mul_i32 s57, s54, 112
    s_lshl_b32 s63, s17, 3
    s_add_u32 s57, s57, s63
    s_lshl_b32 s57, s57, 10
    s_andn2_b32 s58, s54, 1
    s_bfe_u32 s54, s2, 0x10002
    s_add_u32 s58, s58, s54
    s_lshl_b32 s58, s58, 8
    s_add_u32 s58, s58, 147456
M_pairK:
    ds_read_b32 v56, v207 offset:96
    s_add_u32 s68, s68, 1
    s_waitcnt lgkmcnt(0)
    v_cmp_ne_u32 vcc, 2, v56
    s_cmp_gt_u32 s68, 0x100000
    s_cbranch_scc1 M_pairK_x
    s_nop 3
    s_cbranch_vccnz M_pairK
M_pairK_x:
    ds_read_b64 v[64:65], v200 offset:4032
    ds_read_b64 v[66:67], v200 offset:4040
    ds_read_b64 v[68:69], v200 offset:3520
    ds_read_b64 v[70:71], v200 offset:3528
    ds_read_b64 v[72:73], v200 offset:3008
    ds_read_b64 v[74:75], v200 offset:3016
    ds_read_b64 v[76:77], v200 offset:2496
    ds_read_b64 v[78:79], v200 offset:2504
    ds_read_b64 v[80:81], v200 offset:1984
    ds_read_b64 v[82:83], v200 offset:1992
    ds_read_b64 v[84:85], v200 offset:1472
    ds_read_b64 v[86:87], v200 offset:1480
    ds_read_b64 v[88:89], v200 offset:960
    ds_read_b64 v[90:91], v200 offset:968
    ds_read_b64 v[92:93], v200 offset:448
    ds_read_b64 v[94:95], v200 offset:456
    ds_read_b64 v[128:129], v200 offset:3968
    ds_read_b64 v[130:131], v200 offset:3976
    ds_read_b64 v[132:133], v200 offset:3456
    ds_read_b64 v[134:135], v200 offset:3464
    ds_read_b64 v[136:137], v200 offset:2944
    ds_read_b64 v[138:139], v200 offset:2952
    ds_read_b64 v[140:141], v200 offset:2432
    ds_read_b64 v[142:143], v200 offset:2440
    ds_read_b64 v[144:145], v200 offset:1920
    ds_read_b64 v[146:147], v200 offset:1928
    ds_read_b64 v[148:149], v200 offset:1408
    ds_read_b64 v[150:151], v200 offset:1416
    ds_read_b64 v[152:153], v200 offset:896
    ds_read_b64 v[154:155], v200 offset:904
    ds_read_b64 v[156:157], v200 offset:384
    ds_read_b64 v[158:159], v200 offset:392
    s_branch M_cv
.p2align 12
M_cv:
HOP_0:
    s_cbranch_execz HOP_4
    s_waitcnt vmcnt(0) lgkmcnt(0)
    s_barrier
    ds_read_b128 v[96:99], v201 offset:480
    ds_read_b128 v[100:103], v201 offset:992
    ds_read_b128 v[104:107], v201 offset:1504
    ds_read_b128 v[108:111], v201 offset:2016
    ds_read_b128 v[112:115], v201 offset:2528
    ds_read_b128 v[116:119], v201 offset:3040
    ds_read_b128 v[120:123], v201 offset:3552
    ds_read_b128 v[124:127], v201 offset:4064
    s_cmp_ge_u32 s2, 224
    s_cbranch_scc1 M_nocs2
    s_mov_b64 exec, 1
    buffer_atomic_add v25, v28, s[40:43], s15 offen sc1
    s_mov_b64 exec, -1
M_nocs2:
    s_waitcnt lgkmcnt(7)
    v_mfma_f32_16x16x32_bf16 v[32:35], v[64:67], v[96:99], 0
    ds_read_b64 v[192:193], v202 offset:0
    v_mfma_f32_16x16x32_bf16 v[36:39], v[68:71], v[96:99], 0
    ds_read_b64 v[194:195], v231 offset:0
    v_mfma_f32_16x16x32_bf16 v[40:43], v[72:75], v[96:99], 0
    ds_read_b64 v[196:197], v202 offset:2048
    v_mfma_f32_16x16x32_bf16 v[44:47], v[76:79], v[96:99], 0
    ds_read_b64 v[198:199], v231 offset:2048
    v_mfma_f32_16x16x32_bf16 v[48:51], v[80:83], v[96:99], 0
    ds_read_b64 v[248:249], v202 offset:9344
    v_mfma_f32_16x16x32_bf16 v[52:55], v[84:87], v[96:99], 0
    ds_read_b64 v[250:251], v231 offset:9344
    v_mfma_f32_16x16x32_bf16 v[56:59], v[88:91], v[96:99], 0
    ds_read_b64 v[252:253], v202 offset:11392
    v_mfma_f32_16x16x32_bf16 v[60:63], v[92:95], v[96:99], 0
    ds_read_b64 v[254:255], v231 offset:11392
    s_waitcnt lgkmcnt(13)
    v_mfma_f32_16x16x32_bf16 v[36:39], v[64:67], v[100:103], v[36:39]
    ds_read_b128 v[160:163], v201 offset:416
    v_mfma_f32_16x16x32_bf16 v[40:43], v[68:71], v[100:103], v[40:43]
    ds_read_b128 v[164:167], v201 offset:928
    v_mfma_f32_16x16x32_bf16 v[44:47], v[72:75], v[100:103], v[44:47]
    ds_read_b128 v[168:171], v201 offset:1440
    v_mfma_f32_16x16x32_bf16 v[48:51], v[76:79], v[100:103], v[48:51]
    ds_read_b128 v[172:175], v201 offset:1952
    v_mfma_f32_16x16x32_bf16 v[52:55], v[80:83], v[100:103], v[52:55]
    ds_read_b128 v[176:179], v201 offset:2464
    v_mfma_f32_16x16x32_bf16 v[56:59], v[84:87], v[100:103], v[56:59]
    ds_read_b128 v[180:183], v201 offset:2976
    v_mfma_f32_16x16x32_bf16 v[60:63], v[88:91], v[100:103], v[60:63]
    ds_read_b128 v[184:187], v201 offset:3488
    s_waitcnt lgkmcnt(15)
    v_mfma_f32_16x16x32_bf16 v[40:43], v[64:67], v[104:107], v[40:43]
    ds_read_b128 v[188:191], v201 offset:4000
    v_mfma_f32_16x16x32_bf16 v[44:47], v[68:71], v[104:107], v[44:47]
    v_mfma_f32_16x16x32_bf16 v[48:51], v[72:75], v[104:107], v[48:51]
    v_mfma_f32_16x16x32_bf16 v[52:55], v[76:79], v[104:107], v[52:55]
    v_mfma_f32_16x16x32_bf16 v[56:59], v[80:83], v[104:107], v[56:59]
    v_mfma_f32_16x16x32_bf16 v[60:63], v[84:87], v[104:107], v[60:63]
    v_mfma_f32_16x16x32_bf16 v[44:47], v[64:67], v[108:111], v[44:47]
    s_waitcnt lgkmcnt(8)
    v_mfma_f32_16x16x32_bf16 v[48:51], v[68:71], v[108:111], v[48:51]
    v_lshlrev_b32 v212, 16, v192
    v_mfma_f32_16x16x32_bf16 v[52:55], v[72:75], v[108:111], v[52:55]
    v_and_b32 v213, s28, v192
    v_mfma_f32_16x16x32_bf16 v[56:59], v[76:79], v[108:111], v[56:59]
    v_lshlrev_b32 v214, 16, v193
    v_mfma_f32_16x16x32_bf16 v[60:63], v[80:83], v[108:111], v[60:63]
    v_and_b32 v215, s28, v193
    v_mfma_f32_16x16x32_bf16 v[48:51], v[64:67], v[112:115], v[48:51]
    v_lshlrev_b32 v216, 16, v194
    v_mfma_f32_16x16x32_bf16 v[52:55], v[68:71], v[112:115], v[52:55]
    v_and_b32 v217, s28, v194
    v_mfma_f32_16x16x32_bf16 v[56:59], v[72:75], v[112:115], v[56:59]
    v_lshlrev_b32 v218, 16, v195
    v_mfma_f32_16x16x32_bf16 v[60:63], v[76:79], v[112:115], v[60:63]
    v_and_b32 v219, s28, v195
    v_mfma_f32_16x16x32_bf16 v[52:55], v[64:67], v[116:119], v[52:55]
    v_lshlrev_b32 v220, 16, v196
    v_mfma_f32_16x16x32_bf16 v[56:59], v[68:71], v[116:119], v[56:59]
    v_and_b32 v221, s28, v196
    v_mfma_f32_16x16x32_bf16 v[60:63], v[72:75], v[116:119], v[60:63]
    v_lshlrev_b32 v222, 16, v197
    v_mfma_f32_16x16x32_bf16 v[56:59], v[64:67], v[120:123], v[56:59]
    v_and_b32 v223, s28, v197
    v_mfma_f32_16x16x32_bf16 v[60:63], v[68:71], v[120:123], v[60:63]
    v_lshlrev_b32 v224, 16, v198
    v_mfma_f32_16x16x32_bf16 v[60:63], v[64:67], v[124:127], v[60:63]
    v_and_b32 v225, s28, v198
    s_waitcnt lgkmcnt(0)
    v_mfma_f32_16x16x32_bf16 v[32:35], v[128:131], v[160:163], v[32:35]
    v_lshlrev_b32 v226, 16, v199
    v_mfma_f32_16x16x32_bf16 v[36:39], v[132:135], v[160:163], v[36:39]
    v_and_b32 v227, s28, v199
    v_mfma_f32_16x16x32_bf16 v[40:43], v[136:139], v[160:163], v[40:43]
    ds_read_b64 v[64:65], v200 offset:3904
    v_mfma_f32_16x16x32_bf16 v[44:47], v[140:143], v[160:163], v[44:47]
    ds_read_b64 v[66:67], v200 offset:3912
    v_mfma_f32_16x16x32_bf16 v[48:51], v[144:147], v[160:163], v[48:51]
    ds_read_b64 v[68:69], v200 offset:3392
    v_mfma_f32_16x16x32_bf16 v[52:55], v[148:151], v[160:163], v[52:55]
    ds_read_b64 v[70:71], v200 offset:3400
    v_mfma_f32_16x16x32_bf16 v[56:59], v[152:155], v[160:163], v[56:59]
    ds_read_b64 v[72:73], v200 offset:2880
    v_mfma_f32_16x16x32_bf16 v[60:63], v[156:159], v[160:163], v[60:63]
    ds_read_b64 v[74:75], v200 offset:2888
    v_mfma_f32_16x16x32_bf16 v[36:39], v[128:131], v[164:167], v[36:39]
    ds_read_b64 v[76:77], v200 offset:2368
    v_mfma_f32_16x16x32_bf16 v[40:43], v[132:135], v[164:167], v[40:43]
    ds_read_b64 v[78:79], v200 offset:2376
    v_mfma_f32_16x16x32_bf16 v[44:47], v[136:139], v[164:167], v[44:47]
    ds_read_b64 v[80:81], v200 offset:1856
    v_mfma_f32_16x16x32_bf16 v[48:51], v[140:143], v[164:167], v[48:51]
    ds_read_b64 v[82:83], v200 offset:1864
    v_mfma_f32_16x16x32_bf16 v[52:55], v[144:147], v[164:167], v[52:55]
    ds_read_b64 v[84:85], v200 offset:1344
    v_mfma_f32_16x16x32_bf16 v[56:59], v[148:151], v[164:167], v[56:59]
    ds_read_b64 v[86:87], v200 offset:1352
    v_mfma_f32_16x16x32_bf16 v[60:63], v[152:155], v[164:167], v[60:63]
    ds_read_b64 v[88:89], v200 offset:832
    v_mfma_f32_16x16x32_bf16 v[40:43], v[128:131], v[168:171], v[40:43]
    ds_read_b64 v[90:91], v200 offset:840
    v_mfma_f32_16x16x32_bf16 v[44:47], v[132:135], v[168:171], v[44:47]
    ds_read_b64 v[92:93], v200 offset:320
    v_mfma_f32_16x16x32_bf16 v[48:51], v[136:139], v[168:171], v[48:51]
    ds_read_b64 v[94:95], v200 offset:328
    v_mfma_f32_16x16x32_bf16 v[52:55], v[140:143], v[168:171], v[52:55]
    ds_read_b128 v[96:99], v201 offset:352
    v_mfma_f32_16x16x32_bf16 v[56:59], v[144:147], v[168:171], v[56:59]
    ds_read_b128 v[100:103], v201 offset:864
    v_mfma_f32_16x16x32_bf16 v[60:63], v[148:151], v[168:171], v[60:63]
    ds_read_b128 v[104:107], v201 offset:1376
    v_mfma_f32_16x16x32_bf16 v[44:47], v[128:131], v[172:175], v[44:47]
    ds_read_b128 v[108:111], v201 offset:1888
    v_mfma_f32_16x16x32_bf16 v[48:51], v[132:135], v[172:175], v[48:51]
    ds_read_b128 v[112:115], v201 offset:2400
    v_mfma_f32_16x16x32_bf16 v[52:55], v[136:139], v[172:175], v[52:55]
    ds_read_b128 v[116:119], v201 offset:2912
    v_mfma_f32_16x16x32_bf16 v[56:59], v[140:143], v[172:175], v[56:59]
    ds_read_b128 v[120:123], v201 offset:3424
    v_mfma_f32_16x16x32_bf16 v[60:63], v[144:147], v[172:175], v[60:63]
    ds_read_b128 v[124:127], v201 offset:3936
    v_mfma_f32_16x16x32_bf16 v[48:51], v[128:131], v[176:179], v[48:51]
    v_mul_f32 v212, v212, v208
    v_mfma_f32_16x16x32_bf16 v[52:55], v[132:135], v[176:179], v[52:55]
    v_mul_f32 v213, v213, v208
    v_mfma_f32_16x16x32_bf16 v[56:59], v[136:139], v[176:179], v[56:59]
    v_mul_f32 v214, v214, v208
    v_mfma_f32_16x16x32_bf16 v[60:63], v[140:143], v[176:179], v[60:63]
    v_mul_f32 v215, v215, v208
    v_mfma_f32_16x16x32_bf16 v[52:55], v[128:131], v[180:183], v[52:55]
    v_mul_f32 v216, v216, v208
    v_mfma_f32_16x16x32_bf16 v[56:59], v[132:135], v[180:183], v[56:59]
    v_mul_f32 v217, v217, v208
    v_mfma_f32_16x16x32_bf16 v[60:63], v[136:139], v[180:183], v[60:63]
    v_mul_f32 v218, v218, v208
    v_mfma_f32_16x16x32_bf16 v[56:59], v[128:131], v[184:187], v[56:59]
    v_mul_f32 v219, v219, v208
    v_mfma_f32_16x16x32_bf16 v[60:63], v[132:135], v[184:187], v[60:63]
    v_mul_f32 v220, v220, v208
    v_mfma_f32_16x16x32_bf16 v[60:63], v[128:131], v[188:191], v[60:63]
    v_mul_f32 v221, v221, v208
    s_waitcnt lgkmcnt(0)
    v_mfma_f32_16x16x32_bf16 v[32:35], v[64:67], v[96:99], v[32:35]
    v_mul_f32 v222, v222, v208
    v_mfma_f32_16x16x32_bf16 v[36:39], v[68:71], v[96:99], v[36:39]
    v_mul_f32 v223, v223, v208
    v_mfma_f32_16x16x32_bf16 v[40:43], v[72:75], v[96:99], v[40:43]
    ds_read_b64 v[128:129], v200 offset:3840
    v_mfma_f32_16x16x32_bf16 v[44:47], v[76:79], v[96:99], v[44:47]
    ds_read_b64 v[130:131], v200 offset:3848
    v_mfma_f32_16x16x32_bf16 v[48:51], v[80:83], v[96:99], v[48:51]
    ds_read_b64 v[132:133], v200 offset:3328
    v_mfma_f32_16x16x32_bf16 v[52:55], v[84:87], v[96:99], v[52:55]
    ds_read_b64 v[134:135], v200 offset:3336
    v_mfma_f32_16x16x32_bf16 v[56:59], v[88:91], v[96:99], v[56:59]
    ds_read_b64 v[136:137], v200 offset:2816
    v_mfma_f32_16x16x32_bf16 v[60:63], v[92:95], v[96:99], v[60:63]
    ds_read_b64 v[138:139], v200 offset:2824
    v_mfma_f32_16x16x32_bf16 v[36:39], v[64:67], v[100:103], v[36:39]
    ds_read_b64 v[140:141], v200 offset:2304
    v_mfma_f32_16x16x32_bf16 v[40:43], v[68:71], v[100:103], v[40:43]
    ds_read_b64 v[142:143], v200 offset:2312
    v_mfma_f32_16x16x32_bf16 v[44:47], v[72:75], v[100:103], v[44:47]
    ds_read_b64 v[144:145], v200 offset:1792
    v_mfma_f32_16x16x32_bf16 v[48:51], v[76:79], v[100:103], v[48:51]
    ds_read_b64 v[146:147], v200 offset:1800
    v_mfma_f32_16x16x32_bf16 v[52:55], v[80:83], v[100:103], v[52:55]
    ds_read_b64 v[148:149], v200 offset:1280
    v_mfma_f32_16x16x32_bf16 v[56:59], v[84:87], v[100:103], v[56:59]
    ds_read_b64 v[150:151], v200 offset:1288
    v_mfma_f32_16x16x32_bf16 v[60:63], v[88:91], v[100:103], v[60:63]
    ds_read_b64 v[152:153], v200 offset:768
    v_mfma_f32_16x16x32_bf16 v[40:43], v[64:67], v[104:107], v[40:43]
    ds_read_b64 v[154:155], v200 offset:776
    v_mfma_f32_16x16x32_bf16 v[44:47], v[68:71], v[104:107], v[44:47]
    ds_read_b64 v[156:157], v200 offset:256
    v_mfma_f32_16x16x32_bf16 v[48:51], v[72:75], v[104:107], v[48:51]
    ds_read_b64 v[158:159], v200 offset:264
    v_mfma_f32_16x16x32_bf16 v[52:55], v[76:79], v[104:107], v[52:55]
    ds_read_b128 v[160:163], v201 offset:288
    v_mfma_f32_16x16x32_bf16 v[56:59], v[80:83], v[104:107], v[56:59]
    ds_read_b128 v[164:167], v201 offset:800
    v_mfma_f32_16x16x32_bf16 v[60:63], v[84:87], v[104:107], v[60:63]
    ds_read_b128 v[168:171], v201 offset:1312
    v_mfma_f32_16x16x32_bf16 v[44:47], v[64:67], v[108:111], v[44:47]
    ds_read_b128 v[172:175], v201 offset:1824
    v_mfma_f32_16x16x32_bf16 v[48:51], v[68:71], v[108:111], v[48:51]
    ds_read_b128 v[176:179], v201 offset:2336
    v_mfma_f32_16x16x32_bf16 v[52:55], v[72:75], v[108:111], v[52:55]
    ds_read_b128 v[180:183], v201 offset:2848
    v_mfma_f32_16x16x32_bf16 v[56:59], v[76:79], v[108:111], v[56:59]
    ds_read_b128 v[184:187], v201 offset:3360
    v_mfma_f32_16x16x32_bf16 v[60:63], v[80:83], v[108:111], v[60:63]
    ds_read_b128 v[188:191], v201 offset:3872
    v_mfma_f32_16x16x32_bf16 v[48:51], v[64:67], v[112:115], v[48:51]
    v_mul_f32 v224, v224, v208
    v_mfma_f32_16x16x32_bf16 v[52:55], v[68:71], v[112:115], v[52:55]
    v_mul_f32 v225, v225, v208
    v_mfma_f32_16x16x32_bf16 v[56:59], v[72:75], v[112:115], v[56:59]
    v_mul_f32 v226, v226, v208
    v_mfma_f32_16x16x32_bf16 v[60:63], v[76:79], v[112:115], v[60:63]
    v_mul_f32 v227, v227, v208
    v_mfma_f32_16x16x32_bf16 v[52:55], v[64:67], v[116:119], v[52:55]
    v_cvt_pk_bf16_f32 v192, v212, v213
    v_mfma_f32_16x16x32_bf16 v[56:59], v[68:71], v[116:119], v[56:59]
    v_cvt_pk_bf16_f32 v193, v214, v215
    v_mfma_f32_16x16x32_bf16 v[60:63], v[72:75], v[116:119], v[60:63]
    v_cvt_pk_bf16_f32 v194, v216, v217
    v_mfma_f32_16x16x32_bf16 v[56:59], v[64:67], v[120:123], v[56:59]
    v_cvt_pk_bf16_f32 v195, v218, v219
    v_mfma_f32_16x16x32_bf16 v[60:63], v[68:71], v[120:123], v[60:63]
    v_cvt_pk_bf16_f32 v196, v220, v221
    v_mfma_f32_16x16x32_bf16 v[60:63], v[64:67], v[124:127], v[60:63]
    v_cvt_pk_bf16_f32 v197, v222, v223
    s_waitcnt lgkmcnt(0)
    s_cmp_eq_u32 s29, 0
    s_cbranch_scc0 M_w1
    v_mfma_f32_16x16x32_bf16 v[36:39], v[128:131], v[164:167], v[36:39]
    v_cvt_pk_bf16_f32 v198, v224, v225
    v_cvt_pk_bf16_f32 v199, v226, v227
    v_mfma_f32_16x16x32_bf16 v[36:39], v[132:135], v[160:163], v[36:39]
    v_lshlrev_b32 v232, 16, v248
    v_mfma_f32_16x16x32_bf16 v[40:43], v[128:131], v[168:171], v[40:43]
    v_and_b32 v233, s28, v248
    v_mfma_f32_16x16x32_bf16 v[40:43], v[132:135], v[164:167], v[40:43]
    v_lshlrev_b32 v234, 16, v249
    v_and_b32 v235, s28, v249
    v_mfma_f32_16x16x32_bf16 v[40:43], v[136:139], v[160:163], v[40:43]
    v_lshlrev_b32 v236, 16, v250
    v_mfma_f32_16x16x32_bf16 v[52:55], v[128:131], v[180:183], v[52:55]
    ds_write_b128 v205, v[36:39] offset:0
    v_mfma_f32_16x16x32_bf16 v[52:55], v[132:135], v[176:179], v[52:55]
    v_and_b32 v237, s28, v250
    v_lshlrev_b32 v238, 16, v251
    v_mfma_f32_16x16x32_bf16 v[52:55], v[136:139], v[172:175], v[52:55]
    v_and_b32 v239, s28, v251
    v_mfma_f32_16x16x32_bf16 v[52:55], v[140:143], v[168:171], v[52:55]
    v_lshlrev_b32 v240, 16, v252
    v_mfma_f32_16x16x32_bf16 v[52:55], v[144:147], v[164:167], v[52:55]
    ds_write_b128 v205, v[40:43] offset:1024
    v_mfma_f32_16x16x32_bf16 v[52:55], v[148:151], v[160:163], v[52:55]
    v_and_b32 v241, s28, v252
    v_mfma_f32_16x16x32_bf16 v[56:59], v[128:131], v[184:187], v[56:59]
    v_lshlrev_b32 v242, 16, v253
    v_mfma_f32_16x16x32_bf16 v[56:59], v[132:135], v[180:183], v[56:59]
    v_and_b32 v243, s28, v253
    v_lshlrev_b32 v244, 16, v254
    v_mfma_f32_16x16x32_bf16 v[56:59], v[136:139], v[176:179], v[56:59]
    v_and_b32 v245, s28, v254
    v_mfma_f32_16x16x32_bf16 v[56:59], v[140:143], v[172:175], v[56:59]
    ds_write_b128 v205, v[52:55] offset:2048
    v_mfma_f32_16x16x32_bf16 v[56:59], v[144:147], v[168:171], v[56:59]
    v_lshlrev_b32 v246, 16, v255
    v_and_b32 v247, s28, v255
    v_mfma_f32_16x16x32_bf16 v[56:59], v[148:151], v[164:167], v[56:59]
    v_lshlrev_b32 v212, 16, v192
    v_mfma_f32_16x16x32_bf16 v[56:59], v[152:155], v[160:163], v[56:59]
    v_and_b32 v213, s28, v192
    v_mfma_f32_16x16x32_bf16 v[64:67], v[128:131], v[160:163], v[32:35]
    v_lshlrev_b32 v214, 16, v193
    v_and_b32 v215, s28, v193
    v_mfma_f32_16x16x32_bf16 v[68:71], v[140:143], v[160:163], v[44:47]
    v_lshlrev_b32 v216, 16, v194
    v_mfma_f32_16x16x32_bf16 v[72:75], v[144:147], v[160:163], v[48:51]
    v_and_b32 v217, s28, v194
    v_mfma_f32_16x16x32_bf16 v[76:79], v[156:159], v[160:163], v[60:63]
    ds_write_b128 v205, v[56:59] offset:3072
    v_mfma_f32_16x16x32_bf16 v[68:71], v[136:139], v[164:167], v[68:71]
    s_mov_b64 exec, 1
    ds_add_u32 v207, v211 offset:72
    s_mov_b64 exec, -1
    v_mfma_f32_16x16x32_bf16 v[72:75], v[140:143], v[164:167], v[72:75]
    v_lshlrev_b32 v218, 16, v195
    v_mfma_f32_16x16x32_bf16 v[76:79], v[152:155], v[164:167], v[76:79]
    v_and_b32 v219, s28, v195
    v_lshlrev_b32 v220, 16, v196
    v_mfma_f32_16x16x32_bf16 v[68:71], v[132:135], v[168:171], v[68:71]
    v_and_b32 v221, s28, v196
    v_mfma_f32_16x16x32_bf16 v[72:75], v[136:139], v[168:171], v[72:75]
    v_lshlrev_b32 v222, 16, v197
    v_mfma_f32_16x16x32_bf16 v[76:79], v[148:151], v[168:171], v[76:79]
    v_and_b32 v223, s28, v197
    v_lshlrev_b32 v224, 16, v198
    v_mfma_f32_16x16x32_bf16 v[68:71], v[128:131], v[172:175], v[68:71]
    v_and_b32 v225, s28, v198
    v_mfma_f32_16x16x32_bf16 v[72:75], v[132:135], v[172:175], v[72:75]
    v_lshlrev_b32 v226, 16, v199
    v_mfma_f32_16x16x32_bf16 v[76:79], v[144:147], v[172:175], v[76:79]
    v_and_b32 v227, s28, v199
    v_mfma_f32_16x16x32_bf16 v[72:75], v[128:131], v[176:179], v[72:75]
    ds_read_b32 v120, v207 offset:72
    v_mfma_f32_16x16x32_bf16 v[76:79], v[140:143], v[176:179], v[76:79]
    ds_read_b128 v[80:83], v206 offset:0
    v_mfma_f32_16x16x32_bf16 v[76:79], v[136:139], v[180:183], v[76:79]
    ds_read_b128 v[84:87], v206 offset:1024
    v_mfma_f32_16x16x32_bf16 v[76:79], v[132:135], v[184:187], v[76:79]
    ds_read_b128 v[88:91], v206 offset:2048
    v_mfma_f32_16x16x32_bf16 v[76:79], v[128:131], v[188:191], v[76:79]
    ds_read_b128 v[92:95], v206 offset:3072
    s_branch M_w2
M_w1:
HOP_1:
    s_cbranch_execz HOP_5
    v_mfma_f32_16x16x32_bf16 v[32:35], v[128:131], v[160:163], v[32:35]
    v_cvt_pk_bf16_f32 v198, v224, v225
    v_cvt_pk_bf16_f32 v199, v226, v227
    v_mfma_f32_16x16x32_bf16 v[44:47], v[128:131], v[172:175], v[44:47]
    v_lshlrev_b32 v232, 16, v248
    v_mfma_f32_16x16x32_bf16 v[44:47], v[132:135], v[168:171], v[44:47]
    v_and_b32 v233, s28, v248
    v_mfma_f32_16x16x32_bf16 v[44:47], v[136:139], v[164:167], v[44:47]
    v_lshlrev_b32 v234, 16, v249
    v_and_b32 v235, s28, v249
    v_mfma_f32_16x16x32_bf16 v[44:47], v[140:143], v[160:163], v[44:47]
    ds_write_b128 v205, v[32:35] offset:0
    v_mfma_f32_16x16x32_bf16 v[48:51], v[128:131], v[176:179], v[48:51]
    v_lshlrev_b32 v236, 16, v250
    v_mfma_f32_16x16x32_bf16 v[48:51], v[132:135], v[172:175], v[48:51]
    v_and_b32 v237, s28, v250
    v_lshlrev_b32 v238, 16, v251
    v_mfma_f32_16x16x32_bf16 v[48:51], v[136:139], v[168:171], v[48:51]
    v_and_b32 v239, s28, v251
    v_mfma_f32_16x16x32_bf16 v[48:51], v[140:143], v[164:167], v[48:51]
    ds_write_b128 v205, v[44:47] offset:1024
    v_mfma_f32_16x16x32_bf16 v[48:51], v[144:147], v[160:163], v[48:51]
    v_lshlrev_b32 v240, 16, v252
    v_and_b32 v241, s28, v252
    v_mfma_f32_16x16x32_bf16 v[60:63], v[128:131], v[188:191], v[60:63]
    v_lshlrev_b32 v242, 16, v253
    v_mfma_f32_16x16x32_bf16 v[60:63], v[132:135], v[184:187], v[60:63]
    v_and_b32 v243, s28, v253
    v_mfma_f32_16x16x32_bf16 v[60:63], v[136:139], v[180:183], v[60:63]
    v_lshlrev_b32 v244, 16, v254
    v_and_b32 v245, s28, v254
    v_mfma_f32_16x16x32_bf16 v[60:63], v[140:143], v[176:179], v[60:63]
    ds_write_b128 v205, v[48:51] offset:2048
    v_mfma_f32_16x16x32_bf16 v[60:63], v[144:147], v[172:175], v[60:63]
    v_lshlrev_b32 v246, 16, v255
    v_mfma_f32_16x16x32_bf16 v[60:63], v[148:151], v[168:171], v[60:63]
    v_and_b32 v247, s28, v255
    v_lshlrev_b32 v212, 16, v192
    v_mfma_f32_16x16x32_bf16 v[60:63], v[152:155], v[164:167], v[60:63]
    v_and_b32 v213, s28, v192
    v_mfma_f32_16x16x32_bf16 v[60:63], v[156:159], v[160:163], v[60:63]
    v_lshlrev_b32 v214, 16, v193
    v_mfma_f32_16x16x32_bf16 v[64:67], v[132:135], v[160:163], v[36:39]
    v_and_b32 v215, s28, v193
    v_lshlrev_b32 v216, 16, v194
    v_mfma_f32_16x16x32_bf16 v[68:71], v[136:139], v[160:163], v[40:43]
    v_and_b32 v217, s28, v194
    v_mfma_f32_16x16x32_bf16 v[72:75], v[148:151], v[160:163], v[52:55]
    v_lshlrev_b32 v218, 16, v195
    v_mfma_f32_16x16x32_bf16 v[76:79], v[152:155], v[160:163], v[56:59]
    ds_write_b128 v205, v[60:63] offset:3072
    v_mfma_f32_16x16x32_bf16 v[64:67], v[128:131], v[164:167], v[64:67]
    s_mov_b64 exec, 1
    ds_add_u32 v207, v211 offset:72
    s_mov_b64 exec, -1
    v_mfma_f32_16x16x32_bf16 v[68:71], v[132:135], v[164:167], v[68:71]
    v_and_b32 v219, s28, v195
    v_mfma_f32_16x16x32_bf16 v[72:75], v[144:147], v[164:167], v[72:75]
    v_lshlrev_b32 v220, 16, v196
    v_and_b32 v221, s28, v196
    v_mfma_f32_16x16x32_bf16 v[76:79], v[148:151], v[164:167], v[76:79]
    v_lshlrev_b32 v222, 16, v197
    v_mfma_f32_16x16x32_bf16 v[68:71], v[128:131], v[168:171], v[68:71]
    v_and_b32 v223, s28, v197
    v_mfma_f32_16x16x32_bf16 v[72:75], v[140:143], v[168:171], v[72:75]
    v_lshlrev_b32 v224, 16, v198
    v_and_b32 v225, s28, v198
    v_mfma_f32_16x16x32_bf16 v[76:79], v[144:147], v[168:171], v[76:79]
    v_lshlrev_b32 v226, 16, v199
    v_mfma_f32_16x16x32_bf16 v[72:75], v[136:139], v[172:175], v[72:75]
    v_and_b32 v227, s28, v199
    v_mfma_f32_16x16x32_bf16 v[76:79], v[140:143], v[172:175], v[76:79]
    v_mfma_f32_16x16x32_bf16 v[72:75], v[132:135], v[176:179], v[72:75]
    ds_read_b32 v120, v207 offset:72
    v_mfma_f32_16x16x32_bf16 v[76:79], v[136:139], v[176:179], v[76:79]
    ds_read_b128 v[80:83], v206 offset:0
    v_mfma_f32_16x16x32_bf16 v[72:75], v[128:131], v[180:183], v[72:75]
    ds_read_b128 v[84:87], v206 offset:1024
    v_mfma_f32_16x16x32_bf16 v[76:79], v[132:135], v[180:183], v[76:79]
    ds_read_b128 v[88:91], v206 offset:2048
    v_mfma_f32_16x16x32_bf16 v[76:79], v[128:131], v[184:187], v[76:79]
    ds_read_b128 v[92:95], v206 offset:3072
M_w2:
    s_waitcnt lgkmcnt(0)
    v_cmp_ne_u32 vcc, 2, v120
    s_nop 4
    s_cbranch_vccz M_pair_x
M_pair:
    ds_read_b32 v120, v207 offset:72
    ds_read_b128 v[80:83], v206 offset:0
    ds_read_b128 v[84:87], v206 offset:1024
    ds_read_b128 v[88:91], v206 offset:2048
    ds_read_b128 v[92:95], v206 offset:3072
    s_add_u32 s68, s68, 1
    s_waitcnt lgkmcnt(0)
    v_cmp_ne_u32 vcc, 2, v120
    s_cmp_gt_u32 s68, 0x100000
    s_cbranch_scc1 M_pair_x
    s_nop 3
    s_cbranch_vccnz M_pair
M_pair_x:
    v_pk_add_f32 v[64:65], v[64:65], v[80:81]
    v_pk_add_f32 v[66:67], v[66:67], v[82:83]
    v_pk_add_f32 v[68:69], v[68:69], v[84:85]
    v_pk_add_f32 v[70:71], v[70:71], v[86:87]
    v_cvt_pk_bf16_f32 v96, v64, v65
    v_cvt_pk_bf16_f32 v97, v66, v67
    v_cvt_pk_bf16_f32 v98, v68, v69
    v_cvt_pk_bf16_f32 v99, v70, v71
    v_lshlrev_b32 v64, 16, v96
    v_and_b32 v65, s28, v96
    v_lshlrev_b32 v66, 16, v97
    v_and_b32 v67, s28, v97
    v_lshlrev_b32 v68, 16, v98
    v_and_b32 v69, s28, v98
    v_lshlrev_b32 v70, 16, v99
    v_and_b32 v71, s28, v99
    v_pk_add_f32 v[64:65], v[64:65], v[212:213]
    v_pk_add_f32 v[66:67], v[66:67], v[214:215]
    v_pk_add_f32 v[68:69], v[68:69], v[216:217]
    v_pk_add_f32 v[70:71], v[70:71], v[218:219]
    v_cvt_pk_bf16_f32 v96, v64, v65
    v_cvt_pk_bf16_f32 v97, v66, v67
    v_cvt_pk_bf16_f32 v98, v68, v69
    v_cvt_pk_bf16_f32 v99, v70, v71
    v_lshlrev_b32 v64, 16, v96
    v_and_b32 v65, s28, v96
    v_lshlrev_b32 v66, 16, v97
    v_and_b32 v67, s28, v97
    v_lshlrev_b32 v68, 16, v98
    v_and_b32 v69, s28, v98
    v_lshlrev_b32 v70, 16, v99
    v_and_b32 v71, s28, v99
    v_pk_add_f32 v[64:65], v[64:65], v[232:233]
    v_pk_add_f32 v[66:67], v[66:67], v[234:235]
    v_pk_add_f32 v[68:69], v[68:69], v[236:237]
    v_pk_add_f32 v[70:71], v[70:71], v[238:239]
    v_cvt_pk_bf16_f32 v100, v64, v65
    v_cvt_pk_bf16_f32 v101, v66, v67
    v_cvt_pk_bf16_f32 v102, v68, v69
    v_cvt_pk_bf16_f32 v103, v70, v71
    v_min_u32 v100, -2, v100
    v_min_u32 v101, -2, v101
    v_min_u32 v102, -2, v102
    v_min_u32 v103, -2, v103
    s_nop 0
    v_permlane16_swap_b32 v100, v102
    v_permlane16_swap_b32 v101, v103
    buffer_store_dwordx4 v[100:103], v204, s[24:27], s51 offen offset:0 sc1
    v_pk_add_f32 v[72:73], v[72:73], v[88:89]
    v_pk_add_f32 v[74:75], v[74:75], v[90:91]
    v_pk_add_f32 v[76:77], v[76:77], v[92:93]
    v_pk_add_f32 v[78:79], v[78:79], v[94:95]
    v_cvt_pk_bf16_f32 v96, v72, v73
    v_cvt_pk_bf16_f32 v97, v74, v75
    v_cvt_pk_bf16_f32 v98, v76, v77
    v_cvt_pk_bf16_f32 v99, v78, v79
    v_lshlrev_b32 v72, 16, v96
    v_and_b32 v73, s28, v96
    v_lshlrev_b32 v74, 16, v97
    v_and_b32 v75, s28, v97
    v_lshlrev_b32 v76, 16, v98
    v_and_b32 v77, s28, v98
    v_lshlrev_b32 v78, 16, v99
    v_and_b32 v79, s28, v99
    v_pk_add_f32 v[72:73], v[72:73], v[220:221]
    v_pk_add_f32 v[74:75], v[74:75], v[222:223]
    v_pk_add_f32 v[76:77], v[76:77], v[224:225]
    v_pk_add_f32 v[78:79], v[78:79], v[226:227]
    v_cvt_pk_bf16_f32 v96, v72, v73
    v_cvt_pk_bf16_f32 v97, v74, v75
    v_cvt_pk_bf16_f32 v98, v76, v77
    v_cvt_pk_bf16_f32 v99, v78, v79
    v_lshlrev_b32 v72, 16, v96
    v_and_b32 v73, s28, v96
    v_lshlrev_b32 v74, 16, v97
    v_and_b32 v75, s28, v97
    v_lshlrev_b32 v76, 16, v98
    v_and_b32 v77, s28, v98
    v_lshlrev_b32 v78, 16, v99
    v_and_b32 v79, s28, v99
    v_pk_add_f32 v[72:73], v[72:73], v[240:241]
    v_pk_add_f32 v[74:75], v[74:75], v[242:243]
    v_pk_add_f32 v[76:77], v[76:77], v[244:245]
    v_pk_add_f32 v[78:79], v[78:79], v[246:247]
    v_cvt_pk_bf16_f32 v104, v72, v73
    v_cvt_pk_bf16_f32 v105, v74, v75
    v_cvt_pk_bf16_f32 v106, v76, v77
    v_cvt_pk_bf16_f32 v107, v78, v79
    v_min_u32 v104, -2, v104
    v_min_u32 v105, -2, v105
    v_min_u32 v106, -2, v106
    v_min_u32 v107, -2, v107
    s_nop 0
    v_permlane16_swap_b32 v104, v106
    v_permlane16_swap_b32 v105, v107
    buffer_store_dwordx4 v[104:107], v204, s[24:27], s51 offen offset:2048 sc1
    s_waitcnt vmcnt(0)
    s_barrier
    s_branch M_C2
M_L2:
HOP_2:
    s_cbranch_execz HOP_6
    s_cmp_ge_u32 s66, 28
    s_cbranch_scc1 M_hop
    s_add_u32 m0, s53, 0
    s_add_u32 s54, s49, 0
    buffer_load_dwordx4 v12, s[24:27], s54 offen lds
    s_add_u32 m0, s53, 1024
    s_nop 0
    buffer_load_dwordx4 v12, s[28:31], s54 offen lds
    s_add_u32 m0, s53, 8320
    s_add_u32 s54, s49, 114688
    buffer_load_dwordx4 v12, s[24:27], s54 offen lds
    s_add_u32 m0, s53, 9344
    s_nop 0
    buffer_load_dwordx4 v12, s[28:31], s54 offen lds
    s_add_u32 m0, s53, 16640
    s_add_u32 s54, s49, 229376
    buffer_load_dwordx4 v12, s[24:27], s54 offen lds
    s_add_u32 m0, s53, 17664
    s_nop 0
    buffer_load_dwordx4 v12, s[28:31], s54 offen lds
    s_add_u32 m0, s53, 24960
    s_add_u32 s54, s49, 344064
    buffer_load_dwordx4 v12, s[24:27], s54 offen lds
    s_add_u32 m0, s53, 25984
    s_nop 0
    buffer_load_dwordx4 v12, s[28:31], s54 offen lds
    s_add_u32 m0, s53, 33280
    s_add_u32 s54, s49, 458752
    buffer_load_dwordx4 v12, s[24:27], s54 offen lds
    s_add_u32 m0, s53, 34304
    s_nop 0
    buffer_load_dwordx4 v12, s[28:31], s54 offen lds
    s_add_u32 m0, s53, 41600
    s_add_u32 s54, s49, 573440
    buffer_load_dwordx4 v12, s[24:27], s54 offen lds
    s_add_u32 m0, s53, 42624
    s_nop 0
    buffer_load_dwordx4 v12, s[28:31], s54 offen lds
    buffer_store_dwordx4 v[32:35], v85, s[36:39], s15 offen offset:0 sc1
    s_add_u32 m0, s53, 49920
    s_add_u32 s54, s49, 688128
    buffer_load_dwordx4 v12, s[24:27], s54 offen lds
    s_add_u32 m0, s53, 50944
    s_nop 0
    buffer_load_dwordx4 v12, s[28:31], s54 offen lds
    buffer_store_dwordx4 v[32:35], v85, s[36:39], s15 offen offset:1024 sc1
    s_add_u32 m0, s53, 58240
    s_add_u32 s54, s49, 802816
    buffer_load_dwordx4 v12, s[24:27], s54 offen lds
    s_add_u32 m0, s53, 59264
    s_nop 0
    buffer_load_dwordx4 v12, s[28:31], s54 offen lds
    buffer_store_dwordx4 v[32:35], v85, s[36:39], s15 offen offset:2048 sc1
    s_add_u32 m0, s53, 66560
    s_add_u32 s54, s49, 917504
    buffer_load_dwordx4 v12, s[24:27], s54 offen lds
    s_add_u32 m0, s53, 67584
    s_nop 0
    buffer_load_dwordx4 v12, s[28:31], s54 offen lds
    buffer_store_dwordx4 v[32:35], v85, s[36:39], s15 offen offset:3072 sc1
    s_add_u32 m0, s53, 74880
    s_add_u32 s54, s49, 1032192
    buffer_load_dwordx4 v12, s[24:27], s54 offen lds
    s_add_u32 m0, s53, 75904
    s_nop 0
    buffer_load_dwordx4 v12, s[28:31], s54 offen lds
    s_add_u32 m0, s53, 99840
    s_add_u32 s54, s49, 1146880
    buffer_load_dwordx4 v12, s[24:27], s54 offen lds
    s_add_u32 m0, s53, 100864
    s_nop 0
    buffer_load_dwordx4 v12, s[28:31], s54 offen lds
    s_mov_b64 exec, 1
    buffer_load_dword v29, v28, s[40:43], s13 offen sc1
    s_mov_b64 exec, -1
    s_waitcnt vmcnt(0)
    s_mov_b64 exec, 1
    v_cmp_ne_u32 vcc, 64, v29
    s_nop 4
    s_cbranch_vccz KF_pc_ok
KF_pc_lp:
    s_sleep 8
    buffer_load_dword v29, v28, s[40:43], s13 offen sc1
    s_add_u32 s68, s68, 1
    s_waitcnt vmcnt(0)
    v_cmp_ne_u32 vcc, 64, v29
    s_cmp_gt_u32 s68, 0x20000
    s_cbranch_scc1 KF_pc_ok
    s_nop 3
    s_cbranch_vccnz KF_pc_lp
KF_pc_ok:
    s_mov_b64 exec, -1
    buffer_load_dword v56, v40, s[40:43], s14 offen sc1
    s_add_u32 s14, s14, 14336
    buffer_load_dword v57, v40, s[40:43], s14 offen sc1
    s_add_u32 s14, s14, 14336
    buffer_load_dword v58, v40, s[40:43], s14 offen sc1
    s_add_u32 s14, s14, 14336
    buffer_load_dword v59, v40, s[40:43], s14 offen sc1
    s_add_u32 s14, s14, 14336
    buffer_load_dword v60, v40, s[40:43], s14 offen sc1
HOP_3:
    s_cbranch_execz HOP_7
    s_add_u32 s14, s14, 14336
    buffer_load_dword v61, v40, s[40:43], s14 offen sc1
    s_add_u32 s14, s14, 14336
    buffer_load_dword v62, v40, s[40:43], s14 offen sc1
    s_add_u32 s14, s14, 14336
    buffer_load_dword v63, v40, s[40:43], s14 offen sc1
    s_add_u32 s14, s14, 14336
M_hop:
    s_cmp_ge_u32 s66, 28
    s_cbranch_scc1 M_SP
    s_setprio 3
    s_barrier
    s_add_u32 m0, s52, 83200
    s_add_u32 s54, s48, 0
    buffer_load_dwordx4 v10, s[20:23], s54 offen sc1 lds
    buffer_load_dwordx4 v11, s[20:23], s54 offen offset:1024 sc1 lds
    s_add_u32 m0, s52, 91520
    s_add_u32 s54, s48, 131072
    buffer_load_dwordx4 v10, s[20:23], s54 offen sc1 lds
    buffer_load_dwordx4 v11, s[20:23], s54 offen offset:1024 sc1 lds
    s_add_u32 m0, s52, 108160
    s_add_u32 s54, s48, 262144
    buffer_load_dwordx4 v10, s[20:23], s54 offen sc1 lds
    buffer_load_dwordx4 v11, s[20:23], s54 offen offset:1024 sc1 lds
    s_add_u32 m0, s52, 116480
    s_add_u32 s54, s48, 393216
    buffer_load_dwordx4 v10, s[20:23], s54 offen sc1 lds
    buffer_load_dwordx4 v11, s[20:23], s54 offen offset:1024 sc1 lds
    s_add_u32 m0, s52, 124800
    s_add_u32 s54, s48, 524288
    buffer_load_dwordx4 v10, s[20:23], s54 offen sc1 lds
    buffer_load_dwordx4 v11, s[20:23], s54 offen offset:1024 sc1 lds
    s_waitcnt vmcnt(10)
    v_add_f32 v56, v56, v57
    v_add_f32 v58, v58, v59
    v_add_f32 v60, v60, v61
    v_add_f32 v62, v62, v63
    v_add_f32 v56, v56, v58
    v_add_f32 v60, v60, v62
    v_add_f32 v56, v56, v60
    v_mov_b32 v42, 1
    s_lshl_b32 s13, s16, 2
    s_add_u32 s13, s13, s12
    s_andn2_b32 s13, s13, 1
    s_bfe_u32 s14, s2, 0x10002
    s_add_u32 s13, s13, s14
    s_lshl_b32 s13, s13, 8
    s_add_u32 s13, s13, 147456
    ds_write_b32 v41, v56
    v_add_u32 v50, 83200, v44
    s_waitcnt vmcnt(8)
    ds_read2st64_b32 v[46:47], v50 offset0:0 offset1:4
    s_waitcnt lgkmcnt(0)
    v_max_u32 v46, v46, v47
    v_cmp_eq_u32 vcc, -1, v46
    s_nop 1
    s_cbranch_vccnz KF_ckh0_r
KF_ckh0_ok:
    s_barrier
    v_add_u32 v50, 91520, v44
    s_waitcnt vmcnt(6)
    ds_read2st64_b32 v[46:47], v50 offset0:0 offset1:4
    s_add_u32 m0, s52, 133120
    s_add_u32 s54, s48, 655360
    buffer_load_dwordx4 v10, s[20:23], s54 offen sc1 lds
    buffer_load_dwordx4 v11, s[20:23], s54 offen offset:1024 sc1 lds
    s_waitcnt lgkmcnt(0)
    v_max_u32 v46, v46, v47
    v_cmp_eq_u32 vcc, -1, v46
    s_nop 1
    s_cbranch_vccnz KF_ckh1_r
KF_ckh1_ok:
    v_add_u32 v50, 108160, v44
    s_waitcnt vmcnt(6)
    ds_read2st64_b32 v[46:47], v50 offset0:0 offset1:4
    s_barrier
    s_waitcnt lgkmcnt(0)
    v_max_u32 v46, v46, v47
    v_cmp_eq_u32 vcc, -1, v46
    s_nop 1
    s_cbranch_vccnz KF_ckh2_r
KF_ckh2_ok:
    s_add_u32 m0, s52, 141440
    s_add_u32 s54, s48, 786432
    buffer_load_dwordx4 v10, s[20:23], s54 offen sc1 lds
    buffer_load_dwordx4 v11, s[20:23], s54 offen offset:1024 sc1 lds
    s_add_u32 m0, s52, 149760
    s_add_u32 s54, s48, 917504
    buffer_load_dwordx4 v10, s[20:23], s54 offen sc1 lds
    v_add_u32 v50, 116480, v44
    v_add_u32 v51, 124800, v44
    s_waitcnt vmcnt(5)
    ds_read2st64_b32 v[46:47], v50 offset0:0 offset1:4
    ds_read2st64_b32 v[48:49], v51 offset0:0 offset1:4
    s_barrier
    s_waitcnt lgkmcnt(0)
    v_max3_u32 v46, v46, v48, v49
    v_max_u32 v46, v46, v47
    v_cmp_eq_u32 vcc, -1, v46
    s_nop 1
    s_cbranch_vccnz KF_ckh3_r
KF_ckh3_ok:
    s_add_u32 m0, s52, 149760
    s_add_u32 s54, s48, 917504
    buffer_load_dwordx4 v11, s[20:23], s54 offen offset:1024 sc1 lds
    s_add_u32 m0, s52, 0
    s_add_u32 s54, s48, 1048576
    buffer_load_dwordx4 v10, s[20:23], s54 offen sc1 lds
    buffer_load_dwordx4 v11, s[20:23], s54 offen offset:1024 sc1 lds
    s_barrier
    s_add_u32 m0, s52, 83200
    s_add_u32 s54, s48, 1179648
    buffer_load_dwordx4 v10, s[20:23], s54 offen sc1 lds
    buffer_load_dwordx4 v11, s[20:23], s54 offen offset:1024 sc1 lds
    s_add_u32 m0, s52, 8320
    s_add_u32 s54, s48, 1310720
    buffer_load_dwordx4 v10, s[20:23], s54 offen sc1 lds
    v_add_u32 v50, 133120, v44
    v_add_u32 v51, 141440, v44
    s_waitcnt vmcnt(7)
    ds_read2st64_b32 v[46:47], v50 offset0:0 offset1:4
    ds_read2st64_b32 v[48:49], v51 offset0:0 offset1:4
    s_barrier
    s_waitcnt lgkmcnt(0)
    v_max3_u32 v46, v46, v48, v49
    v_max_u32 v46, v46, v47
    v_cmp_eq_u32 vcc, -1, v46
    s_nop 1
    s_cbranch_vccnz KF_ckh5_r
KF_ckh5_ok:
    s_add_u32 m0, s52, 8320
    s_add_u32 s54, s48, 1310720
    buffer_load_dwordx4 v11, s[20:23], s54 offen offset:1024 sc1 lds
    s_add_u32 m0, s52, 91520
    s_add_u32 s54, s48, 1441792
    buffer_load_dwordx4 v10, s[20:23], s54 offen sc1 lds
    buffer_load_dwordx4 v11, s[20:23], s54 offen offset:1024 sc1 lds
    s_barrier
    s_add_u32 m0, s53, 16640
    s_add_u32 s54, s49, 1261568
    buffer_load_dwordx4 v12, s[24:27], s54 offen lds
    s_add_u32 m0, s53, 17664
    s_nop 0
    buffer_load_dwordx4 v12, s[28:31], s54 offen lds
    s_add_u32 m0, s52, 108160
    s_add_u32 s54, s48, 1572864
    buffer_load_dwordx4 v10, s[20:23], s54 offen sc1 lds
    v_add_u32 v50, 149760, v44
    v_add_u32 v51, 0, v44
    s_waitcnt vmcnt(9)
    ds_read2st64_b32 v[46:47], v50 offset0:0 offset1:4
    ds_read2st64_b32 v[48:49], v51 offset0:0 offset1:4
    s_barrier
    s_waitcnt lgkmcnt(0)
    v_max3_u32 v46, v46, v48, v49
    v_max_u32 v46, v46, v47
    v_cmp_eq_u32 vcc, -1, v46
    s_nop 1
    s_cbranch_vccnz KF_ckh7_r
KF_ckh7_ok:
    s_add_u32 m0, s52, 108160
    s_add_u32 s54, s48, 1572864
    buffer_load_dwordx4 v11, s[20:23], s54 offen offset:1024 sc1 lds
    s_add_u32 m0, s53, 24960
    s_add_u32 s54, s49, 1376256
    buffer_load_dwordx4 v12, s[24:27], s54 offen lds
    s_add_u32 m0, s53, 25984
    s_nop 0
    buffer_load_dwordx4 v12, s[28:31], s54 offen lds
    s_barrier
    s_add_u32 m0, s52, 116480
    s_add_u32 s54, s48, 1703936
    buffer_load_dwordx4 v10, s[20:23], s54 offen sc1 lds
    buffer_load_dwordx4 v11, s[20:23], s54 offen offset:1024 sc1 lds
    s_add_u32 m0, s53, 33280
    s_add_u32 s54, s49, 1490944
    buffer_load_dwordx4 v12, s[24:27], s54 offen lds
    v_add_u32 v50, 83200, v44
    v_add_u32 v51, 8320, v44
    s_waitcnt vmcnt(11)
    ds_read2st64_b32 v[46:47], v50 offset0:0 offset1:4
    ds_read2st64_b32 v[48:49], v51 offset0:0 offset1:4
    s_barrier
    s_waitcnt lgkmcnt(0)
    v_max3_u32 v46, v46, v48, v49
    v_max_u32 v46, v46, v47
    v_cmp_eq_u32 vcc, -1, v46
    s_nop 1
    s_cbranch_vccnz KF_ckh9_r
KF_ckh9_ok:
    s_add_u32 m0, s53, 33280
    s_add_u32 s54, s49, 1490944
    s_add_u32 m0, s53, 34304
    s_nop 0
    buffer_load_dwordx4 v12, s[28:31], s54 offen lds
    s_add_u32 m0, s52, 124800
    s_add_u32 s54, s48, 1835008
    buffer_load_dwordx4 v10, s[20:23], s54 offen sc1 lds
    buffer_load_dwordx4 v11, s[20:23], s54 offen offset:1024 sc1 lds
    s_barrier
    s_add_u32 m0, s53, 41600
    s_add_u32 s54, s49, 1605632
    buffer_load_dwordx4 v12, s[24:27], s54 offen lds
    s_add_u32 m0, s53, 42624
    s_nop 0
    buffer_load_dwordx4 v12, s[28:31], s54 offen lds
    s_add_u32 m0, s52, 133120
    s_add_u32 s54, s48, 1966080
    buffer_load_dwordx4 v10, s[20:23], s54 offen sc1 lds
    v_add_u32 v50, 91520, v44
    v_add_u32 v51, 108160, v44
    s_waitcnt vmcnt(11)
    ds_read2st64_b32 v[46:47], v50 offset0:0 offset1:4
    ds_read2st64_b32 v[48:49], v51 offset0:0 offset1:4
    s_barrier
    s_waitcnt lgkmcnt(0)
    v_max3_u32 v46, v46, v48, v49
    v_max_u32 v46, v46, v47
    v_cmp_eq_u32 vcc, -1, v46
    s_nop 1
    s_cbranch_vccnz KF_ckh11_r
KF_ckh11_ok:
    s_add_u32 m0, s52, 133120
    s_add_u32 s54, s48, 1966080
    buffer_load_dwordx4 v11, s[20:23], s54 offen offset:1024 sc1 lds
    s_add_u32 m0, s53, 49920
    s_add_u32 s54, s49, 1720320
    buffer_load_dwordx4 v12, s[24:27], s54 offen lds
    s_add_u32 m0, s53, 50944
    s_nop 0
    buffer_load_dwordx4 v12, s[28:31], s54 offen lds
    s_barrier
    s_add_u32 m0, s53, 141440
    s_add_u32 s54, s49, 128
    buffer_load_dwordx4 v12, s[24:27], s54 offen lds
    s_add_u32 m0, s53, 142464
    s_nop 0
    buffer_load_dwordx4 v12, s[28:31], s54 offen lds
    s_add_u32 m0, s53, 58240
    s_add_u32 s54, s49, 114816
    buffer_load_dwordx4 v12, s[24:27], s54 offen lds
    v_add_u32 v50, 116480, v44
    v_add_u32 v51, 124800, v44
    s_waitcnt vmcnt(9)
    ds_read2st64_b32 v[46:47], v50 offset0:0 offset1:4
    ds_read2st64_b32 v[48:49], v51 offset0:0 offset1:4
    s_barrier
    s_waitcnt lgkmcnt(0)
    v_max3_u32 v46, v46, v48, v49
    v_max_u32 v46, v46, v47
    v_cmp_eq_u32 vcc, -1, v46
    s_nop 1
    s_cbranch_vccnz KF_ckh13_r
KF_ckh13_ok:
    s_add_u32 m0, s53, 58240
    s_add_u32 s54, s49, 114816
    s_add_u32 m0, s53, 59264
    s_nop 0
    buffer_load_dwordx4 v12, s[28:31], s54 offen lds
    s_add_u32 m0, s53, 149760
    s_add_u32 s54, s49, 229504
    buffer_load_dwordx4 v12, s[24:27], s54 offen lds
    s_add_u32 m0, s53, 150784
    s_nop 0
    buffer_load_dwordx4 v12, s[28:31], s54 offen lds
    s_barrier
    s_add_u32 m0, s53, 66560
    s_add_u32 s54, s49, 344192
    buffer_load_dwordx4 v12, s[24:27], s54 offen lds
    s_add_u32 m0, s53, 67584
    s_nop 0
    buffer_load_dwordx4 v12, s[28:31], s54 offen lds
    s_add_u32 m0, s53, 0
    s_add_u32 s54, s49, 458880
    buffer_load_dwordx4 v12, s[24:27], s54 offen lds
    v_add_u32 v50, 133120, v44
    s_waitcnt vmcnt(11)
    ds_read2st64_b32 v[46:47], v50 offset0:0 offset1:4
    s_barrier
    s_waitcnt lgkmcnt(0)
    v_max_u32 v46, v46, v47
    v_cmp_eq_u32 vcc, -1, v46
    s_nop 1
    s_cbranch_vccnz KF_ckh15_r
KF_ckh15_ok:
    s_add_u32 m0, s53, 0
    s_add_u32 s54, s49, 458880
    s_add_u32 m0, s53, 1024
    s_nop 0
    buffer_load_dwordx4 v12, s[28:31], s54 offen lds
    s_add_u32 m0, s53, 74880
    s_add_u32 s54, s49, 573568
    buffer_load_dwordx4 v12, s[24:27], s54 offen lds
    s_add_u32 m0, s53, 75904
    s_nop 0
    buffer_load_dwordx4 v12, s[28:31], s54 offen lds
    s_waitcnt vmcnt(12)
    s_barrier
    s_add_u32 m0, s53, 83200
    s_add_u32 s54, s49, 688256
    buffer_load_dwordx4 v12, s[24:27], s54 offen lds
    s_add_u32 m0, s53, 84224
    s_nop 0
    buffer_load_dwordx4 v12, s[28:31], s54 offen lds
    s_add_u32 m0, s53, 99840
    s_add_u32 s54, s49, 802944
    buffer_load_dwordx4 v12, s[24:27], s54 offen lds
    s_add_u32 m0, s53, 100864
    s_nop 0
    buffer_load_dwordx4 v12, s[28:31], s54 offen lds
    s_barrier
    s_add_u32 m0, s53, 8320
    s_add_u32 s54, s49, 917632
    buffer_load_dwordx4 v12, s[24:27], s54 offen lds
    s_add_u32 m0, s53, 9344
    s_nop 0
    buffer_load_dwordx4 v12, s[28:31], s54 offen lds
    s_add_u32 m0, s53, 91520
    s_add_u32 s54, s49, 1032320
    buffer_load_dwordx4 v12, s[24:27], s54 offen lds
    s_add_u32 m0, s53, 92544
    s_nop 0
    buffer_load_dwordx4 v12, s[28:31], s54 offen lds
    s_add_u32 m0, s53, 16640
    s_add_u32 s54, s49, 1147008
    buffer_load_dwordx4 v12, s[24:27], s54 offen lds
    s_add_u32 m0, s53, 17664
    s_nop 0
    buffer_load_dwordx4 v12, s[28:31], s54 offen lds
    s_add_u32 m0, s53, 108160
    s_add_u32 s54, s49, 1261696
    buffer_load_dwordx4 v12, s[24:27], s54 offen lds
    s_add_u32 m0, s53, 109184
    s_nop 0
    buffer_load_dwordx4 v12, s[28:31], s54 offen lds
    s_waitcnt vmcnt(22)
    s_barrier
    s_add_u32 m0, s53, 24960
    s_add_u32 s54, s49, 1376384
    buffer_load_dwordx4 v12, s[24:27], s54 offen lds
    s_add_u32 m0, s53, 25984
    s_nop 0
    buffer_load_dwordx4 v12, s[28:31], s54 offen lds
    s_add_u32 m0, s53, 116480
    s_add_u32 s54, s49, 1491072
    buffer_load_dwordx4 v12, s[24:27], s54 offen lds
    s_waitcnt vmcnt(23)
    s_barrier
    s_add_u32 m0, s53, 116480
    s_add_u32 s54, s49, 1491072
    s_add_u32 m0, s53, 117504
    s_nop 0
    buffer_load_dwordx4 v12, s[28:31], s54 offen lds
    s_add_u32 m0, s53, 33280
    s_add_u32 s54, s49, 1605760
    buffer_load_dwordx4 v12, s[24:27], s54 offen lds
    s_add_u32 m0, s53, 34304
    s_nop 0
    buffer_load_dwordx4 v12, s[28:31], s54 offen lds
    s_waitcnt vmcnt(24)
    s_barrier
    s_add_u32 m0, s53, 124800
    s_add_u32 s54, s49, 1720448
    buffer_load_dwordx4 v12, s[24:27], s54 offen lds
    s_add_u32 m0, s53, 125824
    s_nop 0
    buffer_load_dwordx4 v12, s[28:31], s54 offen lds
    s_add_u32 m0, s53, 41600
    s_add_u32 s54, s50, 0
    buffer_load_dwordx4 v13, s[32:35], s54 offen lds
    s_waitcnt vmcnt(25)
    s_barrier
    s_mov_b64 exec, 1
    buffer_atomic_add v42, v28, s[40:43], s13 offen sc1
    s_mov_b64 exec, -1
    s_add_u32 m0, s53, 41600
    s_add_u32 s54, s50, 0
    buffer_load_dwordx4 v14, s[32:35], s54 offen offset:1024 lds
    s_add_u32 m0, s53, 133120
    s_add_u32 s54, s50, 131072
    buffer_load_dwordx4 v13, s[32:35], s54 offen lds
    buffer_load_dwordx4 v14, s[32:35], s54 offen offset:1024 lds
    s_waitcnt vmcnt(27)
    s_barrier
    s_add_u32 m0, s53, 49920
    s_add_u32 s54, s50, 262144
    buffer_load_dwordx4 v13, s[32:35], s54 offen lds
    buffer_load_dwordx4 v14, s[32:35], s54 offen offset:1024 lds
    s_add_u32 m0, s53, 141440
    s_add_u32 s54, s50, 393216
    buffer_load_dwordx4 v13, s[32:35], s54 offen lds
    s_waitcnt vmcnt(28)
    s_barrier
    s_add_u32 m0, s53, 141440
    s_add_u32 s54, s50, 393216
    buffer_load_dwordx4 v14, s[32:35], s54 offen offset:1024 lds
    s_add_u32 m0, s53, 58240
    s_add_u32 s54, s50, 524288
    buffer_load_dwordx4 v13, s[32:35], s54 offen lds
    buffer_load_dwordx4 v14, s[32:35], s54 offen offset:1024 lds
    s_waitcnt vmcnt(29)
    s_barrier
    s_add_u32 m0, s53, 149760
    s_add_u32 s54, s50, 655360
    buffer_load_dwordx4 v13, s[32:35], s54 offen lds
    buffer_load_dwordx4 v14, s[32:35], s54 offen offset:1024 lds
    s_add_u32 m0, s53, 66560
    s_add_u32 s54, s50, 786432
    buffer_load_dwordx4 v13, s[32:35], s54 offen lds
    s_waitcnt vmcnt(30)
    s_barrier
    s_add_u32 m0, s53, 66560
    s_add_u32 s54, s50, 786432
    buffer_load_dwordx4 v14, s[32:35], s54 offen offset:1024 lds
    s_add_u32 m0, s53, 0
    s_add_u32 s54, s56, 917504
    buffer_load_dwordx4 v13, s[32:35], s54 offen lds
    buffer_load_dwordx4 v14, s[32:35], s54 offen offset:1024 lds
    s_waitcnt vmcnt(31)
    s_barrier
    s_add_u32 m0, s53, 74880
    s_add_u32 s54, s56, 1048576
    buffer_load_dwordx4 v13, s[32:35], s54 offen lds
    buffer_load_dwordx4 v14, s[32:35], s54 offen offset:1024 lds
    s_add_u32 m0, s53, 83200
    s_add_u32 s54, s56, 1179648
    buffer_load_dwordx4 v13, s[32:35], s54 offen lds
    s_waitcnt vmcnt(32)
    s_barrier
    s_mov_b64 exec, 1
    buffer_load_dword v29, v28, s[40:43], s59 offen sc1
    s_mov_b64 exec, -1
    s_add_u32 m0, s53, 83200
    s_add_u32 s54, s56, 1179648
    buffer_load_dwordx4 v14, s[32:35], s54 offen offset:1024 lds
    s_add_u32 m0, s53, 99840
    s_add_u32 s54, s56, 1310720
    buffer_load_dwordx4 v13, s[32:35], s54 offen lds
    buffer_load_dwordx4 v14, s[32:35], s54 offen offset:1024 lds
    s_waitcnt vmcnt(34)
    s_barrier
    s_add_u32 m0, s53, 8320
    s_add_u32 s54, s56, 1441792
    buffer_load_dwordx4 v13, s[32:35], s54 offen lds
    buffer_load_dwordx4 v14, s[32:35], s54 offen offset:1024 lds
    s_waitcnt vmcnt(34)
    s_barrier
    s_waitcnt vmcnt(5)
    s_mov_b64 exec, 1
    v_cmp_ne_u32 vcc, 14, v29
    s_nop 4
    s_cbranch_vccz KF_pe_ok
KF_pe_lp:
    s_sleep 6
    buffer_load_dword v29, v28, s[40:43], s59 offen sc1
    s_add_u32 s68, s68, 1
    s_waitcnt vmcnt(0)
    v_cmp_ne_u32 vcc, 14, v29
    s_cmp_gt_u32 s68, 0x20000
    s_cbranch_scc1 KF_pe_ok
    s_nop 3
    s_cbranch_vccnz KF_pe_lp
KF_pe_ok:
    s_mov_b64 exec, -1
    s_add_u32 m0, s53, 91520
    s_add_u32 s54, s56, 1572864
    buffer_load_dwordx4 v13, s[32:35], s54 offen lds
    buffer_load_dwordx4 v14, s[32:35], s54 offen offset:1024 lds
    s_barrier
    s_mov_b64 exec, 1
    buffer_load_dword v30, v28, s[40:43], s58 offen sc1
    s_mov_b64 exec, -1
    s_add_u32 m0, s53, 16640
    s_add_u32 s54, s56, 1703936
    buffer_load_dwordx4 v13, s[32:35], s54 offen lds
    buffer_load_dwordx4 v14, s[32:35], s54 offen offset:1024 lds
    s_barrier
    s_add_u32 m0, s53, 108160
    s_add_u32 s54, s50, 65536
    buffer_load_dwordx4 v13, s[32:35], s54 offen lds
    buffer_load_dwordx4 v14, s[32:35], s54 offen offset:1024 lds
    s_barrier
    s_waitcnt vmcnt(4)
    s_mov_b64 exec, 1
    v_cmp_ne_u32 vcc, 14, v30
    s_nop 4
    s_cbranch_vccz KF_po_ok
KF_po_lp:
    s_sleep 6
    buffer_load_dword v30, v28, s[40:43], s58 offen sc1
    s_add_u32 s68, s68, 1
    s_waitcnt vmcnt(0)
    v_cmp_ne_u32 vcc, 14, v30
    s_cmp_gt_u32 s68, 0x20000
    s_cbranch_scc1 KF_po_ok
    s_nop 3
    s_cbranch_vccnz KF_po_lp
KF_po_ok:
    s_mov_b64 exec, -1
    s_add_u32 m0, s53, 24960
    s_add_u32 s54, s50, 196608
    buffer_load_dwordx4 v13, s[32:35], s54 offen lds
    buffer_load_dwordx4 v14, s[32:35], s54 offen offset:1024 lds
    s_barrier
    s_add_u32 m0, s53, 116480
    s_add_u32 s54, s50, 327680
    buffer_load_dwordx4 v13, s[32:35], s54 offen lds
    buffer_load_dwordx4 v14, s[32:35], s54 offen offset:1024 lds
    s_barrier
KF_L33:
    s_add_u32 m0, s53, 33280
    s_add_u32 s54, s50, 458752
    buffer_load_dwordx4 v13, s[32:35], s54 offen lds
    buffer_load_dwordx4 v14, s[32:35], s54 offen offset:1024 lds
    s_add_u32 m0, s53, 124800
    s_add_u32 s54, s50, 589824
    buffer_load_dwordx4 v13, s[32:35], s54 offen lds
    buffer_load_dwordx4 v14, s[32:35], s54 offen offset:1024 lds
    s_waitcnt vmcnt(0)
    s_barrier
    s_barrier
    s_barrier
    s_barrier
    s_add_u32 m0, s53, 41600
    s_add_u32 s54, s50, 720896
    buffer_load_dwordx4 v13, s[32:35], s54 offen lds
    buffer_load_dwordx4 v14, s[32:35], s54 offen offset:1024 lds
    s_add_u32 m0, s53, 133120
    s_add_u32 s54, s50, 851968
    buffer_load_dwordx4 v13, s[32:35], s54 offen lds
    buffer_load_dwordx4 v14, s[32:35], s54 offen offset:1024 lds
    s_add_u32 m0, s53, 49920
    s_add_u32 s54, s56, 983040
    buffer_load_dwordx4 v13, s[32:35], s54 offen lds
    buffer_load_dwordx4 v14, s[32:35], s54 offen offset:1024 lds
    s_barrier
    s_add_u32 m0, s53, 141440
    s_add_u32 s54, s56, 1114112
    buffer_load_dwordx4 v13, s[32:35], s54 offen lds
    buffer_load_dwordx4 v14, s[32:35], s54 offen offset:1024 lds
    s_add_u32 m0, s53, 58240
    s_add_u32 s54, s56, 1245184
    buffer_load_dwordx4 v13, s[32:35], s54 offen lds
    buffer_load_dwordx4 v14, s[32:35], s54 offen offset:1024 lds
    s_add_u32 m0, s53, 149760
    s_add_u32 s54, s56, 1376256
    buffer_load_dwordx4 v13, s[32:35], s54 offen lds
    buffer_load_dwordx4 v14, s[32:35], s54 offen offset:1024 lds
    s_barrier
    s_add_u32 m0, s53, 66560
    s_add_u32 s54, s56, 1507328
    buffer_load_dwordx4 v13, s[32:35], s54 offen lds
    buffer_load_dwordx4 v14, s[32:35], s54 offen offset:1024 lds
    s_add_u32 m0, s53, 0
    s_add_u32 s54, s56, 1638400
    buffer_load_dwordx4 v13, s[32:35], s54 offen lds
    buffer_load_dwordx4 v14, s[32:35], s54 offen offset:1024 lds
    s_barrier
    s_add_u32 m0, s53, 74880
    s_add_u32 s54, s56, 1769472
    buffer_load_dwordx4 v13, s[32:35], s54 offen lds
    buffer_load_dwordx4 v14, s[32:35], s54 offen offset:1024 lds
    s_add_u32 m0, s53, 83200
    s_nop 0
    buffer_load_dwordx4 v16, s[20:23], s55 offen sc1 lds
    buffer_load_dwordx4 v17, s[20:23], s55 offen offset:1024 sc1 lds
    s_barrier
    s_barrier
    s_waitcnt vmcnt(16)
    s_barrier
    s_waitcnt vmcnt(12)
    s_barrier
    s_waitcnt vmcnt(8)
    s_barrier
    s_waitcnt vmcnt(4)
    s_barrier
    s_waitcnt vmcnt(0)
    s_barrier
    s_endpgm
M_SP:
    s_barrier
    s_branch M_S
.p2align 12
M_C2:
HOP_4:
    s_cbranch_execz HOP_8
    s_cmp_ge_u32 s66, 28
    s_cbranch_scc1 M_SC
    s_lshl_b32 s61, s2, 2
    s_add_u32 s61, s61, s12
    s_lshl_b32 s61, s61, 11
    v_and_b32 v30, 15, v2
    v_lshl_add_u32 v30, v30, 7, s61
    s_barrier
    ds_read_b64_tr_b16 v[128:129], v5 offset:24960
    ds_read_b64_tr_b16 v[130:131], v5 offset:25472
    ds_read_b64_tr_b16 v[132:133], v8 offset:24960
    ds_read_b64_tr_b16 v[134:135], v8 offset:25472
    ds_read_b64_tr_b16 v[32:33], v10 offset:0
    ds_read_b64_tr_b16 v[34:35], v10 offset:256
    ds_read_b64_tr_b16 v[36:37], v10 offset:1024
    ds_read_b64_tr_b16 v[38:39], v10 offset:1280
    ds_read_b64_tr_b16 v[40:41], v10 offset:32
    ds_read_b64_tr_b16 v[42:43], v10 offset:288
    ds_read_b64_tr_b16 v[44:45], v10 offset:1056
    ds_read_b64_tr_b16 v[46:47], v10 offset:1312
    s_waitcnt lgkmcnt(4)
    v_mfma_f32_16x16x32_bf16 v[64:67], v[32:35], v[128:131], 0
    ds_read_b64_tr_b16 v[48:49], v10 offset:64
    v_mfma_f32_16x16x32_bf16 v[72:75], v[32:35], v[132:135], 0
    ds_read_b64_tr_b16 v[50:51], v10 offset:320
    v_mfma_f32_16x16x32_bf16 v[68:71], v[36:39], v[128:131], 0
    ds_read_b64_tr_b16 v[52:53], v10 offset:1088
    v_mfma_f32_16x16x32_bf16 v[76:79], v[36:39], v[132:135], 0
    ds_read_b64_tr_b16 v[54:55], v10 offset:1344
    s_waitcnt lgkmcnt(4)
    v_mfma_f32_16x16x32_bf16 v[80:83], v[40:43], v[128:131], 0
    ds_read_b64_tr_b16 v[56:57], v10 offset:96
    v_mfma_f32_16x16x32_bf16 v[88:91], v[40:43], v[132:135], 0
    ds_read_b64_tr_b16 v[58:59], v10 offset:352
    v_mfma_f32_16x16x32_bf16 v[84:87], v[44:47], v[128:131], 0
    ds_read_b64_tr_b16 v[60:61], v10 offset:1120
    v_mfma_f32_16x16x32_bf16 v[92:95], v[44:47], v[132:135], 0
    ds_read_b64_tr_b16 v[62:63], v10 offset:1376
    s_barrier
    s_waitcnt lgkmcnt(4)
    v_mfma_f32_16x16x32_bf16 v[96:99], v[48:51], v[128:131], 0
    ds_read_b64_tr_b16 v[136:137], v5 offset:33280
    ds_read_b64_tr_b16 v[138:139], v5 offset:33792
    v_mfma_f32_16x16x32_bf16 v[104:107], v[48:51], v[132:135], 0
    ds_read_b64_tr_b16 v[140:141], v8 offset:33280
    ds_read_b64_tr_b16 v[142:143], v8 offset:33792
    v_mfma_f32_16x16x32_bf16 v[100:103], v[52:55], v[128:131], 0
    ds_read_b64_tr_b16 v[32:33], v10 offset:8320
    v_mfma_f32_16x16x32_bf16 v[108:111], v[52:55], v[132:135], 0
    ds_read_b64_tr_b16 v[34:35], v10 offset:8576
    s_waitcnt lgkmcnt(6)
    v_mfma_f32_16x16x32_bf16 v[112:115], v[56:59], v[128:131], 0
    ds_read_b64_tr_b16 v[36:37], v10 offset:9344
    ds_read_b64_tr_b16 v[38:39], v10 offset:9600
    v_mfma_f32_16x16x32_bf16 v[120:123], v[56:59], v[132:135], 0
    ds_read_b64_tr_b16 v[40:41], v10 offset:8352
    ds_read_b64_tr_b16 v[42:43], v10 offset:8608
    v_mfma_f32_16x16x32_bf16 v[116:119], v[60:63], v[128:131], 0
    ds_read_b64_tr_b16 v[44:45], v10 offset:9376
    v_mfma_f32_16x16x32_bf16 v[124:127], v[60:63], v[132:135], 0
    ds_read_b64_tr_b16 v[46:47], v10 offset:9632
    s_waitcnt lgkmcnt(4)
    v_mfma_f32_16x16x32_bf16 v[64:67], v[32:35], v[136:139], v[64:67]
    ds_read_b64_tr_b16 v[48:49], v10 offset:8384
    v_mfma_f32_16x16x32_bf16 v[72:75], v[32:35], v[140:143], v[72:75]
    ds_read_b64_tr_b16 v[50:51], v10 offset:8640
    v_mfma_f32_16x16x32_bf16 v[68:71], v[36:39], v[136:139], v[68:71]
    ds_read_b64_tr_b16 v[52:53], v10 offset:9408
    v_mfma_f32_16x16x32_bf16 v[76:79], v[36:39], v[140:143], v[76:79]
    ds_read_b64_tr_b16 v[54:55], v10 offset:9664
    s_waitcnt lgkmcnt(4)
    v_mfma_f32_16x16x32_bf16 v[80:83], v[40:43], v[136:139], v[80:83]
    ds_read_b64_tr_b16 v[56:57], v10 offset:8416
    v_mfma_f32_16x16x32_bf16 v[88:91], v[40:43], v[140:143], v[88:91]
    ds_read_b64_tr_b16 v[58:59], v10 offset:8672
    v_mfma_f32_16x16x32_bf16 v[84:87], v[44:47], v[136:139], v[84:87]
    ds_read_b64_tr_b16 v[60:61], v10 offset:9440
    v_mfma_f32_16x16x32_bf16 v[92:95], v[44:47], v[140:143], v[92:95]
    ds_read_b64_tr_b16 v[62:63], v10 offset:9696
    s_barrier
    s_waitcnt lgkmcnt(4)
    v_mfma_f32_16x16x32_bf16 v[96:99], v[48:51], v[136:139], v[96:99]
    ds_read_b64_tr_b16 v[144:145], v5 offset:49920
    ds_read_b64_tr_b16 v[146:147], v5 offset:50432
    v_mfma_f32_16x16x32_bf16 v[104:107], v[48:51], v[140:143], v[104:107]
    ds_read_b64_tr_b16 v[148:149], v8 offset:49920
    ds_read_b64_tr_b16 v[150:151], v8 offset:50432
    v_mfma_f32_16x16x32_bf16 v[100:103], v[52:55], v[136:139], v[100:103]
    ds_read_b64_tr_b16 v[32:33], v10 offset:16640
    v_mfma_f32_16x16x32_bf16 v[108:111], v[52:55], v[140:143], v[108:111]
    ds_read_b64_tr_b16 v[34:35], v10 offset:16896
    s_waitcnt lgkmcnt(6)
    v_mfma_f32_16x16x32_bf16 v[112:115], v[56:59], v[136:139], v[112:115]
    ds_read_b64_tr_b16 v[36:37], v10 offset:17664
    ds_read_b64_tr_b16 v[38:39], v10 offset:17920
    v_mfma_f32_16x16x32_bf16 v[120:123], v[56:59], v[140:143], v[120:123]
    ds_read_b64_tr_b16 v[40:41], v10 offset:16672
    ds_read_b64_tr_b16 v[42:43], v10 offset:16928
    v_mfma_f32_16x16x32_bf16 v[116:119], v[60:63], v[136:139], v[116:119]
    ds_read_b64_tr_b16 v[44:45], v10 offset:17696
    v_mfma_f32_16x16x32_bf16 v[124:127], v[60:63], v[140:143], v[124:127]
    ds_read_b64_tr_b16 v[46:47], v10 offset:17952
    s_waitcnt lgkmcnt(4)
    v_mfma_f32_16x16x32_bf16 v[64:67], v[32:35], v[144:147], v[64:67]
    ds_read_b64_tr_b16 v[48:49], v10 offset:16704
    v_mfma_f32_16x16x32_bf16 v[72:75], v[32:35], v[148:151], v[72:75]
    ds_read_b64_tr_b16 v[50:51], v10 offset:16960
    v_mfma_f32_16x16x32_bf16 v[68:71], v[36:39], v[144:147], v[68:71]
    ds_read_b64_tr_b16 v[52:53], v10 offset:17728
    v_mfma_f32_16x16x32_bf16 v[76:79], v[36:39], v[148:151], v[76:79]
    ds_read_b64_tr_b16 v[54:55], v10 offset:17984
    s_waitcnt lgkmcnt(4)
    v_mfma_f32_16x16x32_bf16 v[80:83], v[40:43], v[144:147], v[80:83]
    ds_read_b64_tr_b16 v[56:57], v10 offset:16736
    v_mfma_f32_16x16x32_bf16 v[88:91], v[40:43], v[148:151], v[88:91]
    ds_read_b64_tr_b16 v[58:59], v10 offset:16992
    v_mfma_f32_16x16x32_bf16 v[84:87], v[44:47], v[144:147], v[84:87]
    ds_read_b64_tr_b16 v[60:61], v10 offset:17760
    v_mfma_f32_16x16x32_bf16 v[92:95], v[44:47], v[148:151], v[92:95]
    ds_read_b64_tr_b16 v[62:63], v10 offset:18016
    s_barrier
    s_waitcnt lgkmcnt(4)
    v_mfma_f32_16x16x32_bf16 v[96:99], v[48:51], v[144:147], v[96:99]
    ds_read_b64_tr_b16 v[152:153], v6 offset:0
    ds_read_b64_tr_b16 v[154:155], v6 offset:512
    v_mfma_f32_16x16x32_bf16 v[104:107], v[48:51], v[148:151], v[104:107]
    ds_read_b64_tr_b16 v[156:157], v9 offset:0
    ds_read_b64_tr_b16 v[158:159], v9 offset:512
    v_mfma_f32_16x16x32_bf16 v[100:103], v[52:55], v[144:147], v[100:103]
    ds_read_b64_tr_b16 v[32:33], v10 offset:24960
    v_mfma_f32_16x16x32_bf16 v[108:111], v[52:55], v[148:151], v[108:111]
    ds_read_b64_tr_b16 v[34:35], v10 offset:25216
    s_waitcnt lgkmcnt(6)
    v_mfma_f32_16x16x32_bf16 v[112:115], v[56:59], v[144:147], v[112:115]
    ds_read_b64_tr_b16 v[36:37], v10 offset:25984
    ds_read_b64_tr_b16 v[38:39], v10 offset:26240
    v_mfma_f32_16x16x32_bf16 v[120:123], v[56:59], v[148:151], v[120:123]
    ds_read_b64_tr_b16 v[40:41], v10 offset:24992
    ds_read_b64_tr_b16 v[42:43], v10 offset:25248
    v_mfma_f32_16x16x32_bf16 v[116:119], v[60:63], v[144:147], v[116:119]
    ds_read_b64_tr_b16 v[44:45], v10 offset:26016
    v_mfma_f32_16x16x32_bf16 v[124:127], v[60:63], v[148:151], v[124:127]
    ds_read_b64_tr_b16 v[46:47], v10 offset:26272
    s_waitcnt lgkmcnt(4)
    v_mfma_f32_16x16x32_bf16 v[64:67], v[32:35], v[152:155], v[64:67]
    ds_read_b64_tr_b16 v[48:49], v10 offset:25024
    v_mfma_f32_16x16x32_bf16 v[72:75], v[32:35], v[156:159], v[72:75]
    ds_read_b64_tr_b16 v[50:51], v10 offset:25280
    v_mfma_f32_16x16x32_bf16 v[68:71], v[36:39], v[152:155], v[68:71]
    ds_read_b64_tr_b16 v[52:53], v10 offset:26048
    v_mfma_f32_16x16x32_bf16 v[76:79], v[36:39], v[156:159], v[76:79]
    ds_read_b64_tr_b16 v[54:55], v10 offset:26304
    s_waitcnt lgkmcnt(4)
    v_mfma_f32_16x16x32_bf16 v[80:83], v[40:43], v[152:155], v[80:83]
    ds_read_b64_tr_b16 v[56:57], v10 offset:25056
    v_mfma_f32_16x16x32_bf16 v[88:91], v[40:43], v[156:159], v[88:91]
    ds_read_b64_tr_b16 v[58:59], v10 offset:25312
    v_mfma_f32_16x16x32_bf16 v[84:87], v[44:47], v[152:155], v[84:87]
    ds_read_b64_tr_b16 v[60:61], v10 offset:26080
    v_mfma_f32_16x16x32_bf16 v[92:95], v[44:47], v[156:159], v[92:95]
    ds_read_b64_tr_b16 v[62:63], v10 offset:26336
    s_barrier
    s_waitcnt lgkmcnt(4)
    v_mfma_f32_16x16x32_bf16 v[96:99], v[48:51], v[152:155], v[96:99]
    ds_read_b64_tr_b16 v[160:161], v6 offset:8320
    ds_read_b64_tr_b16 v[162:163], v6 offset:8832
    v_mfma_f32_16x16x32_bf16 v[104:107], v[48:51], v[156:159], v[104:107]
    ds_read_b64_tr_b16 v[164:165], v9 offset:8320
    ds_read_b64_tr_b16 v[166:167], v9 offset:8832
    v_mfma_f32_16x16x32_bf16 v[100:103], v[52:55], v[152:155], v[100:103]
    ds_read_b64_tr_b16 v[32:33], v10 offset:33280
    v_mfma_f32_16x16x32_bf16 v[108:111], v[52:55], v[156:159], v[108:111]
    ds_read_b64_tr_b16 v[34:35], v10 offset:33536
    s_waitcnt lgkmcnt(6)
    v_mfma_f32_16x16x32_bf16 v[112:115], v[56:59], v[152:155], v[112:115]
    ds_read_b64_tr_b16 v[36:37], v10 offset:34304
    ds_read_b64_tr_b16 v[38:39], v10 offset:34560
    v_mfma_f32_16x16x32_bf16 v[120:123], v[56:59], v[156:159], v[120:123]
    ds_read_b64_tr_b16 v[40:41], v10 offset:33312
    ds_read_b64_tr_b16 v[42:43], v10 offset:33568
    v_mfma_f32_16x16x32_bf16 v[116:119], v[60:63], v[152:155], v[116:119]
    ds_read_b64_tr_b16 v[44:45], v10 offset:34336
    v_mfma_f32_16x16x32_bf16 v[124:127], v[60:63], v[156:159], v[124:127]
    ds_read_b64_tr_b16 v[46:47], v10 offset:34592
    s_waitcnt lgkmcnt(4)
    v_mfma_f32_16x16x32_bf16 v[64:67], v[32:35], v[160:163], v[64:67]
    ds_read_b64_tr_b16 v[48:49], v10 offset:33344
    v_mfma_f32_16x16x32_bf16 v[72:75], v[32:35], v[164:167], v[72:75]
    ds_read_b64_tr_b16 v[50:51], v10 offset:33600
    v_mfma_f32_16x16x32_bf16 v[68:71], v[36:39], v[160:163], v[68:71]
    ds_read_b64_tr_b16 v[52:53], v10 offset:34368
    v_mfma_f32_16x16x32_bf16 v[76:79], v[36:39], v[164:167], v[76:79]
    ds_read_b64_tr_b16 v[54:55], v10 offset:34624
    s_waitcnt lgkmcnt(4)
    v_mfma_f32_16x16x32_bf16 v[80:83], v[40:43], v[160:163], v[80:83]
    ds_read_b64_tr_b16 v[56:57], v10 offset:33376
    v_mfma_f32_16x16x32_bf16 v[88:91], v[40:43], v[164:167], v[88:91]
    ds_read_b64_tr_b16 v[58:59], v10 offset:33632
    v_mfma_f32_16x16x32_bf16 v[84:87], v[44:47], v[160:163], v[84:87]
    ds_read_b64_tr_b16 v[60:61], v10 offset:34400
    v_mfma_f32_16x16x32_bf16 v[92:95], v[44:47], v[164:167], v[92:95]
    ds_read_b64_tr_b16 v[62:63], v10 offset:34656
    s_barrier
    s_waitcnt lgkmcnt(4)
    v_mfma_f32_16x16x32_bf16 v[96:99], v[48:51], v[160:163], v[96:99]
    ds_read_b64_tr_b16 v[168:169], v6 offset:16640
    ds_read_b64_tr_b16 v[170:171], v6 offset:17152
    v_mfma_f32_16x16x32_bf16 v[104:107], v[48:51], v[164:167], v[104:107]
    ds_read_b64_tr_b16 v[172:173], v9 offset:16640
    ds_read_b64_tr_b16 v[174:175], v9 offset:17152
    v_mfma_f32_16x16x32_bf16 v[100:103], v[52:55], v[160:163], v[100:103]
    ds_read_b64_tr_b16 v[32:33], v10 offset:41600
    v_mfma_f32_16x16x32_bf16 v[108:111], v[52:55], v[164:167], v[108:111]
    ds_read_b64_tr_b16 v[34:35], v10 offset:41856
    s_waitcnt lgkmcnt(6)
    v_mfma_f32_16x16x32_bf16 v[112:115], v[56:59], v[160:163], v[112:115]
    ds_read_b64_tr_b16 v[36:37], v10 offset:42624
    ds_read_b64_tr_b16 v[38:39], v10 offset:42880
    v_mfma_f32_16x16x32_bf16 v[120:123], v[56:59], v[164:167], v[120:123]
    ds_read_b64_tr_b16 v[40:41], v10 offset:41632
    ds_read_b64_tr_b16 v[42:43], v10 offset:41888
    v_mfma_f32_16x16x32_bf16 v[116:119], v[60:63], v[160:163], v[116:119]
    ds_read_b64_tr_b16 v[44:45], v10 offset:42656
    v_mfma_f32_16x16x32_bf16 v[124:127], v[60:63], v[164:167], v[124:127]
    ds_read_b64_tr_b16 v[46:47], v10 offset:42912
    s_waitcnt lgkmcnt(4)
    v_mfma_f32_16x16x32_bf16 v[64:67], v[32:35], v[168:171], v[64:67]
    ds_read_b64_tr_b16 v[48:49], v10 offset:41664
    v_mfma_f32_16x16x32_bf16 v[72:75], v[32:35], v[172:175], v[72:75]
    ds_read_b64_tr_b16 v[50:51], v10 offset:41920
    v_mfma_f32_16x16x32_bf16 v[68:71], v[36:39], v[168:171], v[68:71]
    ds_read_b64_tr_b16 v[52:53], v10 offset:42688
    v_mfma_f32_16x16x32_bf16 v[76:79], v[36:39], v[172:175], v[76:79]
    ds_read_b64_tr_b16 v[54:55], v10 offset:42944
    s_waitcnt lgkmcnt(4)
    v_mfma_f32_16x16x32_bf16 v[80:83], v[40:43], v[168:171], v[80:83]
    ds_read_b64_tr_b16 v[56:57], v10 offset:41696
    v_mfma_f32_16x16x32_bf16 v[88:91], v[40:43], v[172:175], v[88:91]
    ds_read_b64_tr_b16 v[58:59], v10 offset:41952
    v_mfma_f32_16x16x32_bf16 v[84:87], v[44:47], v[168:171], v[84:87]
    ds_read_b64_tr_b16 v[60:61], v10 offset:42720
    v_mfma_f32_16x16x32_bf16 v[92:95], v[44:47], v[172:175], v[92:95]
    ds_read_b64_tr_b16 v[62:63], v10 offset:42976
    global_load_dword v31, v30, s[8:9]
    s_barrier
    s_waitcnt lgkmcnt(4)
    v_mfma_f32_16x16x32_bf16 v[96:99], v[48:51], v[168:171], v[96:99]
    ds_read_b64_tr_b16 v[176:177], v6 offset:24960
    ds_read_b64_tr_b16 v[178:179], v6 offset:25472
    v_mfma_f32_16x16x32_bf16 v[104:107], v[48:51], v[172:175], v[104:107]
    ds_read_b64_tr_b16 v[180:181], v9 offset:24960
    ds_read_b64_tr_b16 v[182:183], v9 offset:25472
    v_mfma_f32_16x16x32_bf16 v[100:103], v[52:55], v[168:171], v[100:103]
    ds_read_b64_tr_b16 v[32:33], v10 offset:49920
    v_mfma_f32_16x16x32_bf16 v[108:111], v[52:55], v[172:175], v[108:111]
    ds_read_b64_tr_b16 v[34:35], v10 offset:50176
    s_waitcnt lgkmcnt(6)
    v_mfma_f32_16x16x32_bf16 v[112:115], v[56:59], v[168:171], v[112:115]
    ds_read_b64_tr_b16 v[36:37], v10 offset:50944
    ds_read_b64_tr_b16 v[38:39], v10 offset:51200
    v_mfma_f32_16x16x32_bf16 v[120:123], v[56:59], v[172:175], v[120:123]
    ds_read_b64_tr_b16 v[40:41], v10 offset:49952
    ds_read_b64_tr_b16 v[42:43], v10 offset:50208
    v_mfma_f32_16x16x32_bf16 v[116:119], v[60:63], v[168:171], v[116:119]
    ds_read_b64_tr_b16 v[44:45], v10 offset:50976
    v_mfma_f32_16x16x32_bf16 v[124:127], v[60:63], v[172:175], v[124:127]
    ds_read_b64_tr_b16 v[46:47], v10 offset:51232
    s_waitcnt lgkmcnt(4)
    v_mfma_f32_16x16x32_bf16 v[64:67], v[32:35], v[176:179], v[64:67]
    ds_read_b64_tr_b16 v[48:49], v10 offset:49984
    v_mfma_f32_16x16x32_bf16 v[72:75], v[32:35], v[180:183], v[72:75]
    ds_read_b64_tr_b16 v[50:51], v10 offset:50240
    v_mfma_f32_16x16x32_bf16 v[68:71], v[36:39], v[176:179], v[68:71]
    ds_read_b64_tr_b16 v[52:53], v10 offset:51008
    v_mfma_f32_16x16x32_bf16 v[76:79], v[36:39], v[180:183], v[76:79]
    ds_read_b64_tr_b16 v[54:55], v10 offset:51264
    s_waitcnt lgkmcnt(4)
    v_mfma_f32_16x16x32_bf16 v[80:83], v[40:43], v[176:179], v[80:83]
    ds_read_b64_tr_b16 v[56:57], v10 offset:50016
    v_mfma_f32_16x16x32_bf16 v[88:91], v[40:43], v[180:183], v[88:91]
    ds_read_b64_tr_b16 v[58:59], v10 offset:50272
    v_mfma_f32_16x16x32_bf16 v[84:87], v[44:47], v[176:179], v[84:87]
    ds_read_b64_tr_b16 v[60:61], v10 offset:51040
    v_mfma_f32_16x16x32_bf16 v[92:95], v[44:47], v[180:183], v[92:95]
    ds_read_b64_tr_b16 v[62:63], v10 offset:51296
    s_barrier
    s_waitcnt lgkmcnt(4)
    v_mfma_f32_16x16x32_bf16 v[96:99], v[48:51], v[176:179], v[96:99]
    ds_read_b64_tr_b16 v[184:185], v6 offset:33280
    ds_read_b64_tr_b16 v[186:187], v6 offset:33792
    v_mfma_f32_16x16x32_bf16 v[104:107], v[48:51], v[180:183], v[104:107]
    ds_read_b64_tr_b16 v[188:189], v9 offset:33280
    ds_read_b64_tr_b16 v[190:191], v9 offset:33792
    v_mfma_f32_16x16x32_bf16 v[100:103], v[52:55], v[176:179], v[100:103]
    ds_read_b64_tr_b16 v[32:33], v11 offset:0
    v_mfma_f32_16x16x32_bf16 v[108:111], v[52:55], v[180:183], v[108:111]
    ds_read_b64_tr_b16 v[34:35], v11 offset:256
    s_waitcnt lgkmcnt(6)
    v_mfma_f32_16x16x32_bf16 v[112:115], v[56:59], v[176:179], v[112:115]
    ds_read_b64_tr_b16 v[36:37], v11 offset:1024
    ds_read_b64_tr_b16 v[38:39], v11 offset:1280
    v_mfma_f32_16x16x32_bf16 v[120:123], v[56:59], v[180:183], v[120:123]
    ds_read_b64_tr_b16 v[40:41], v11 offset:32
    ds_read_b64_tr_b16 v[42:43], v11 offset:288
    v_mfma_f32_16x16x32_bf16 v[116:119], v[60:63], v[176:179], v[116:119]
    ds_read_b64_tr_b16 v[44:45], v11 offset:1056
    v_mfma_f32_16x16x32_bf16 v[124:127], v[60:63], v[180:183], v[124:127]
    ds_read_b64_tr_b16 v[46:47], v11 offset:1312
    s_waitcnt lgkmcnt(4)
    v_mfma_f32_16x16x32_bf16 v[64:67], v[32:35], v[184:187], v[64:67]
    ds_read_b64_tr_b16 v[48:49], v11 offset:64
    v_mfma_f32_16x16x32_bf16 v[72:75], v[32:35], v[188:191], v[72:75]
    ds_read_b64_tr_b16 v[50:51], v11 offset:320
    v_mfma_f32_16x16x32_bf16 v[68:71], v[36:39], v[184:187], v[68:71]
    ds_read_b64_tr_b16 v[52:53], v11 offset:1088
    v_mfma_f32_16x16x32_bf16 v[76:79], v[36:39], v[188:191], v[76:79]
    ds_read_b64_tr_b16 v[54:55], v11 offset:1344
    s_waitcnt lgkmcnt(4)
    v_mfma_f32_16x16x32_bf16 v[80:83], v[40:43], v[184:187], v[80:83]
    ds_read_b64_tr_b16 v[56:57], v11 offset:96
    v_mfma_f32_16x16x32_bf16 v[88:91], v[40:43], v[188:191], v[88:91]
    ds_read_b64_tr_b16 v[58:59], v11 offset:352
    v_mfma_f32_16x16x32_bf16 v[84:87], v[44:47], v[184:187], v[84:87]
    ds_read_b64_tr_b16 v[60:61], v11 offset:1120
    v_mfma_f32_16x16x32_bf16 v[92:95], v[44:47], v[188:191], v[92:95]
    ds_read_b64_tr_b16 v[62:63], v11 offset:1376
    s_barrier
    s_waitcnt lgkmcnt(4)
    v_mfma_f32_16x16x32_bf16 v[96:99], v[48:51], v[184:187], v[96:99]
    ds_read_b64_tr_b16 v[192:193], v4 offset:0
    ds_read_b64_tr_b16 v[194:195], v4 offset:512
    v_mfma_f32_16x16x32_bf16 v[104:107], v[48:51], v[188:191], v[104:107]
    ds_read_b64_tr_b16 v[196:197], v7 offset:0
    ds_read_b64_tr_b16 v[198:199], v7 offset:512
    v_mfma_f32_16x16x32_bf16 v[100:103], v[52:55], v[184:187], v[100:103]
    ds_read_b64_tr_b16 v[32:33], v11 offset:8320
    v_mfma_f32_16x16x32_bf16 v[108:111], v[52:55], v[188:191], v[108:111]
    ds_read_b64_tr_b16 v[34:35], v11 offset:8576
    s_waitcnt lgkmcnt(6)
    v_mfma_f32_16x16x32_bf16 v[112:115], v[56:59], v[184:187], v[112:115]
    ds_read_b64_tr_b16 v[36:37], v11 offset:9344
    ds_read_b64_tr_b16 v[38:39], v11 offset:9600
    v_mfma_f32_16x16x32_bf16 v[120:123], v[56:59], v[188:191], v[120:123]
    ds_read_b64_tr_b16 v[40:41], v11 offset:8352
    ds_read_b64_tr_b16 v[42:43], v11 offset:8608
    v_mfma_f32_16x16x32_bf16 v[116:119], v[60:63], v[184:187], v[116:119]
    ds_read_b64_tr_b16 v[44:45], v11 offset:9376
    v_mfma_f32_16x16x32_bf16 v[124:127], v[60:63], v[188:191], v[124:127]
    ds_read_b64_tr_b16 v[46:47], v11 offset:9632
    s_waitcnt lgkmcnt(4)
    v_mfma_f32_16x16x32_bf16 v[64:67], v[32:35], v[192:195], v[64:67]
    ds_read_b64_tr_b16 v[48:49], v11 offset:8384
    v_mfma_f32_16x16x32_bf16 v[72:75], v[32:35], v[196:199], v[72:75]
    ds_read_b64_tr_b16 v[50:51], v11 offset:8640
    v_mfma_f32_16x16x32_bf16 v[68:71], v[36:39], v[192:195], v[68:71]
    ds_read_b64_tr_b16 v[52:53], v11 offset:9408
    v_mfma_f32_16x16x32_bf16 v[76:79], v[36:39], v[196:199], v[76:79]
    ds_read_b64_tr_b16 v[54:55], v11 offset:9664
    s_waitcnt lgkmcnt(4)
    v_mfma_f32_16x16x32_bf16 v[80:83], v[40:43], v[192:195], v[80:83]
    ds_read_b64_tr_b16 v[56:57], v11 offset:8416
    v_mfma_f32_16x16x32_bf16 v[88:91], v[40:43], v[196:199], v[88:91]
    ds_read_b64_tr_b16 v[58:59], v11 offset:8672
    v_mfma_f32_16x16x32_bf16 v[84:87], v[44:47], v[192:195], v[84:87]
    ds_read_b64_tr_b16 v[60:61], v11 offset:9440
    v_mfma_f32_16x16x32_bf16 v[92:95], v[44:47], v[196:199], v[92:95]
    ds_read_b64_tr_b16 v[62:63], v11 offset:9696
    s_barrier
    s_waitcnt lgkmcnt(4)
    v_mfma_f32_16x16x32_bf16 v[96:99], v[48:51], v[192:195], v[96:99]
    ds_read_b64_tr_b16 v[200:201], v5 offset:24960
    ds_read_b64_tr_b16 v[202:203], v5 offset:25472
    v_mfma_f32_16x16x32_bf16 v[104:107], v[48:51], v[196:199], v[104:107]
    ds_read_b64_tr_b16 v[204:205], v8 offset:24960
    ds_read_b64_tr_b16 v[206:207], v8 offset:25472
    v_mfma_f32_16x16x32_bf16 v[100:103], v[52:55], v[192:195], v[100:103]
    ds_read_b64_tr_b16 v[32:33], v11 offset:16640
    v_mfma_f32_16x16x32_bf16 v[108:111], v[52:55], v[196:199], v[108:111]
    ds_read_b64_tr_b16 v[34:35], v11 offset:16896
    s_waitcnt lgkmcnt(6)
    v_mfma_f32_16x16x32_bf16 v[112:115], v[56:59], v[192:195], v[112:115]
    ds_read_b64_tr_b16 v[36:37], v11 offset:17664
    ds_read_b64_tr_b16 v[38:39], v11 offset:17920
    v_mfma_f32_16x16x32_bf16 v[120:123], v[56:59], v[196:199], v[120:123]
    ds_read_b64_tr_b16 v[40:41], v11 offset:16672
    ds_read_b64_tr_b16 v[42:43], v11 offset:16928
    v_mfma_f32_16x16x32_bf16 v[116:119], v[60:63], v[192:195], v[116:119]
    ds_read_b64_tr_b16 v[44:45], v11 offset:17696
    v_mfma_f32_16x16x32_bf16 v[124:127], v[60:63], v[196:199], v[124:127]
    ds_read_b64_tr_b16 v[46:47], v11 offset:17952
    s_waitcnt lgkmcnt(4)
    v_mfma_f32_16x16x32_bf16 v[64:67], v[32:35], v[200:203], v[64:67]
    ds_read_b64_tr_b16 v[48:49], v11 offset:16704
    v_mfma_f32_16x16x32_bf16 v[72:75], v[32:35], v[204:207], v[72:75]
    ds_read_b64_tr_b16 v[50:51], v11 offset:16960
    v_mfma_f32_16x16x32_bf16 v[68:71], v[36:39], v[200:203], v[68:71]
    ds_read_b64_tr_b16 v[52:53], v11 offset:17728
    v_mfma_f32_16x16x32_bf16 v[76:79], v[36:39], v[204:207], v[76:79]
    ds_read_b64_tr_b16 v[54:55], v11 offset:17984
    s_waitcnt lgkmcnt(4)
    v_mfma_f32_16x16x32_bf16 v[80:83], v[40:43], v[200:203], v[80:83]
    ds_read_b64_tr_b16 v[56:57], v11 offset:16736
    v_mfma_f32_16x16x32_bf16 v[88:91], v[40:43], v[204:207], v[88:91]
    ds_read_b64_tr_b16 v[58:59], v11 offset:16992
    v_mfma_f32_16x16x32_bf16 v[84:87], v[44:47], v[200:203], v[84:87]
    ds_read_b64_tr_b16 v[60:61], v11 offset:17760
    v_mfma_f32_16x16x32_bf16 v[92:95], v[44:47], v[204:207], v[92:95]
    ds_read_b64_tr_b16 v[62:63], v11 offset:18016
    s_barrier
    s_waitcnt lgkmcnt(4)
    v_mfma_f32_16x16x32_bf16 v[96:99], v[48:51], v[200:203], v[96:99]
    ds_read_b64_tr_b16 v[208:209], v4 offset:8320
    ds_read_b64_tr_b16 v[210:211], v4 offset:8832
    v_mfma_f32_16x16x32_bf16 v[104:107], v[48:51], v[204:207], v[104:107]
    ds_read_b64_tr_b16 v[212:213], v7 offset:8320
    ds_read_b64_tr_b16 v[214:215], v7 offset:8832
    v_mfma_f32_16x16x32_bf16 v[100:103], v[52:55], v[200:203], v[100:103]
    ds_read_b64_tr_b16 v[32:33], v11 offset:41600
    v_mfma_f32_16x16x32_bf16 v[108:111], v[52:55], v[204:207], v[108:111]
    ds_read_b64_tr_b16 v[34:35], v11 offset:41856
    s_waitcnt lgkmcnt(6)
    v_mfma_f32_16x16x32_bf16 v[112:115], v[56:59], v[200:203], v[112:115]
    ds_read_b64_tr_b16 v[36:37], v11 offset:42624
    ds_read_b64_tr_b16 v[38:39], v11 offset:42880
    v_mfma_f32_16x16x32_bf16 v[120:123], v[56:59], v[204:207], v[120:123]
    ds_read_b64_tr_b16 v[40:41], v11 offset:41632
    ds_read_b64_tr_b16 v[42:43], v11 offset:41888
    v_mfma_f32_16x16x32_bf16 v[116:119], v[60:63], v[200:203], v[116:119]
    ds_read_b64_tr_b16 v[44:45], v11 offset:42656
    v_mfma_f32_16x16x32_bf16 v[124:127], v[60:63], v[204:207], v[124:127]
    ds_read_b64_tr_b16 v[46:47], v11 offset:42912
    s_waitcnt lgkmcnt(4)
    v_mfma_f32_16x16x32_bf16 v[64:67], v[32:35], v[208:211], v[64:67]
    ds_read_b64_tr_b16 v[48:49], v11 offset:41664
    v_mfma_f32_16x16x32_bf16 v[72:75], v[32:35], v[212:215], v[72:75]
    ds_read_b64_tr_b16 v[50:51], v11 offset:41920
    v_mfma_f32_16x16x32_bf16 v[68:71], v[36:39], v[208:211], v[68:71]
    ds_read_b64_tr_b16 v[52:53], v11 offset:42688
    v_mfma_f32_16x16x32_bf16 v[76:79], v[36:39], v[212:215], v[76:79]
    ds_read_b64_tr_b16 v[54:55], v11 offset:42944
    s_waitcnt lgkmcnt(4)
    v_mfma_f32_16x16x32_bf16 v[80:83], v[40:43], v[208:211], v[80:83]
    ds_read_b64_tr_b16 v[56:57], v11 offset:41696
    v_mfma_f32_16x16x32_bf16 v[88:91], v[40:43], v[212:215], v[88:91]
    ds_read_b64_tr_b16 v[58:59], v11 offset:41952
    v_mfma_f32_16x16x32_bf16 v[84:87], v[44:47], v[208:211], v[84:87]
    ds_read_b64_tr_b16 v[60:61], v11 offset:42720
    v_mfma_f32_16x16x32_bf16 v[92:95], v[44:47], v[212:215], v[92:95]
    ds_read_b64_tr_b16 v[62:63], v11 offset:42976
    s_barrier
    s_waitcnt lgkmcnt(4)
    v_mfma_f32_16x16x32_bf16 v[96:99], v[48:51], v[208:211], v[96:99]
    ds_read_b64_tr_b16 v[216:217], v5 offset:33280
    ds_read_b64_tr_b16 v[218:219], v5 offset:33792
    v_mfma_f32_16x16x32_bf16 v[104:107], v[48:51], v[212:215], v[104:107]
    ds_read_b64_tr_b16 v[220:221], v8 offset:33280
    ds_read_b64_tr_b16 v[222:223], v8 offset:33792
    v_mfma_f32_16x16x32_bf16 v[100:103], v[52:55], v[208:211], v[100:103]
    ds_read_b64_tr_b16 v[32:33], v10 offset:16640
    v_mfma_f32_16x16x32_bf16 v[108:111], v[52:55], v[212:215], v[108:111]
    ds_read_b64_tr_b16 v[34:35], v10 offset:16896
    s_waitcnt lgkmcnt(6)
    v_mfma_f32_16x16x32_bf16 v[112:115], v[56:59], v[208:211], v[112:115]
    ds_read_b64_tr_b16 v[36:37], v10 offset:17664
    ds_read_b64_tr_b16 v[38:39], v10 offset:17920
    v_mfma_f32_16x16x32_bf16 v[120:123], v[56:59], v[212:215], v[120:123]
    ds_read_b64_tr_b16 v[40:41], v10 offset:16672
    ds_read_b64_tr_b16 v[42:43], v10 offset:16928
    v_mfma_f32_16x16x32_bf16 v[116:119], v[60:63], v[208:211], v[116:119]
    ds_read_b64_tr_b16 v[44:45], v10 offset:17696
    v_mfma_f32_16x16x32_bf16 v[124:127], v[60:63], v[212:215], v[124:127]
    ds_read_b64_tr_b16 v[46:47], v10 offset:17952
    s_waitcnt lgkmcnt(4)
    v_mfma_f32_16x16x32_bf16 v[64:67], v[32:35], v[216:219], v[64:67]
    ds_read_b64_tr_b16 v[48:49], v10 offset:16704
    v_mfma_f32_16x16x32_bf16 v[72:75], v[32:35], v[220:223], v[72:75]
    ds_read_b64_tr_b16 v[50:51], v10 offset:16960
    v_mfma_f32_16x16x32_bf16 v[68:71], v[36:39], v[216:219], v[68:71]
    ds_read_b64_tr_b16 v[52:53], v10 offset:17728
    v_mfma_f32_16x16x32_bf16 v[76:79], v[36:39], v[220:223], v[76:79]
    ds_read_b64_tr_b16 v[54:55], v10 offset:17984
    s_waitcnt lgkmcnt(4)
    v_mfma_f32_16x16x32_bf16 v[80:83], v[40:43], v[216:219], v[80:83]
    ds_read_b64_tr_b16 v[56:57], v10 offset:16736
    v_mfma_f32_16x16x32_bf16 v[88:91], v[40:43], v[220:223], v[88:91]
    ds_read_b64_tr_b16 v[58:59], v10 offset:16992
    v_mfma_f32_16x16x32_bf16 v[84:87], v[44:47], v[216:219], v[84:87]
    ds_read_b64_tr_b16 v[60:61], v10 offset:17760
    v_mfma_f32_16x16x32_bf16 v[92:95], v[44:47], v[220:223], v[92:95]
    ds_read_b64_tr_b16 v[62:63], v10 offset:18016
    s_barrier
    s_waitcnt lgkmcnt(4)
    v_mfma_f32_16x16x32_bf16 v[96:99], v[48:51], v[216:219], v[96:99]
    ds_read_b64_tr_b16 v[224:225], v5 offset:49920
    ds_read_b64_tr_b16 v[226:227], v5 offset:50432
    v_mfma_f32_16x16x32_bf16 v[104:107], v[48:51], v[220:223], v[104:107]
    ds_read_b64_tr_b16 v[228:229], v8 offset:49920
    ds_read_b64_tr_b16 v[230:231], v8 offset:50432
    v_mfma_f32_16x16x32_bf16 v[100:103], v[52:55], v[216:219], v[100:103]
    ds_read_b64_tr_b16 v[32:33], v10 offset:24960
    v_mfma_f32_16x16x32_bf16 v[108:111], v[52:55], v[220:223], v[108:111]
    ds_read_b64_tr_b16 v[34:35], v10 offset:25216
    s_waitcnt lgkmcnt(6)
    v_mfma_f32_16x16x32_bf16 v[112:115], v[56:59], v[216:219], v[112:115]
    ds_read_b64_tr_b16 v[36:37], v10 offset:25984
    ds_read_b64_tr_b16 v[38:39], v10 offset:26240
    v_mfma_f32_16x16x32_bf16 v[120:123], v[56:59], v[220:223], v[120:123]
    ds_read_b64_tr_b16 v[40:41], v10 offset:24992
    ds_read_b64_tr_b16 v[42:43], v10 offset:25248
    v_mfma_f32_16x16x32_bf16 v[116:119], v[60:63], v[216:219], v[116:119]
    ds_read_b64_tr_b16 v[44:45], v10 offset:26016
    v_mfma_f32_16x16x32_bf16 v[124:127], v[60:63], v[220:223], v[124:127]
    ds_read_b64_tr_b16 v[46:47], v10 offset:26272
    s_waitcnt lgkmcnt(4)
    v_mfma_f32_16x16x32_bf16 v[64:67], v[32:35], v[224:227], v[64:67]
    ds_read_b64_tr_b16 v[48:49], v10 offset:25024
    v_mfma_f32_16x16x32_bf16 v[72:75], v[32:35], v[228:231], v[72:75]
    ds_read_b64_tr_b16 v[50:51], v10 offset:25280
    v_mfma_f32_16x16x32_bf16 v[68:71], v[36:39], v[224:227], v[68:71]
    ds_read_b64_tr_b16 v[52:53], v10 offset:26048
    v_mfma_f32_16x16x32_bf16 v[76:79], v[36:39], v[228:231], v[76:79]
    ds_read_b64_tr_b16 v[54:55], v10 offset:26304
    s_waitcnt lgkmcnt(4)
    v_mfma_f32_16x16x32_bf16 v[80:83], v[40:43], v[224:227], v[80:83]
    ds_read_b64_tr_b16 v[56:57], v10 offset:25056
    v_mfma_f32_16x16x32_bf16 v[88:91], v[40:43], v[228:231], v[88:91]
    ds_read_b64_tr_b16 v[58:59], v10 offset:25312
    v_mfma_f32_16x16x32_bf16 v[84:87], v[44:47], v[224:227], v[84:87]
    ds_read_b64_tr_b16 v[60:61], v10 offset:26080
    v_mfma_f32_16x16x32_bf16 v[92:95], v[44:47], v[228:231], v[92:95]
    ds_read_b64_tr_b16 v[62:63], v10 offset:26336
    buffer_load_dwordx2 v[14:15], v26, s[40:43], s56 offen offset:0 sc1
    buffer_load_dwordx2 v[16:17], v26, s[40:43], s56 offen offset:128 sc1
    s_barrier
    s_waitcnt lgkmcnt(4)
    v_mfma_f32_16x16x32_bf16 v[96:99], v[48:51], v[224:227], v[96:99]
    ds_read_b64_tr_b16 v[232:233], v6 offset:0
    ds_read_b64_tr_b16 v[234:235], v6 offset:512
    v_mfma_f32_16x16x32_bf16 v[104:107], v[48:51], v[228:231], v[104:107]
    ds_read_b64_tr_b16 v[236:237], v9 offset:0
    ds_read_b64_tr_b16 v[238:239], v9 offset:512
    v_mfma_f32_16x16x32_bf16 v[100:103], v[52:55], v[224:227], v[100:103]
    ds_read_b64_tr_b16 v[32:33], v10 offset:33280
    v_mfma_f32_16x16x32_bf16 v[108:111], v[52:55], v[228:231], v[108:111]
    ds_read_b64_tr_b16 v[34:35], v10 offset:33536
    s_waitcnt lgkmcnt(6)
    v_mfma_f32_16x16x32_bf16 v[112:115], v[56:59], v[224:227], v[112:115]
    ds_read_b64_tr_b16 v[36:37], v10 offset:34304
HOP_5:
    s_cbranch_execz HOP_9
    ds_read_b64_tr_b16 v[38:39], v10 offset:34560
    v_mfma_f32_16x16x32_bf16 v[120:123], v[56:59], v[228:231], v[120:123]
    ds_read_b64_tr_b16 v[40:41], v10 offset:33312
    ds_read_b64_tr_b16 v[42:43], v10 offset:33568
    v_mfma_f32_16x16x32_bf16 v[116:119], v[60:63], v[224:227], v[116:119]
    ds_read_b64_tr_b16 v[44:45], v10 offset:34336
    v_mfma_f32_16x16x32_bf16 v[124:127], v[60:63], v[228:231], v[124:127]
    ds_read_b64_tr_b16 v[46:47], v10 offset:34592
    s_waitcnt lgkmcnt(4)
    v_mfma_f32_16x16x32_bf16 v[64:67], v[32:35], v[232:235], v[64:67]
    ds_read_b64_tr_b16 v[48:49], v10 offset:33344
    v_mfma_f32_16x16x32_bf16 v[72:75], v[32:35], v[236:239], v[72:75]
    ds_read_b64_tr_b16 v[50:51], v10 offset:33600
    v_mfma_f32_16x16x32_bf16 v[68:71], v[36:39], v[232:235], v[68:71]
    ds_read_b64_tr_b16 v[52:53], v10 offset:34368
    v_mfma_f32_16x16x32_bf16 v[76:79], v[36:39], v[236:239], v[76:79]
    ds_read_b64_tr_b16 v[54:55], v10 offset:34624
    s_waitcnt lgkmcnt(4)
    v_mfma_f32_16x16x32_bf16 v[80:83], v[40:43], v[232:235], v[80:83]
    ds_read_b64_tr_b16 v[56:57], v10 offset:33376
    v_mfma_f32_16x16x32_bf16 v[88:91], v[40:43], v[236:239], v[88:91]
    ds_read_b64_tr_b16 v[58:59], v10 offset:33632
    v_mfma_f32_16x16x32_bf16 v[84:87], v[44:47], v[232:235], v[84:87]
    ds_read_b64_tr_b16 v[60:61], v10 offset:34400
    v_mfma_f32_16x16x32_bf16 v[92:95], v[44:47], v[236:239], v[92:95]
    ds_read_b64_tr_b16 v[62:63], v10 offset:34656
    s_barrier
    s_waitcnt lgkmcnt(4)
    v_mfma_f32_16x16x32_bf16 v[96:99], v[48:51], v[232:235], v[96:99]
    ds_read_b64_tr_b16 v[240:241], v6 offset:8320
    ds_read_b64_tr_b16 v[242:243], v6 offset:8832
    v_mfma_f32_16x16x32_bf16 v[104:107], v[48:51], v[236:239], v[104:107]
    ds_read_b64_tr_b16 v[244:245], v9 offset:8320
    ds_read_b64_tr_b16 v[246:247], v9 offset:8832
    v_mfma_f32_16x16x32_bf16 v[100:103], v[52:55], v[232:235], v[100:103]
    ds_read_b64_tr_b16 v[32:33], v10 offset:41600
    v_mfma_f32_16x16x32_bf16 v[108:111], v[52:55], v[236:239], v[108:111]
    ds_read_b64_tr_b16 v[34:35], v10 offset:41856
    s_waitcnt lgkmcnt(6)
    v_mfma_f32_16x16x32_bf16 v[112:115], v[56:59], v[232:235], v[112:115]
    ds_read_b64_tr_b16 v[36:37], v10 offset:42624
    ds_read_b64_tr_b16 v[38:39], v10 offset:42880
    v_mfma_f32_16x16x32_bf16 v[120:123], v[56:59], v[236:239], v[120:123]
    ds_read_b64_tr_b16 v[40:41], v10 offset:41632
    ds_read_b64_tr_b16 v[42:43], v10 offset:41888
    v_mfma_f32_16x16x32_bf16 v[116:119], v[60:63], v[232:235], v[116:119]
    ds_read_b64_tr_b16 v[44:45], v10 offset:42656
    v_mfma_f32_16x16x32_bf16 v[124:127], v[60:63], v[236:239], v[124:127]
    ds_read_b64_tr_b16 v[46:47], v10 offset:42912
    s_waitcnt lgkmcnt(4)
    v_mfma_f32_16x16x32_bf16 v[64:67], v[32:35], v[240:243], v[64:67]
    ds_read_b64_tr_b16 v[48:49], v10 offset:41664
    v_mfma_f32_16x16x32_bf16 v[72:75], v[32:35], v[244:247], v[72:75]
    ds_read_b64_tr_b16 v[50:51], v10 offset:41920
    v_mfma_f32_16x16x32_bf16 v[68:71], v[36:39], v[240:243], v[68:71]
    ds_read_b64_tr_b16 v[52:53], v10 offset:42688
    v_mfma_f32_16x16x32_bf16 v[76:79], v[36:39], v[244:247], v[76:79]
    ds_read_b64_tr_b16 v[54:55], v10 offset:42944
    s_waitcnt lgkmcnt(4)
    v_mfma_f32_16x16x32_bf16 v[80:83], v[40:43], v[240:243], v[80:83]
    ds_read_b64_tr_b16 v[56:57], v10 offset:41696
    v_mfma_f32_16x16x32_bf16 v[88:91], v[40:43], v[244:247], v[88:91]
    ds_read_b64_tr_b16 v[58:59], v10 offset:41952
    v_mfma_f32_16x16x32_bf16 v[84:87], v[44:47], v[240:243], v[84:87]
    ds_read_b64_tr_b16 v[60:61], v10 offset:42720
    v_mfma_f32_16x16x32_bf16 v[92:95], v[44:47], v[244:247], v[92:95]
    ds_read_b64_tr_b16 v[62:63], v10 offset:42976
    s_barrier
    s_waitcnt lgkmcnt(4)
    v_mfma_f32_16x16x32_bf16 v[96:99], v[48:51], v[240:243], v[96:99]
    ds_read_b64_tr_b16 v[248:249], v6 offset:16640
    ds_read_b64_tr_b16 v[250:251], v6 offset:17152
    v_mfma_f32_16x16x32_bf16 v[104:107], v[48:51], v[244:247], v[104:107]
    ds_read_b64_tr_b16 v[252:253], v9 offset:16640
    ds_read_b64_tr_b16 v[254:255], v9 offset:17152
    v_mfma_f32_16x16x32_bf16 v[100:103], v[52:55], v[240:243], v[100:103]
    ds_read_b64_tr_b16 v[32:33], v10 offset:49920
    v_mfma_f32_16x16x32_bf16 v[108:111], v[52:55], v[244:247], v[108:111]
    ds_read_b64_tr_b16 v[34:35], v10 offset:50176
    s_waitcnt lgkmcnt(6)
    v_mfma_f32_16x16x32_bf16 v[112:115], v[56:59], v[240:243], v[112:115]
    ds_read_b64_tr_b16 v[36:37], v10 offset:50944
    ds_read_b64_tr_b16 v[38:39], v10 offset:51200
    v_mfma_f32_16x16x32_bf16 v[120:123], v[56:59], v[244:247], v[120:123]
    ds_read_b64_tr_b16 v[40:41], v10 offset:49952
    ds_read_b64_tr_b16 v[42:43], v10 offset:50208
    v_mfma_f32_16x16x32_bf16 v[116:119], v[60:63], v[240:243], v[116:119]
    ds_read_b64_tr_b16 v[44:45], v10 offset:50976
    v_mfma_f32_16x16x32_bf16 v[124:127], v[60:63], v[244:247], v[124:127]
    ds_read_b64_tr_b16 v[46:47], v10 offset:51232
    s_waitcnt lgkmcnt(4)
    v_mfma_f32_16x16x32_bf16 v[64:67], v[32:35], v[248:251], v[64:67]
    ds_read_b64_tr_b16 v[48:49], v10 offset:49984
    v_mfma_f32_16x16x32_bf16 v[72:75], v[32:35], v[252:255], v[72:75]
    ds_read_b64_tr_b16 v[50:51], v10 offset:50240
    v_mfma_f32_16x16x32_bf16 v[68:71], v[36:39], v[248:251], v[68:71]
    ds_read_b64_tr_b16 v[52:53], v10 offset:51008
    v_mfma_f32_16x16x32_bf16 v[76:79], v[36:39], v[252:255], v[76:79]
    ds_read_b64_tr_b16 v[54:55], v10 offset:51264
    s_waitcnt lgkmcnt(4)
    v_mfma_f32_16x16x32_bf16 v[80:83], v[40:43], v[248:251], v[80:83]
    ds_read_b64_tr_b16 v[56:57], v10 offset:50016
    v_mfma_f32_16x16x32_bf16 v[88:91], v[40:43], v[252:255], v[88:91]
    ds_read_b64_tr_b16 v[58:59], v10 offset:50272
    v_mfma_f32_16x16x32_bf16 v[84:87], v[44:47], v[248:251], v[84:87]
    ds_read_b64_tr_b16 v[60:61], v10 offset:51040
    v_mfma_f32_16x16x32_bf16 v[92:95], v[44:47], v[252:255], v[92:95]
    ds_read_b64_tr_b16 v[62:63], v10 offset:51296
    s_waitcnt vmcnt(0)
    v_min_u32 v30, v15, v17
    v_cmp_eq_u32 vcc, 0, v30
    s_nop 4
    s_cbranch_vccz KF_st_ok
KF_st_lp:
    buffer_load_dwordx2 v[14:15], v26, s[40:43], s56 offen offset:0 sc1
    buffer_load_dwordx2 v[16:17], v26, s[40:43], s56 offen offset:128 sc1
    s_add_u32 s68, s68, 1
    s_waitcnt vmcnt(0)
    v_min_u32 v30, v15, v17
    v_cmp_eq_u32 vcc, 0, v30
    s_cmp_gt_u32 s68, 0x20000
    s_cbranch_scc1 KF_st_ok
    s_nop 3
    s_cbranch_vccnz KF_st_lp
KF_st_ok:
    v_mul_f32 v18, v15, v15
    v_rcp_f32 v15, v15
    v_mul_f32 v19, v17, v17
    v_rcp_f32 v17, v17
    v_mul_f32 v15, 0xbfb8aa3b, v15
    v_mul_f32 v17, 0xbfb8aa3b, v17
    s_waitcnt lgkmcnt(4)
    v_mfma_f32_16x16x32_bf16 v[96:99], v[48:51], v[248:251], v[96:99]
    v_mfma_f32_16x16x32_bf16 v[104:107], v[48:51], v[252:255], v[104:107]
    v_mfma_f32_16x16x32_bf16 v[100:103], v[52:55], v[248:251], v[100:103]
    v_mfma_f32_16x16x32_bf16 v[108:111], v[52:55], v[252:255], v[108:111]
    s_waitcnt lgkmcnt(0)
    s_barrier
    v_mfma_f32_16x16x32_bf16 v[112:115], v[56:59], v[248:251], v[112:115]
    ds_read_b128 v[32:35], v27 offset:0
    ds_read_b128 v[36:39], v27 offset:64
    ds_read_b128 v[40:43], v27 offset:512
    ds_read_b128 v[44:47], v27 offset:576
    v_mfma_f32_16x16x32_bf16 v[120:123], v[56:59], v[252:255], v[120:123]
    v_mfma_f32_16x16x32_bf16 v[116:119], v[60:63], v[248:251], v[116:119]
    v_mfma_f32_16x16x32_bf16 v[124:127], v[60:63], v[252:255], v[124:127]
    s_waitcnt lgkmcnt(2)
    v_pk_fma_f32 v[64:65], v[32:33], v[14:15], v[64:65] op_sel_hi:[1,0,1] neg_lo:[1,0,0] neg_hi:[1,0,0]
    v_pk_fma_f32 v[66:67], v[34:35], v[14:15], v[66:67] op_sel_hi:[1,0,1] neg_lo:[1,0,0] neg_hi:[1,0,0]
    v_pk_fma_f32 v[80:81], v[36:37], v[14:15], v[80:81] op_sel_hi:[1,0,1] neg_lo:[1,0,0] neg_hi:[1,0,0]
    v_pk_fma_f32 v[82:83], v[38:39], v[14:15], v[82:83] op_sel_hi:[1,0,1] neg_lo:[1,0,0] neg_hi:[1,0,0]
    ds_read_b128 v[48:51], v27 offset:128
    ds_read_b128 v[52:55], v27 offset:192
    v_pk_mul_f32 v[56:57], v[64:65], v[14:15] op_sel:[0,1] op_sel_hi:[1,1]
    v_pk_mul_f32 v[58:59], v[66:67], v[14:15] op_sel:[0,1] op_sel_hi:[1,1]
    v_pk_mul_f32 v[60:61], v[80:81], v[14:15] op_sel:[0,1] op_sel_hi:[1,1]
    v_pk_mul_f32 v[62:63], v[82:83], v[14:15] op_sel:[0,1] op_sel_hi:[1,1]
    v_exp_f32 v56, v56
    v_exp_f32 v57, v57
    s_waitcnt lgkmcnt(2)
    v_pk_fma_f32 v[68:69], v[40:41], v[14:15], v[68:69] op_sel_hi:[1,0,1] neg_lo:[1,0,0] neg_hi:[1,0,0]
    v_exp_f32 v58, v58
    v_exp_f32 v59, v59
    v_pk_fma_f32 v[70:71], v[42:43], v[14:15], v[70:71] op_sel_hi:[1,0,1] neg_lo:[1,0,0] neg_hi:[1,0,0]
    v_exp_f32 v60, v60
    v_exp_f32 v61, v61
    v_pk_fma_f32 v[84:85], v[44:45], v[14:15], v[84:85] op_sel_hi:[1,0,1] neg_lo:[1,0,0] neg_hi:[1,0,0]
    v_exp_f32 v62, v62
    v_exp_f32 v63, v63
    v_pk_fma_f32 v[86:87], v[46:47], v[14:15], v[86:87] op_sel_hi:[1,0,1] neg_lo:[1,0,0] neg_hi:[1,0,0]
    v_pk_fma_f32 v[56:57], v[56:57], v[18:19], v[18:19] op_sel:[0,0,0] op_sel_hi:[1,0,0]
    v_pk_fma_f32 v[58:59], v[58:59], v[18:19], v[18:19] op_sel:[0,0,0] op_sel_hi:[1,0,0]
    v_pk_fma_f32 v[60:61], v[60:61], v[18:19], v[18:19] op_sel:[0,0,0] op_sel_hi:[1,0,0]
    v_pk_fma_f32 v[62:63], v[62:63], v[18:19], v[18:19] op_sel:[0,0,0] op_sel_hi:[1,0,0]
    v_rcp_f32 v56, v56
    v_rcp_f32 v57, v57
    v_pk_mul_f32 v[64:65], v[64:65], v[68:69]
    v_rcp_f32 v58, v58
    v_rcp_f32 v59, v59
    v_pk_mul_f32 v[66:67], v[66:67], v[70:71]
    v_rcp_f32 v60, v60
    v_rcp_f32 v61, v61
    v_pk_mul_f32 v[80:81], v[80:81], v[84:85]
    v_rcp_f32 v62, v62
    v_rcp_f32 v63, v63
    v_pk_mul_f32 v[82:83], v[82:83], v[86:87]
    v_pk_mul_f32 v[64:65], v[64:65], v[56:57]
    v_pk_mul_f32 v[66:67], v[66:67], v[58:59]
    v_pk_mul_f32 v[80:81], v[80:81], v[60:61]
    v_pk_mul_f32 v[82:83], v[82:83], v[62:63]
    v_cvt_pk_bf16_f32 v84, v64, v65
    v_cvt_pk_bf16_f32 v85, v66, v67
    v_cvt_pk_bf16_f32 v86, v80, v81
    v_cvt_pk_bf16_f32 v87, v82, v83
    buffer_store_dwordx4 v[84:87], v3, s[36:39], s57 offen offset:0 sc1
    v_pk_fma_f32 v[72:73], v[32:33], v[16:17], v[72:73] op_sel_hi:[1,0,1] neg_lo:[1,0,0] neg_hi:[1,0,0]
    v_pk_fma_f32 v[74:75], v[34:35], v[16:17], v[74:75] op_sel_hi:[1,0,1] neg_lo:[1,0,0] neg_hi:[1,0,0]
    v_pk_fma_f32 v[88:89], v[36:37], v[16:17], v[88:89] op_sel_hi:[1,0,1] neg_lo:[1,0,0] neg_hi:[1,0,0]
    v_pk_fma_f32 v[90:91], v[38:39], v[16:17], v[90:91] op_sel_hi:[1,0,1] neg_lo:[1,0,0] neg_hi:[1,0,0]
    v_pk_mul_f32 v[56:57], v[72:73], v[16:17] op_sel:[0,1] op_sel_hi:[1,1]
    v_pk_mul_f32 v[58:59], v[74:75], v[16:17] op_sel:[0,1] op_sel_hi:[1,1]
    v_pk_mul_f32 v[60:61], v[88:89], v[16:17] op_sel:[0,1] op_sel_hi:[1,1]
    v_pk_mul_f32 v[62:63], v[90:91], v[16:17] op_sel:[0,1] op_sel_hi:[1,1]
    v_exp_f32 v56, v56
    v_exp_f32 v57, v57
    v_pk_fma_f32 v[76:77], v[40:41], v[16:17], v[76:77] op_sel_hi:[1,0,1] neg_lo:[1,0,0] neg_hi:[1,0,0]
    v_exp_f32 v58, v58
    v_exp_f32 v59, v59
    v_pk_fma_f32 v[78:79], v[42:43], v[16:17], v[78:79] op_sel_hi:[1,0,1] neg_lo:[1,0,0] neg_hi:[1,0,0]
    v_exp_f32 v60, v60
    v_exp_f32 v61, v61
    v_pk_fma_f32 v[92:93], v[44:45], v[16:17], v[92:93] op_sel_hi:[1,0,1] neg_lo:[1,0,0] neg_hi:[1,0,0]
    v_exp_f32 v62, v62
    v_exp_f32 v63, v63
    v_pk_fma_f32 v[94:95], v[46:47], v[16:17], v[94:95] op_sel_hi:[1,0,1] neg_lo:[1,0,0] neg_hi:[1,0,0]
    ds_read_b128 v[40:43], v27 offset:640
    ds_read_b128 v[44:47], v27 offset:704
    v_pk_fma_f32 v[56:57], v[56:57], v[18:19], v[18:19] op_sel:[0,1,1] op_sel_hi:[1,1,1]
    v_pk_fma_f32 v[58:59], v[58:59], v[18:19], v[18:19] op_sel:[0,1,1] op_sel_hi:[1,1,1]
    v_pk_fma_f32 v[60:61], v[60:61], v[18:19], v[18:19] op_sel:[0,1,1] op_sel_hi:[1,1,1]
    v_pk_fma_f32 v[62:63], v[62:63], v[18:19], v[18:19] op_sel:[0,1,1] op_sel_hi:[1,1,1]
    v_rcp_f32 v56, v56
    v_rcp_f32 v57, v57
    v_pk_mul_f32 v[72:73], v[72:73], v[76:77]
    v_rcp_f32 v58, v58
    v_rcp_f32 v59, v59
    v_pk_mul_f32 v[74:75], v[74:75], v[78:79]
    v_rcp_f32 v60, v60
    v_rcp_f32 v61, v61
    v_pk_mul_f32 v[88:89], v[88:89], v[92:93]
    v_rcp_f32 v62, v62
    v_rcp_f32 v63, v63
    v_pk_mul_f32 v[90:91], v[90:91], v[94:95]
    v_pk_mul_f32 v[72:73], v[72:73], v[56:57]
    v_pk_mul_f32 v[74:75], v[74:75], v[58:59]
    v_pk_mul_f32 v[88:89], v[88:89], v[60:61]
    v_pk_mul_f32 v[90:91], v[90:91], v[62:63]
    v_cvt_pk_bf16_f32 v92, v72, v73
    v_cvt_pk_bf16_f32 v93, v74, v75
    v_cvt_pk_bf16_f32 v94, v88, v89
    v_cvt_pk_bf16_f32 v95, v90, v91
    buffer_store_dwordx4 v[92:95], v3, s[36:39], s57 offen offset:1024 sc1
    s_waitcnt lgkmcnt(2)
    v_pk_fma_f32 v[96:97], v[48:49], v[14:15], v[96:97] op_sel_hi:[1,0,1] neg_lo:[1,0,0] neg_hi:[1,0,0]
    v_pk_fma_f32 v[98:99], v[50:51], v[14:15], v[98:99] op_sel_hi:[1,0,1] neg_lo:[1,0,0] neg_hi:[1,0,0]
    v_pk_fma_f32 v[112:113], v[52:53], v[14:15], v[112:113] op_sel_hi:[1,0,1] neg_lo:[1,0,0] neg_hi:[1,0,0]
    v_pk_fma_f32 v[114:115], v[54:55], v[14:15], v[114:115] op_sel_hi:[1,0,1] neg_lo:[1,0,0] neg_hi:[1,0,0]
    v_pk_mul_f32 v[56:57], v[96:97], v[14:15] op_sel:[0,1] op_sel_hi:[1,1]
    v_pk_mul_f32 v[58:59], v[98:99], v[14:15] op_sel:[0,1] op_sel_hi:[1,1]
    v_pk_mul_f32 v[60:61], v[112:113], v[14:15] op_sel:[0,1] op_sel_hi:[1,1]
    v_pk_mul_f32 v[62:63], v[114:115], v[14:15] op_sel:[0,1] op_sel_hi:[1,1]
    v_exp_f32 v56, v56
    v_exp_f32 v57, v57
    s_waitcnt lgkmcnt(0)
    v_pk_fma_f32 v[100:101], v[40:41], v[14:15], v[100:101] op_sel_hi:[1,0,1] neg_lo:[1,0,0] neg_hi:[1,0,0]
    v_exp_f32 v58, v58
    v_exp_f32 v59, v59
    v_pk_fma_f32 v[102:103], v[42:43], v[14:15], v[102:103] op_sel_hi:[1,0,1] neg_lo:[1,0,0] neg_hi:[1,0,0]
    v_exp_f32 v60, v60
    v_exp_f32 v61, v61
    v_pk_fma_f32 v[116:117], v[44:45], v[14:15], v[116:117] op_sel_hi:[1,0,1] neg_lo:[1,0,0] neg_hi:[1,0,0]
    v_exp_f32 v62, v62
    v_exp_f32 v63, v63
    v_pk_fma_f32 v[118:119], v[46:47], v[14:15], v[118:119] op_sel_hi:[1,0,1] neg_lo:[1,0,0] neg_hi:[1,0,0]
    v_pk_fma_f32 v[56:57], v[56:57], v[18:19], v[18:19] op_sel:[0,0,0] op_sel_hi:[1,0,0]
    v_pk_fma_f32 v[58:59], v[58:59], v[18:19], v[18:19] op_sel:[0,0,0] op_sel_hi:[1,0,0]
    v_pk_fma_f32 v[60:61], v[60:61], v[18:19], v[18:19] op_sel:[0,0,0] op_sel_hi:[1,0,0]
    v_pk_fma_f32 v[62:63], v[62:63], v[18:19], v[18:19] op_sel:[0,0,0] op_sel_hi:[1,0,0]
    v_rcp_f32 v56, v56
    v_rcp_f32 v57, v57
    v_pk_mul_f32 v[96:97], v[96:97], v[100:101]
    v_rcp_f32 v58, v58
    v_rcp_f32 v59, v59
    v_pk_mul_f32 v[98:99], v[98:99], v[102:103]
    v_rcp_f32 v60, v60
    v_rcp_f32 v61, v61
    v_pk_mul_f32 v[112:113], v[112:113], v[116:117]
    v_rcp_f32 v62, v62
    v_rcp_f32 v63, v63
    v_pk_mul_f32 v[114:115], v[114:115], v[118:119]
    v_pk_mul_f32 v[96:97], v[96:97], v[56:57]
    v_pk_mul_f32 v[98:99], v[98:99], v[58:59]
    v_pk_mul_f32 v[112:113], v[112:113], v[60:61]
    v_pk_mul_f32 v[114:115], v[114:115], v[62:63]
    v_cvt_pk_bf16_f32 v116, v96, v97
    v_cvt_pk_bf16_f32 v117, v98, v99
    v_cvt_pk_bf16_f32 v118, v112, v113
    v_cvt_pk_bf16_f32 v119, v114, v115
    buffer_store_dwordx4 v[116:119], v3, s[36:39], s57 offen offset:2048 sc1
    v_pk_fma_f32 v[104:105], v[48:49], v[16:17], v[104:105] op_sel_hi:[1,0,1] neg_lo:[1,0,0] neg_hi:[1,0,0]
    v_pk_fma_f32 v[106:107], v[50:51], v[16:17], v[106:107] op_sel_hi:[1,0,1] neg_lo:[1,0,0] neg_hi:[1,0,0]
    v_pk_fma_f32 v[120:121], v[52:53], v[16:17], v[120:121] op_sel_hi:[1,0,1] neg_lo:[1,0,0] neg_hi:[1,0,0]
    v_pk_fma_f32 v[122:123], v[54:55], v[16:17], v[122:123] op_sel_hi:[1,0,1] neg_lo:[1,0,0] neg_hi:[1,0,0]
    v_pk_mul_f32 v[56:57], v[104:105], v[16:17] op_sel:[0,1] op_sel_hi:[1,1]
    v_pk_mul_f32 v[58:59], v[106:107], v[16:17] op_sel:[0,1] op_sel_hi:[1,1]
    v_pk_mul_f32 v[60:61], v[120:121], v[16:17] op_sel:[0,1] op_sel_hi:[1,1]
    v_pk_mul_f32 v[62:63], v[122:123], v[16:17] op_sel:[0,1] op_sel_hi:[1,1]
    v_exp_f32 v56, v56
    v_exp_f32 v57, v57
    v_pk_fma_f32 v[108:109], v[40:41], v[16:17], v[108:109] op_sel_hi:[1,0,1] neg_lo:[1,0,0] neg_hi:[1,0,0]
    v_exp_f32 v58, v58
    v_exp_f32 v59, v59
    v_pk_fma_f32 v[110:111], v[42:43], v[16:17], v[110:111] op_sel_hi:[1,0,1] neg_lo:[1,0,0] neg_hi:[1,0,0]
    v_exp_f32 v60, v60
    v_exp_f32 v61, v61
    v_pk_fma_f32 v[124:125], v[44:45], v[16:17], v[124:125] op_sel_hi:[1,0,1] neg_lo:[1,0,0] neg_hi:[1,0,0]
    v_exp_f32 v62, v62
    v_exp_f32 v63, v63
    v_pk_fma_f32 v[126:127], v[46:47], v[16:17], v[126:127] op_sel_hi:[1,0,1] neg_lo:[1,0,0] neg_hi:[1,0,0]
    s_barrier
    ds_read_b64_tr_b16 v[32:33], v12 offset:24960
    ds_read_b64_tr_b16 v[34:35], v12 offset:25216
    ds_read_b64_tr_b16 v[36:37], v12 offset:25984
    ds_read_b64_tr_b16 v[38:39], v12 offset:26240
    ds_read_b64_tr_b16 v[40:41], v12 offset:24992
    ds_read_b64_tr_b16 v[42:43], v12 offset:25248
    ds_read_b64_tr_b16 v[44:45], v12 offset:26016
    ds_read_b64_tr_b16 v[46:47], v12 offset:26272
    v_pk_fma_f32 v[56:57], v[56:57], v[18:19], v[18:19] op_sel:[0,1,1] op_sel_hi:[1,1,1]
    v_pk_fma_f32 v[58:59], v[58:59], v[18:19], v[18:19] op_sel:[0,1,1] op_sel_hi:[1,1,1]
    v_pk_fma_f32 v[60:61], v[60:61], v[18:19], v[18:19] op_sel:[0,1,1] op_sel_hi:[1,1,1]
    v_pk_fma_f32 v[62:63], v[62:63], v[18:19], v[18:19] op_sel:[0,1,1] op_sel_hi:[1,1,1]
    v_rcp_f32 v56, v56
    v_rcp_f32 v57, v57
    v_pk_mul_f32 v[104:105], v[104:105], v[108:109]
    v_rcp_f32 v58, v58
    v_rcp_f32 v59, v59
    v_pk_mul_f32 v[106:107], v[106:107], v[110:111]
    v_rcp_f32 v60, v60
    v_rcp_f32 v61, v61
    v_pk_mul_f32 v[120:121], v[120:121], v[124:125]
    v_rcp_f32 v62, v62
    v_rcp_f32 v63, v63
    v_pk_mul_f32 v[122:123], v[122:123], v[126:127]
    v_pk_mul_f32 v[104:105], v[104:105], v[56:57]
    v_pk_mul_f32 v[106:107], v[106:107], v[58:59]
    v_pk_mul_f32 v[120:121], v[120:121], v[60:61]
    v_pk_mul_f32 v[122:123], v[122:123], v[62:63]
    v_cvt_pk_bf16_f32 v124, v104, v105
    v_cvt_pk_bf16_f32 v125, v106, v107
    v_cvt_pk_bf16_f32 v126, v120, v121
    v_cvt_pk_bf16_f32 v127, v122, v123
    buffer_store_dwordx4 v[124:127], v3, s[36:39], s57 offen offset:3072 sc1
    s_waitcnt lgkmcnt(4)
    v_mfma_f32_16x16x32_bf16 v[64:67], v[32:35], v[128:131], 0
    ds_read_b64_tr_b16 v[48:49], v12 offset:25024
    v_add_u32 v4, s30, v13
    v_mfma_f32_16x16x32_bf16 v[72:75], v[32:35], v[132:135], 0
    ds_read_b64_tr_b16 v[50:51], v12 offset:25280
    v_mfma_f32_16x16x32_bf16 v[68:71], v[36:39], v[128:131], 0
    ds_read_b64_tr_b16 v[52:53], v12 offset:26048
    v_add_u32 v7, s31, v13
    v_mfma_f32_16x16x32_bf16 v[76:79], v[36:39], v[132:135], 0
    ds_read_b64_tr_b16 v[54:55], v12 offset:26304
    s_waitcnt lgkmcnt(4)
    v_mfma_f32_16x16x32_bf16 v[80:83], v[40:43], v[128:131], 0
    ds_read_b64_tr_b16 v[56:57], v12 offset:25056
    v_mfma_f32_16x16x32_bf16 v[88:91], v[40:43], v[132:135], 0
    ds_read_b64_tr_b16 v[58:59], v12 offset:25312
    v_add_u32 v5, 58240, v4
    v_mfma_f32_16x16x32_bf16 v[84:87], v[44:47], v[128:131], 0
    ds_read_b64_tr_b16 v[60:61], v12 offset:26080
    v_mfma_f32_16x16x32_bf16 v[92:95], v[44:47], v[132:135], 0
    ds_read_b64_tr_b16 v[62:63], v12 offset:26336
    s_barrier
    s_waitcnt lgkmcnt(4)
    v_mfma_f32_16x16x32_bf16 v[96:99], v[48:51], v[128:131], 0
    ds_read_b64_tr_b16 v[32:33], v11 offset:0
    v_add_u32 v6, 116480, v4
    v_mfma_f32_16x16x32_bf16 v[104:107], v[48:51], v[132:135], 0
    ds_read_b64_tr_b16 v[34:35], v11 offset:256
    v_mfma_f32_16x16x32_bf16 v[100:103], v[52:55], v[128:131], 0
    ds_read_b64_tr_b16 v[36:37], v11 offset:1024
    v_add_u32 v8, 58240, v7
    v_mfma_f32_16x16x32_bf16 v[108:111], v[52:55], v[132:135], 0
    ds_read_b64_tr_b16 v[38:39], v11 offset:1280
    s_waitcnt lgkmcnt(4)
    v_mfma_f32_16x16x32_bf16 v[112:115], v[56:59], v[128:131], 0
    ds_read_b64_tr_b16 v[40:41], v11 offset:32
    v_mfma_f32_16x16x32_bf16 v[120:123], v[56:59], v[132:135], 0
    ds_read_b64_tr_b16 v[42:43], v11 offset:288
    v_add_u32 v9, 116480, v7
    v_mfma_f32_16x16x32_bf16 v[116:119], v[60:63], v[128:131], 0
    ds_read_b64_tr_b16 v[44:45], v11 offset:1056
    v_mfma_f32_16x16x32_bf16 v[124:127], v[60:63], v[132:135], 0
    ds_read_b64_tr_b16 v[46:47], v11 offset:1312
    s_waitcnt lgkmcnt(4)
    v_mfma_f32_16x16x32_bf16 v[64:67], v[32:35], v[136:139], v[64:67]
    ds_read_b64_tr_b16 v[48:49], v11 offset:64
    v_mfma_f32_16x16x32_bf16 v[72:75], v[32:35], v[140:143], v[72:75]
    ds_read_b64_tr_b16 v[50:51], v11 offset:320
    v_mfma_f32_16x16x32_bf16 v[68:71], v[36:39], v[136:139], v[68:71]
    ds_read_b64_tr_b16 v[52:53], v11 offset:1088
    v_mfma_f32_16x16x32_bf16 v[76:79], v[36:39], v[140:143], v[76:79]
    ds_read_b64_tr_b16 v[54:55], v11 offset:1344
    s_waitcnt lgkmcnt(4)
    v_mfma_f32_16x16x32_bf16 v[80:83], v[40:43], v[136:139], v[80:83]
    ds_read_b64_tr_b16 v[56:57], v11 offset:96
    v_mfma_f32_16x16x32_bf16 v[88:91], v[40:43], v[140:143], v[88:91]
    ds_read_b64_tr_b16 v[58:59], v11 offset:352
    v_mfma_f32_16x16x32_bf16 v[84:87], v[44:47], v[136:139], v[84:87]
    ds_read_b64_tr_b16 v[60:61], v11 offset:1120
    v_mfma_f32_16x16x32_bf16 v[92:95], v[44:47], v[140:143], v[92:95]
    ds_read_b64_tr_b16 v[62:63], v11 offset:1376
    s_barrier
    s_waitcnt lgkmcnt(4)
    v_mfma_f32_16x16x32_bf16 v[96:99], v[48:51], v[136:139], v[96:99]
    ds_read_b64_tr_b16 v[32:33], v12 offset:33280
    v_mfma_f32_16x16x32_bf16 v[104:107], v[48:51], v[140:143], v[104:107]
    ds_read_b64_tr_b16 v[34:35], v12 offset:33536
    v_mfma_f32_16x16x32_bf16 v[100:103], v[52:55], v[136:139], v[100:103]
    ds_read_b64_tr_b16 v[36:37], v12 offset:34304
    v_mfma_f32_16x16x32_bf16 v[108:111], v[52:55], v[140:143], v[108:111]
    ds_read_b64_tr_b16 v[38:39], v12 offset:34560
    s_waitcnt lgkmcnt(4)
    v_mfma_f32_16x16x32_bf16 v[112:115], v[56:59], v[136:139], v[112:115]
    ds_read_b64_tr_b16 v[40:41], v12 offset:33312
    v_mfma_f32_16x16x32_bf16 v[120:123], v[56:59], v[140:143], v[120:123]
    ds_read_b64_tr_b16 v[42:43], v12 offset:33568
    v_mfma_f32_16x16x32_bf16 v[116:119], v[60:63], v[136:139], v[116:119]
    ds_read_b64_tr_b16 v[44:45], v12 offset:34336
    v_mfma_f32_16x16x32_bf16 v[124:127], v[60:63], v[140:143], v[124:127]
    ds_read_b64_tr_b16 v[46:47], v12 offset:34592
    s_waitcnt lgkmcnt(4)
    v_mfma_f32_16x16x32_bf16 v[64:67], v[32:35], v[144:147], v[64:67]
    ds_read_b64_tr_b16 v[48:49], v12 offset:33344
    v_mfma_f32_16x16x32_bf16 v[72:75], v[32:35], v[148:151], v[72:75]
    ds_read_b64_tr_b16 v[50:51], v12 offset:33600
    v_mfma_f32_16x16x32_bf16 v[68:71], v[36:39], v[144:147], v[68:71]
    ds_read_b64_tr_b16 v[52:53], v12 offset:34368
    v_mfma_f32_16x16x32_bf16 v[76:79], v[36:39], v[148:151], v[76:79]
    ds_read_b64_tr_b16 v[54:55], v12 offset:34624
    s_waitcnt lgkmcnt(4)
    v_mfma_f32_16x16x32_bf16 v[80:83], v[40:43], v[144:147], v[80:83]
    ds_read_b64_tr_b16 v[56:57], v12 offset:33376
    v_mfma_f32_16x16x32_bf16 v[88:91], v[40:43], v[148:151], v[88:91]
    ds_read_b64_tr_b16 v[58:59], v12 offset:33632
    v_mfma_f32_16x16x32_bf16 v[84:87], v[44:47], v[144:147], v[84:87]
    ds_read_b64_tr_b16 v[60:61], v12 offset:34400
    v_mfma_f32_16x16x32_bf16 v[92:95], v[44:47], v[148:151], v[92:95]
    ds_read_b64_tr_b16 v[62:63], v12 offset:34656
    s_waitcnt vmcnt(0)
    s_barrier
    s_waitcnt lgkmcnt(4)
    v_mfma_f32_16x16x32_bf16 v[96:99], v[48:51], v[144:147], v[96:99]
    ds_read_b64_tr_b16 v[32:33], v11 offset:8320
    v_mfma_f32_16x16x32_bf16 v[104:107], v[48:51], v[148:151], v[104:107]
    ds_read_b64_tr_b16 v[34:35], v11 offset:8576
    v_mfma_f32_16x16x32_bf16 v[100:103], v[52:55], v[144:147], v[100:103]
    ds_read_b64_tr_b16 v[36:37], v11 offset:9344
    v_mfma_f32_16x16x32_bf16 v[108:111], v[52:55], v[148:151], v[108:111]
    ds_read_b64_tr_b16 v[38:39], v11 offset:9600
    s_waitcnt lgkmcnt(4)
    v_mfma_f32_16x16x32_bf16 v[112:115], v[56:59], v[144:147], v[112:115]
    ds_read_b64_tr_b16 v[40:41], v11 offset:8352
    v_mfma_f32_16x16x32_bf16 v[120:123], v[56:59], v[148:151], v[120:123]
    ds_read_b64_tr_b16 v[42:43], v11 offset:8608
    v_mfma_f32_16x16x32_bf16 v[116:119], v[60:63], v[144:147], v[116:119]
    ds_read_b64_tr_b16 v[44:45], v11 offset:9376
    v_mfma_f32_16x16x32_bf16 v[124:127], v[60:63], v[148:151], v[124:127]
    ds_read_b64_tr_b16 v[46:47], v11 offset:9632
    s_waitcnt lgkmcnt(4)
    v_mfma_f32_16x16x32_bf16 v[64:67], v[32:35], v[152:155], v[64:67]
    ds_read_b64_tr_b16 v[48:49], v11 offset:8384
    v_mfma_f32_16x16x32_bf16 v[72:75], v[32:35], v[156:159], v[72:75]
    ds_read_b64_tr_b16 v[50:51], v11 offset:8640
    v_mfma_f32_16x16x32_bf16 v[68:71], v[36:39], v[152:155], v[68:71]
    ds_read_b64_tr_b16 v[52:53], v11 offset:9408
    v_mfma_f32_16x16x32_bf16 v[76:79], v[36:39], v[156:159], v[76:79]
    ds_read_b64_tr_b16 v[54:55], v11 offset:9664
    s_waitcnt lgkmcnt(4)
    v_mfma_f32_16x16x32_bf16 v[80:83], v[40:43], v[152:155], v[80:83]
    ds_read_b64_tr_b16 v[56:57], v11 offset:8416
    v_mfma_f32_16x16x32_bf16 v[88:91], v[40:43], v[156:159], v[88:91]
    ds_read_b64_tr_b16 v[58:59], v11 offset:8672
    v_mfma_f32_16x16x32_bf16 v[84:87], v[44:47], v[152:155], v[84:87]
    ds_read_b64_tr_b16 v[60:61], v11 offset:9440
    v_mfma_f32_16x16x32_bf16 v[92:95], v[44:47], v[156:159], v[92:95]
    ds_read_b64_tr_b16 v[62:63], v11 offset:9696
    s_barrier
    s_waitcnt lgkmcnt(4)
    v_mfma_f32_16x16x32_bf16 v[96:99], v[48:51], v[152:155], v[96:99]
    ds_read_b64_tr_b16 v[32:33], v10 offset:0
    v_mfma_f32_16x16x32_bf16 v[104:107], v[48:51], v[156:159], v[104:107]
    ds_read_b64_tr_b16 v[34:35], v10 offset:256
    v_mfma_f32_16x16x32_bf16 v[100:103], v[52:55], v[152:155], v[100:103]
    ds_read_b64_tr_b16 v[36:37], v10 offset:1024
    v_mfma_f32_16x16x32_bf16 v[108:111], v[52:55], v[156:159], v[108:111]
    ds_read_b64_tr_b16 v[38:39], v10 offset:1280
    s_waitcnt lgkmcnt(4)
    v_mfma_f32_16x16x32_bf16 v[112:115], v[56:59], v[152:155], v[112:115]
    ds_read_b64_tr_b16 v[40:41], v10 offset:32
    v_mfma_f32_16x16x32_bf16 v[120:123], v[56:59], v[156:159], v[120:123]
    ds_read_b64_tr_b16 v[42:43], v10 offset:288
    v_mfma_f32_16x16x32_bf16 v[116:119], v[60:63], v[152:155], v[116:119]
    ds_read_b64_tr_b16 v[44:45], v10 offset:1056
    v_mfma_f32_16x16x32_bf16 v[124:127], v[60:63], v[156:159], v[124:127]
    ds_read_b64_tr_b16 v[46:47], v10 offset:1312
    s_waitcnt lgkmcnt(4)
    v_mfma_f32_16x16x32_bf16 v[64:67], v[32:35], v[160:163], v[64:67]
    ds_read_b64_tr_b16 v[48:49], v10 offset:64
    v_mfma_f32_16x16x32_bf16 v[72:75], v[32:35], v[164:167], v[72:75]
    ds_read_b64_tr_b16 v[50:51], v10 offset:320
    v_mfma_f32_16x16x32_bf16 v[68:71], v[36:39], v[160:163], v[68:71]
    ds_read_b64_tr_b16 v[52:53], v10 offset:1088
    v_mfma_f32_16x16x32_bf16 v[76:79], v[36:39], v[164:167], v[76:79]
    ds_read_b64_tr_b16 v[54:55], v10 offset:1344
    s_waitcnt lgkmcnt(4)
    v_mfma_f32_16x16x32_bf16 v[80:83], v[40:43], v[160:163], v[80:83]
    ds_read_b64_tr_b16 v[56:57], v10 offset:96
    v_mfma_f32_16x16x32_bf16 v[88:91], v[40:43], v[164:167], v[88:91]
    ds_read_b64_tr_b16 v[58:59], v10 offset:352
    v_mfma_f32_16x16x32_bf16 v[84:87], v[44:47], v[160:163], v[84:87]
    ds_read_b64_tr_b16 v[60:61], v10 offset:1120
    v_mfma_f32_16x16x32_bf16 v[92:95], v[44:47], v[164:167], v[92:95]
    ds_read_b64_tr_b16 v[62:63], v10 offset:1376
    s_barrier
    s_waitcnt lgkmcnt(4)
    v_mfma_f32_16x16x32_bf16 v[96:99], v[48:51], v[160:163], v[96:99]
    ds_read_b64_tr_b16 v[32:33], v11 offset:16640
    v_mfma_f32_16x16x32_bf16 v[104:107], v[48:51], v[164:167], v[104:107]
    ds_read_b64_tr_b16 v[34:35], v11 offset:16896
    v_mfma_f32_16x16x32_bf16 v[100:103], v[52:55], v[160:163], v[100:103]
    ds_read_b64_tr_b16 v[36:37], v11 offset:17664
    v_mfma_f32_16x16x32_bf16 v[108:111], v[52:55], v[164:167], v[108:111]
    ds_read_b64_tr_b16 v[38:39], v11 offset:17920
    s_waitcnt lgkmcnt(4)
    v_mfma_f32_16x16x32_bf16 v[112:115], v[56:59], v[160:163], v[112:115]
    ds_read_b64_tr_b16 v[40:41], v11 offset:16672
    v_mfma_f32_16x16x32_bf16 v[120:123], v[56:59], v[164:167], v[120:123]
    ds_read_b64_tr_b16 v[42:43], v11 offset:16928
    v_mfma_f32_16x16x32_bf16 v[116:119], v[60:63], v[160:163], v[116:119]
    ds_read_b64_tr_b16 v[44:45], v11 offset:17696
    v_mfma_f32_16x16x32_bf16 v[124:127], v[60:63], v[164:167], v[124:127]
    ds_read_b64_tr_b16 v[46:47], v11 offset:17952
    s_waitcnt lgkmcnt(4)
    v_mfma_f32_16x16x32_bf16 v[64:67], v[32:35], v[168:171], v[64:67]
    ds_read_b64_tr_b16 v[48:49], v11 offset:16704
    v_mfma_f32_16x16x32_bf16 v[72:75], v[32:35], v[172:175], v[72:75]
    ds_read_b64_tr_b16 v[50:51], v11 offset:16960
    v_mfma_f32_16x16x32_bf16 v[68:71], v[36:39], v[168:171], v[68:71]
    ds_read_b64_tr_b16 v[52:53], v11 offset:17728
    v_mfma_f32_16x16x32_bf16 v[76:79], v[36:39], v[172:175], v[76:79]
    ds_read_b64_tr_b16 v[54:55], v11 offset:17984
    s_waitcnt lgkmcnt(4)
    v_mfma_f32_16x16x32_bf16 v[80:83], v[40:43], v[168:171], v[80:83]
    ds_read_b64_tr_b16 v[56:57], v11 offset:16736
    v_mfma_f32_16x16x32_bf16 v[88:91], v[40:43], v[172:175], v[88:91]
    ds_read_b64_tr_b16 v[58:59], v11 offset:16992
    v_mfma_f32_16x16x32_bf16 v[84:87], v[44:47], v[168:171], v[84:87]
    ds_read_b64_tr_b16 v[60:61], v11 offset:17760
    v_mfma_f32_16x16x32_bf16 v[92:95], v[44:47], v[172:175], v[92:95]
    ds_read_b64_tr_b16 v[62:63], v11 offset:18016
    s_barrier
    s_waitcnt lgkmcnt(4)
    v_mfma_f32_16x16x32_bf16 v[96:99], v[48:51], v[168:171], v[96:99]
    ds_read_b64_tr_b16 v[32:33], v11 offset:24960
    v_mfma_f32_16x16x32_bf16 v[104:107], v[48:51], v[172:175], v[104:107]
    ds_read_b64_tr_b16 v[34:35], v11 offset:25216
    v_mfma_f32_16x16x32_bf16 v[100:103], v[52:55], v[168:171], v[100:103]
    ds_read_b64_tr_b16 v[36:37], v11 offset:25984
    v_mfma_f32_16x16x32_bf16 v[108:111], v[52:55], v[172:175], v[108:111]
    ds_read_b64_tr_b16 v[38:39], v11 offset:26240
    s_waitcnt lgkmcnt(4)
    v_mfma_f32_16x16x32_bf16 v[112:115], v[56:59], v[168:171], v[112:115]
    ds_read_b64_tr_b16 v[40:41], v11 offset:24992
    v_mfma_f32_16x16x32_bf16 v[120:123], v[56:59], v[172:175], v[120:123]
    ds_read_b64_tr_b16 v[42:43], v11 offset:25248
    v_mfma_f32_16x16x32_bf16 v[116:119], v[60:63], v[168:171], v[116:119]
    ds_read_b64_tr_b16 v[44:45], v11 offset:26016
    v_mfma_f32_16x16x32_bf16 v[124:127], v[60:63], v[172:175], v[124:127]
    ds_read_b64_tr_b16 v[46:47], v11 offset:26272
    s_waitcnt lgkmcnt(4)
    v_mfma_f32_16x16x32_bf16 v[64:67], v[32:35], v[176:179], v[64:67]
    ds_read_b64_tr_b16 v[48:49], v11 offset:25024
    v_mfma_f32_16x16x32_bf16 v[72:75], v[32:35], v[180:183], v[72:75]
    ds_read_b64_tr_b16 v[50:51], v11 offset:25280
    v_mfma_f32_16x16x32_bf16 v[68:71], v[36:39], v[176:179], v[68:71]
    ds_read_b64_tr_b16 v[52:53], v11 offset:26048
    v_mfma_f32_16x16x32_bf16 v[76:79], v[36:39], v[180:183], v[76:79]
HOP_6:
    s_cbranch_execz HOP_10
    ds_read_b64_tr_b16 v[54:55], v11 offset:26304
    s_waitcnt lgkmcnt(4)
    v_mfma_f32_16x16x32_bf16 v[80:83], v[40:43], v[176:179], v[80:83]
    ds_read_b64_tr_b16 v[56:57], v11 offset:25056
    v_mfma_f32_16x16x32_bf16 v[88:91], v[40:43], v[180:183], v[88:91]
    ds_read_b64_tr_b16 v[58:59], v11 offset:25312
    v_mfma_f32_16x16x32_bf16 v[84:87], v[44:47], v[176:179], v[84:87]
    ds_read_b64_tr_b16 v[60:61], v11 offset:26080
    v_mfma_f32_16x16x32_bf16 v[92:95], v[44:47], v[180:183], v[92:95]
    ds_read_b64_tr_b16 v[62:63], v11 offset:26336
    s_barrier
    s_waitcnt lgkmcnt(4)
    v_mfma_f32_16x16x32_bf16 v[96:99], v[48:51], v[176:179], v[96:99]
    ds_read_b64_tr_b16 v[32:33], v11 offset:41600
    v_mfma_f32_16x16x32_bf16 v[104:107], v[48:51], v[180:183], v[104:107]
    ds_read_b64_tr_b16 v[34:35], v11 offset:41856
    v_mfma_f32_16x16x32_bf16 v[100:103], v[52:55], v[176:179], v[100:103]
    ds_read_b64_tr_b16 v[36:37], v11 offset:42624
    v_mfma_f32_16x16x32_bf16 v[108:111], v[52:55], v[180:183], v[108:111]
    ds_read_b64_tr_b16 v[38:39], v11 offset:42880
    s_waitcnt lgkmcnt(4)
    v_mfma_f32_16x16x32_bf16 v[112:115], v[56:59], v[176:179], v[112:115]
    ds_read_b64_tr_b16 v[40:41], v11 offset:41632
    v_mfma_f32_16x16x32_bf16 v[120:123], v[56:59], v[180:183], v[120:123]
    ds_read_b64_tr_b16 v[42:43], v11 offset:41888
    v_mfma_f32_16x16x32_bf16 v[116:119], v[60:63], v[176:179], v[116:119]
    ds_read_b64_tr_b16 v[44:45], v11 offset:42656
    v_mfma_f32_16x16x32_bf16 v[124:127], v[60:63], v[180:183], v[124:127]
    ds_read_b64_tr_b16 v[46:47], v11 offset:42912
    s_waitcnt lgkmcnt(4)
    v_mfma_f32_16x16x32_bf16 v[64:67], v[32:35], v[184:187], v[64:67]
    ds_read_b64_tr_b16 v[48:49], v11 offset:41664
    v_mfma_f32_16x16x32_bf16 v[72:75], v[32:35], v[188:191], v[72:75]
    ds_read_b64_tr_b16 v[50:51], v11 offset:41920
    v_mfma_f32_16x16x32_bf16 v[68:71], v[36:39], v[184:187], v[68:71]
    ds_read_b64_tr_b16 v[52:53], v11 offset:42688
    v_mfma_f32_16x16x32_bf16 v[76:79], v[36:39], v[188:191], v[76:79]
    ds_read_b64_tr_b16 v[54:55], v11 offset:42944
    s_waitcnt lgkmcnt(4)
    v_mfma_f32_16x16x32_bf16 v[80:83], v[40:43], v[184:187], v[80:83]
    ds_read_b64_tr_b16 v[56:57], v11 offset:41696
    v_mfma_f32_16x16x32_bf16 v[88:91], v[40:43], v[188:191], v[88:91]
    ds_read_b64_tr_b16 v[58:59], v11 offset:41952
    v_mfma_f32_16x16x32_bf16 v[84:87], v[44:47], v[184:187], v[84:87]
    ds_read_b64_tr_b16 v[60:61], v11 offset:42720
    v_mfma_f32_16x16x32_bf16 v[92:95], v[44:47], v[188:191], v[92:95]
    ds_read_b64_tr_b16 v[62:63], v11 offset:42976
    s_barrier
    s_waitcnt lgkmcnt(4)
    v_mfma_f32_16x16x32_bf16 v[96:99], v[48:51], v[184:187], v[96:99]
    ds_read_b64_tr_b16 v[32:33], v10 offset:8320
    v_mfma_f32_16x16x32_bf16 v[104:107], v[48:51], v[188:191], v[104:107]
    ds_read_b64_tr_b16 v[34:35], v10 offset:8576
    v_mfma_f32_16x16x32_bf16 v[100:103], v[52:55], v[184:187], v[100:103]
    ds_read_b64_tr_b16 v[36:37], v10 offset:9344
    v_mfma_f32_16x16x32_bf16 v[108:111], v[52:55], v[188:191], v[108:111]
    ds_read_b64_tr_b16 v[38:39], v10 offset:9600
    s_waitcnt lgkmcnt(4)
    v_mfma_f32_16x16x32_bf16 v[112:115], v[56:59], v[184:187], v[112:115]
    ds_read_b64_tr_b16 v[40:41], v10 offset:8352
    v_mfma_f32_16x16x32_bf16 v[120:123], v[56:59], v[188:191], v[120:123]
    ds_read_b64_tr_b16 v[42:43], v10 offset:8608
    v_mfma_f32_16x16x32_bf16 v[116:119], v[60:63], v[184:187], v[116:119]
    ds_read_b64_tr_b16 v[44:45], v10 offset:9376
    v_mfma_f32_16x16x32_bf16 v[124:127], v[60:63], v[188:191], v[124:127]
    ds_read_b64_tr_b16 v[46:47], v10 offset:9632
    s_waitcnt lgkmcnt(4)
    v_mfma_f32_16x16x32_bf16 v[64:67], v[32:35], v[192:195], v[64:67]
    ds_read_b64_tr_b16 v[48:49], v10 offset:8384
    v_mfma_f32_16x16x32_bf16 v[72:75], v[32:35], v[196:199], v[72:75]
    ds_read_b64_tr_b16 v[50:51], v10 offset:8640
    v_mfma_f32_16x16x32_bf16 v[68:71], v[36:39], v[192:195], v[68:71]
    ds_read_b64_tr_b16 v[52:53], v10 offset:9408
    v_mfma_f32_16x16x32_bf16 v[76:79], v[36:39], v[196:199], v[76:79]
    ds_read_b64_tr_b16 v[54:55], v10 offset:9664
    s_waitcnt lgkmcnt(4)
    v_mfma_f32_16x16x32_bf16 v[80:83], v[40:43], v[192:195], v[80:83]
    ds_read_b64_tr_b16 v[56:57], v10 offset:8416
    v_mfma_f32_16x16x32_bf16 v[88:91], v[40:43], v[196:199], v[88:91]
    ds_read_b64_tr_b16 v[58:59], v10 offset:8672
    v_mfma_f32_16x16x32_bf16 v[84:87], v[44:47], v[192:195], v[84:87]
    ds_read_b64_tr_b16 v[60:61], v10 offset:9440
    v_mfma_f32_16x16x32_bf16 v[92:95], v[44:47], v[196:199], v[92:95]
    ds_read_b64_tr_b16 v[62:63], v10 offset:9696
    s_barrier
    s_waitcnt lgkmcnt(4)
    v_mfma_f32_16x16x32_bf16 v[96:99], v[48:51], v[192:195], v[96:99]
    ds_read_b64_tr_b16 v[32:33], v11 offset:33280
    v_mfma_f32_16x16x32_bf16 v[104:107], v[48:51], v[196:199], v[104:107]
    ds_read_b64_tr_b16 v[34:35], v11 offset:33536
    v_mfma_f32_16x16x32_bf16 v[100:103], v[52:55], v[192:195], v[100:103]
    ds_read_b64_tr_b16 v[36:37], v11 offset:34304
    v_mfma_f32_16x16x32_bf16 v[108:111], v[52:55], v[196:199], v[108:111]
    ds_read_b64_tr_b16 v[38:39], v11 offset:34560
    s_waitcnt lgkmcnt(4)
    v_mfma_f32_16x16x32_bf16 v[112:115], v[56:59], v[192:195], v[112:115]
    ds_read_b64_tr_b16 v[40:41], v11 offset:33312
    v_mfma_f32_16x16x32_bf16 v[120:123], v[56:59], v[196:199], v[120:123]
    ds_read_b64_tr_b16 v[42:43], v11 offset:33568
    v_mfma_f32_16x16x32_bf16 v[116:119], v[60:63], v[192:195], v[116:119]
    ds_read_b64_tr_b16 v[44:45], v11 offset:34336
    v_mfma_f32_16x16x32_bf16 v[124:127], v[60:63], v[196:199], v[124:127]
    ds_read_b64_tr_b16 v[46:47], v11 offset:34592
    s_waitcnt lgkmcnt(4)
    v_mfma_f32_16x16x32_bf16 v[64:67], v[32:35], v[200:203], v[64:67]
    ds_read_b64_tr_b16 v[48:49], v11 offset:33344
    v_mfma_f32_16x16x32_bf16 v[72:75], v[32:35], v[204:207], v[72:75]
    ds_read_b64_tr_b16 v[50:51], v11 offset:33600
    v_mfma_f32_16x16x32_bf16 v[68:71], v[36:39], v[200:203], v[68:71]
    ds_read_b64_tr_b16 v[52:53], v11 offset:34368
    v_mfma_f32_16x16x32_bf16 v[76:79], v[36:39], v[204:207], v[76:79]
    ds_read_b64_tr_b16 v[54:55], v11 offset:34624
    s_waitcnt lgkmcnt(4)
    v_mfma_f32_16x16x32_bf16 v[80:83], v[40:43], v[200:203], v[80:83]
    ds_read_b64_tr_b16 v[56:57], v11 offset:33376
    v_mfma_f32_16x16x32_bf16 v[88:91], v[40:43], v[204:207], v[88:91]
    ds_read_b64_tr_b16 v[58:59], v11 offset:33632
    v_mfma_f32_16x16x32_bf16 v[84:87], v[44:47], v[200:203], v[84:87]
    ds_read_b64_tr_b16 v[60:61], v11 offset:34400
    v_mfma_f32_16x16x32_bf16 v[92:95], v[44:47], v[204:207], v[92:95]
    ds_read_b64_tr_b16 v[62:63], v11 offset:34656
    s_barrier
    s_waitcnt lgkmcnt(4)
    v_mfma_f32_16x16x32_bf16 v[96:99], v[48:51], v[200:203], v[96:99]
    ds_read_b64_tr_b16 v[32:33], v10 offset:16640
    v_mfma_f32_16x16x32_bf16 v[104:107], v[48:51], v[204:207], v[104:107]
    ds_read_b64_tr_b16 v[34:35], v10 offset:16896
    v_mfma_f32_16x16x32_bf16 v[100:103], v[52:55], v[200:203], v[100:103]
    ds_read_b64_tr_b16 v[36:37], v10 offset:17664
    v_mfma_f32_16x16x32_bf16 v[108:111], v[52:55], v[204:207], v[108:111]
    ds_read_b64_tr_b16 v[38:39], v10 offset:17920
    s_waitcnt lgkmcnt(4)
    v_mfma_f32_16x16x32_bf16 v[112:115], v[56:59], v[200:203], v[112:115]
    ds_read_b64_tr_b16 v[40:41], v10 offset:16672
    v_mfma_f32_16x16x32_bf16 v[120:123], v[56:59], v[204:207], v[120:123]
    ds_read_b64_tr_b16 v[42:43], v10 offset:16928
    v_mfma_f32_16x16x32_bf16 v[116:119], v[60:63], v[200:203], v[116:119]
    ds_read_b64_tr_b16 v[44:45], v10 offset:17696
    v_mfma_f32_16x16x32_bf16 v[124:127], v[60:63], v[204:207], v[124:127]
    ds_read_b64_tr_b16 v[46:47], v10 offset:17952
    s_waitcnt lgkmcnt(4)
    v_mfma_f32_16x16x32_bf16 v[64:67], v[32:35], v[208:211], v[64:67]
    ds_read_b64_tr_b16 v[48:49], v10 offset:16704
    v_mfma_f32_16x16x32_bf16 v[72:75], v[32:35], v[212:215], v[72:75]
    ds_read_b64_tr_b16 v[50:51], v10 offset:16960
    v_mfma_f32_16x16x32_bf16 v[68:71], v[36:39], v[208:211], v[68:71]
    ds_read_b64_tr_b16 v[52:53], v10 offset:17728
    v_mfma_f32_16x16x32_bf16 v[76:79], v[36:39], v[212:215], v[76:79]
    ds_read_b64_tr_b16 v[54:55], v10 offset:17984
    s_waitcnt lgkmcnt(4)
    v_mfma_f32_16x16x32_bf16 v[80:83], v[40:43], v[208:211], v[80:83]
    ds_read_b64_tr_b16 v[56:57], v10 offset:16736
    v_mfma_f32_16x16x32_bf16 v[88:91], v[40:43], v[212:215], v[88:91]
    ds_read_b64_tr_b16 v[58:59], v10 offset:16992
    v_mfma_f32_16x16x32_bf16 v[84:87], v[44:47], v[208:211], v[84:87]
    ds_read_b64_tr_b16 v[60:61], v10 offset:17760
    v_mfma_f32_16x16x32_bf16 v[92:95], v[44:47], v[212:215], v[92:95]
    ds_read_b64_tr_b16 v[62:63], v10 offset:18016
    s_barrier
    s_waitcnt lgkmcnt(4)
    v_mfma_f32_16x16x32_bf16 v[96:99], v[48:51], v[208:211], v[96:99]
    ds_read_b64_tr_b16 v[32:33], v11 offset:49920
    v_mfma_f32_16x16x32_bf16 v[104:107], v[48:51], v[212:215], v[104:107]
    ds_read_b64_tr_b16 v[34:35], v11 offset:50176
    v_mfma_f32_16x16x32_bf16 v[100:103], v[52:55], v[208:211], v[100:103]
    ds_read_b64_tr_b16 v[36:37], v11 offset:50944
    v_mfma_f32_16x16x32_bf16 v[108:111], v[52:55], v[212:215], v[108:111]
    ds_read_b64_tr_b16 v[38:39], v11 offset:51200
    s_waitcnt lgkmcnt(4)
    v_mfma_f32_16x16x32_bf16 v[112:115], v[56:59], v[208:211], v[112:115]
    ds_read_b64_tr_b16 v[40:41], v11 offset:49952
    v_mfma_f32_16x16x32_bf16 v[120:123], v[56:59], v[212:215], v[120:123]
    ds_read_b64_tr_b16 v[42:43], v11 offset:50208
    v_mfma_f32_16x16x32_bf16 v[116:119], v[60:63], v[208:211], v[116:119]
    ds_read_b64_tr_b16 v[44:45], v11 offset:50976
    v_mfma_f32_16x16x32_bf16 v[124:127], v[60:63], v[212:215], v[124:127]
    ds_read_b64_tr_b16 v[46:47], v11 offset:51232
    s_waitcnt lgkmcnt(4)
    v_mfma_f32_16x16x32_bf16 v[64:67], v[32:35], v[216:219], v[64:67]
    ds_read_b64_tr_b16 v[48:49], v11 offset:49984
    v_mfma_f32_16x16x32_bf16 v[72:75], v[32:35], v[220:223], v[72:75]
    ds_read_b64_tr_b16 v[50:51], v11 offset:50240
    v_mfma_f32_16x16x32_bf16 v[68:71], v[36:39], v[216:219], v[68:71]
    ds_read_b64_tr_b16 v[52:53], v11 offset:51008
    v_mfma_f32_16x16x32_bf16 v[76:79], v[36:39], v[220:223], v[76:79]
    ds_read_b64_tr_b16 v[54:55], v11 offset:51264
    s_waitcnt lgkmcnt(4)
    v_mfma_f32_16x16x32_bf16 v[80:83], v[40:43], v[216:219], v[80:83]
    ds_read_b64_tr_b16 v[56:57], v11 offset:50016
    v_mfma_f32_16x16x32_bf16 v[88:91], v[40:43], v[220:223], v[88:91]
    ds_read_b64_tr_b16 v[58:59], v11 offset:50272
    v_mfma_f32_16x16x32_bf16 v[84:87], v[44:47], v[216:219], v[84:87]
    ds_read_b64_tr_b16 v[60:61], v11 offset:51040
    v_mfma_f32_16x16x32_bf16 v[92:95], v[44:47], v[220:223], v[92:95]
    ds_read_b64_tr_b16 v[62:63], v11 offset:51296
    s_barrier
    s_waitcnt lgkmcnt(4)
    v_mfma_f32_16x16x32_bf16 v[96:99], v[48:51], v[216:219], v[96:99]
    ds_read_b64_tr_b16 v[32:33], v10 offset:24960
    v_mfma_f32_16x16x32_bf16 v[104:107], v[48:51], v[220:223], v[104:107]
    ds_read_b64_tr_b16 v[34:35], v10 offset:25216
    s_add_u32 s54, s60, 0
    buffer_load_dwordx4 v[128:131], v21, s[36:39], s54 offen sc1
    v_mfma_f32_16x16x32_bf16 v[100:103], v[52:55], v[216:219], v[100:103]
    ds_read_b64_tr_b16 v[36:37], v10 offset:25984
    v_mfma_f32_16x16x32_bf16 v[108:111], v[52:55], v[220:223], v[108:111]
    ds_read_b64_tr_b16 v[38:39], v10 offset:26240
    s_waitcnt lgkmcnt(4)
    v_mfma_f32_16x16x32_bf16 v[112:115], v[56:59], v[216:219], v[112:115]
    ds_read_b64_tr_b16 v[40:41], v10 offset:24992
    v_mfma_f32_16x16x32_bf16 v[120:123], v[56:59], v[220:223], v[120:123]
    ds_read_b64_tr_b16 v[42:43], v10 offset:25248
    v_mfma_f32_16x16x32_bf16 v[116:119], v[60:63], v[216:219], v[116:119]
    ds_read_b64_tr_b16 v[44:45], v10 offset:26016
    v_mfma_f32_16x16x32_bf16 v[124:127], v[60:63], v[220:223], v[124:127]
    ds_read_b64_tr_b16 v[46:47], v10 offset:26272
    s_waitcnt lgkmcnt(4)
    v_mfma_f32_16x16x32_bf16 v[64:67], v[32:35], v[224:227], v[64:67]
    ds_read_b64_tr_b16 v[48:49], v10 offset:25024
    v_mfma_f32_16x16x32_bf16 v[72:75], v[32:35], v[228:231], v[72:75]
    ds_read_b64_tr_b16 v[50:51], v10 offset:25280
    buffer_load_dwordx4 v[132:135], v21, s[36:39], s54 offen offset:1024 sc1
    v_mfma_f32_16x16x32_bf16 v[68:71], v[36:39], v[224:227], v[68:71]
    ds_read_b64_tr_b16 v[52:53], v10 offset:26048
    v_mfma_f32_16x16x32_bf16 v[76:79], v[36:39], v[228:231], v[76:79]
    ds_read_b64_tr_b16 v[54:55], v10 offset:26304
    s_waitcnt lgkmcnt(4)
    v_mfma_f32_16x16x32_bf16 v[80:83], v[40:43], v[224:227], v[80:83]
    ds_read_b64_tr_b16 v[56:57], v10 offset:25056
    v_mfma_f32_16x16x32_bf16 v[88:91], v[40:43], v[228:231], v[88:91]
    ds_read_b64_tr_b16 v[58:59], v10 offset:25312
    s_add_u32 s54, s60, 8192
    buffer_load_dwordx4 v[136:139], v21, s[36:39], s54 offen sc1
    v_mfma_f32_16x16x32_bf16 v[84:87], v[44:47], v[224:227], v[84:87]
    ds_read_b64_tr_b16 v[60:61], v10 offset:26080
    v_mfma_f32_16x16x32_bf16 v[92:95], v[44:47], v[228:231], v[92:95]
    ds_read_b64_tr_b16 v[62:63], v10 offset:26336
    s_barrier
    s_waitcnt lgkmcnt(4)
    v_mfma_f32_16x16x32_bf16 v[96:99], v[48:51], v[224:227], v[96:99]
    ds_read_b64_tr_b16 v[32:33], v12 offset:0
    v_mfma_f32_16x16x32_bf16 v[104:107], v[48:51], v[228:231], v[104:107]
    ds_read_b64_tr_b16 v[34:35], v12 offset:256
    buffer_load_dwordx4 v[140:143], v21, s[36:39], s54 offen offset:1024 sc1
    v_mfma_f32_16x16x32_bf16 v[100:103], v[52:55], v[224:227], v[100:103]
    ds_read_b64_tr_b16 v[36:37], v12 offset:1024
    v_mfma_f32_16x16x32_bf16 v[108:111], v[52:55], v[228:231], v[108:111]
    ds_read_b64_tr_b16 v[38:39], v12 offset:1280
    s_waitcnt lgkmcnt(4)
    v_mfma_f32_16x16x32_bf16 v[112:115], v[56:59], v[224:227], v[112:115]
    ds_read_b64_tr_b16 v[40:41], v12 offset:32
    v_mfma_f32_16x16x32_bf16 v[120:123], v[56:59], v[228:231], v[120:123]
    ds_read_b64_tr_b16 v[42:43], v12 offset:288
    v_mfma_f32_16x16x32_bf16 v[116:119], v[60:63], v[224:227], v[116:119]
    ds_read_b64_tr_b16 v[44:45], v12 offset:1056
    v_mfma_f32_16x16x32_bf16 v[124:127], v[60:63], v[228:231], v[124:127]
    ds_read_b64_tr_b16 v[46:47], v12 offset:1312
    s_waitcnt lgkmcnt(4)
    v_mfma_f32_16x16x32_bf16 v[64:67], v[32:35], v[232:235], v[64:67]
    ds_read_b64_tr_b16 v[48:49], v12 offset:64
    v_mfma_f32_16x16x32_bf16 v[72:75], v[32:35], v[236:239], v[72:75]
    ds_read_b64_tr_b16 v[50:51], v12 offset:320
    s_add_u32 s54, s60, 16384
    buffer_load_dwordx4 v[144:147], v21, s[36:39], s54 offen sc1
    v_mfma_f32_16x16x32_bf16 v[68:71], v[36:39], v[232:235], v[68:71]
    ds_read_b64_tr_b16 v[52:53], v12 offset:1088
    v_mfma_f32_16x16x32_bf16 v[76:79], v[36:39], v[236:239], v[76:79]
    ds_read_b64_tr_b16 v[54:55], v12 offset:1344
    s_waitcnt lgkmcnt(4)
    v_mfma_f32_16x16x32_bf16 v[80:83], v[40:43], v[232:235], v[80:83]
    ds_read_b64_tr_b16 v[56:57], v12 offset:96
    v_mfma_f32_16x16x32_bf16 v[88:91], v[40:43], v[236:239], v[88:91]
    ds_read_b64_tr_b16 v[58:59], v12 offset:352
    buffer_load_dwordx4 v[148:151], v21, s[36:39], s54 offen offset:1024 sc1
    v_mfma_f32_16x16x32_bf16 v[84:87], v[44:47], v[232:235], v[84:87]
    ds_read_b64_tr_b16 v[60:61], v12 offset:1120
    v_mfma_f32_16x16x32_bf16 v[92:95], v[44:47], v[236:239], v[92:95]
    ds_read_b64_tr_b16 v[62:63], v12 offset:1376
    s_barrier
    s_waitcnt lgkmcnt(4)
    v_mfma_f32_16x16x32_bf16 v[96:99], v[48:51], v[232:235], v[96:99]
    ds_read_b64_tr_b16 v[32:33], v10 offset:33280
    v_mfma_f32_16x16x32_bf16 v[104:107], v[48:51], v[236:239], v[104:107]
    ds_read_b64_tr_b16 v[34:35], v10 offset:33536
    s_add_u32 s54, s60, 24576
    buffer_load_dwordx4 v[152:155], v21, s[36:39], s54 offen sc1
    v_mfma_f32_16x16x32_bf16 v[100:103], v[52:55], v[232:235], v[100:103]
    ds_read_b64_tr_b16 v[36:37], v10 offset:34304
    v_mfma_f32_16x16x32_bf16 v[108:111], v[52:55], v[236:239], v[108:111]
    ds_read_b64_tr_b16 v[38:39], v10 offset:34560
    s_waitcnt lgkmcnt(4)
    v_mfma_f32_16x16x32_bf16 v[112:115], v[56:59], v[232:235], v[112:115]
    ds_read_b64_tr_b16 v[40:41], v10 offset:33312
    v_mfma_f32_16x16x32_bf16 v[120:123], v[56:59], v[236:239], v[120:123]
    ds_read_b64_tr_b16 v[42:43], v10 offset:33568
    v_mfma_f32_16x16x32_bf16 v[116:119], v[60:63], v[232:235], v[116:119]
    ds_read_b64_tr_b16 v[44:45], v10 offset:34336
    v_mfma_f32_16x16x32_bf16 v[124:127], v[60:63], v[236:239], v[124:127]
    ds_read_b64_tr_b16 v[46:47], v10 offset:34592
    s_waitcnt lgkmcnt(4)
    v_mfma_f32_16x16x32_bf16 v[64:67], v[32:35], v[240:243], v[64:67]
    ds_read_b64_tr_b16 v[48:49], v10 offset:33344
    v_mfma_f32_16x16x32_bf16 v[72:75], v[32:35], v[244:247], v[72:75]
    ds_read_b64_tr_b16 v[50:51], v10 offset:33600
    buffer_load_dwordx4 v[156:159], v21, s[36:39], s54 offen offset:1024 sc1
    v_mfma_f32_16x16x32_bf16 v[68:71], v[36:39], v[240:243], v[68:71]
    ds_read_b64_tr_b16 v[52:53], v10 offset:34368
    v_mfma_f32_16x16x32_bf16 v[76:79], v[36:39], v[244:247], v[76:79]
    ds_read_b64_tr_b16 v[54:55], v10 offset:34624
    s_waitcnt lgkmcnt(4)
    v_mfma_f32_16x16x32_bf16 v[80:83], v[40:43], v[240:243], v[80:83]
    ds_read_b64_tr_b16 v[56:57], v10 offset:33376
    v_mfma_f32_16x16x32_bf16 v[88:91], v[40:43], v[244:247], v[88:91]
    ds_read_b64_tr_b16 v[58:59], v10 offset:33632
    s_add_u32 s54, s60, 32768
    buffer_load_dwordx4 v[160:163], v21, s[36:39], s54 offen sc1
    v_mfma_f32_16x16x32_bf16 v[84:87], v[44:47], v[240:243], v[84:87]
    ds_read_b64_tr_b16 v[60:61], v10 offset:34400
    v_mfma_f32_16x16x32_bf16 v[92:95], v[44:47], v[244:247], v[92:95]
    ds_read_b64_tr_b16 v[62:63], v10 offset:34656
    s_barrier
    s_waitcnt lgkmcnt(4)
    v_mfma_f32_16x16x32_bf16 v[96:99], v[48:51], v[240:243], v[96:99]
    ds_read_b64_tr_b16 v[32:33], v12 offset:8320
    v_mfma_f32_16x16x32_bf16 v[104:107], v[48:51], v[244:247], v[104:107]
    ds_read_b64_tr_b16 v[34:35], v12 offset:8576
    buffer_load_dwordx4 v[164:167], v21, s[36:39], s54 offen offset:1024 sc1
    v_mfma_f32_16x16x32_bf16 v[100:103], v[52:55], v[240:243], v[100:103]
    ds_read_b64_tr_b16 v[36:37], v12 offset:9344
    v_mfma_f32_16x16x32_bf16 v[108:111], v[52:55], v[244:247], v[108:111]
    ds_read_b64_tr_b16 v[38:39], v12 offset:9600
    s_waitcnt lgkmcnt(4)
    v_mfma_f32_16x16x32_bf16 v[112:115], v[56:59], v[240:243], v[112:115]
    ds_read_b64_tr_b16 v[40:41], v12 offset:8352
    v_mfma_f32_16x16x32_bf16 v[120:123], v[56:59], v[244:247], v[120:123]
    ds_read_b64_tr_b16 v[42:43], v12 offset:8608
    v_mfma_f32_16x16x32_bf16 v[116:119], v[60:63], v[240:243], v[116:119]
    ds_read_b64_tr_b16 v[44:45], v12 offset:9376
    v_mfma_f32_16x16x32_bf16 v[124:127], v[60:63], v[244:247], v[124:127]
    ds_read_b64_tr_b16 v[46:47], v12 offset:9632
    s_waitcnt lgkmcnt(4)
    v_mfma_f32_16x16x32_bf16 v[64:67], v[32:35], v[248:251], v[64:67]
    ds_read_b64_tr_b16 v[48:49], v12 offset:8384
    v_mfma_f32_16x16x32_bf16 v[72:75], v[32:35], v[252:255], v[72:75]
    ds_read_b64_tr_b16 v[50:51], v12 offset:8640
    s_add_u32 s54, s60, 40960
    buffer_load_dwordx4 v[168:171], v21, s[36:39], s54 offen sc1
    v_mfma_f32_16x16x32_bf16 v[68:71], v[36:39], v[248:251], v[68:71]
    ds_read_b64_tr_b16 v[52:53], v12 offset:9408
    v_mfma_f32_16x16x32_bf16 v[76:79], v[36:39], v[252:255], v[76:79]
    ds_read_b64_tr_b16 v[54:55], v12 offset:9664
    s_waitcnt lgkmcnt(4)
    v_mfma_f32_16x16x32_bf16 v[80:83], v[40:43], v[248:251], v[80:83]
    ds_read_b64_tr_b16 v[56:57], v12 offset:8416
    v_mfma_f32_16x16x32_bf16 v[88:91], v[40:43], v[252:255], v[88:91]
    ds_read_b64_tr_b16 v[58:59], v12 offset:8672
    buffer_load_dwordx4 v[172:175], v21, s[36:39], s54 offen offset:1024 sc1
    v_mfma_f32_16x16x32_bf16 v[84:87], v[44:47], v[248:251], v[84:87]
    ds_read_b64_tr_b16 v[60:61], v12 offset:9440
    v_mfma_f32_16x16x32_bf16 v[92:95], v[44:47], v[252:255], v[92:95]
    ds_read_b64_tr_b16 v[62:63], v12 offset:9696
    s_add_u32 s57, s57, 4096
    s_waitcnt lgkmcnt(4)
    v_mfma_f32_16x16x32_bf16 v[96:99], v[48:51], v[248:251], v[96:99]
    v_mfma_f32_16x16x32_bf16 v[104:107], v[48:51], v[252:255], v[104:107]
    s_add_u32 s54, s60, 49152
    buffer_load_dwordx4 v[176:179], v21, s[36:39], s54 offen sc1
    v_mfma_f32_16x16x32_bf16 v[100:103], v[52:55], v[248:251], v[100:103]
    v_mfma_f32_16x16x32_bf16 v[108:111], v[52:55], v[252:255], v[108:111]
    s_waitcnt lgkmcnt(0)
    s_barrier
    v_mfma_f32_16x16x32_bf16 v[112:115], v[56:59], v[248:251], v[112:115]
    ds_read_b128 v[32:35], v27 offset:256
    ds_read_b128 v[36:39], v27 offset:320
    ds_read_b128 v[40:43], v27 offset:768
    ds_read_b128 v[44:47], v27 offset:832
    v_mfma_f32_16x16x32_bf16 v[120:123], v[56:59], v[252:255], v[120:123]
    v_mfma_f32_16x16x32_bf16 v[116:119], v[60:63], v[248:251], v[116:119]
    v_mfma_f32_16x16x32_bf16 v[124:127], v[60:63], v[252:255], v[124:127]
    s_waitcnt lgkmcnt(2)
    v_pk_fma_f32 v[64:65], v[32:33], v[14:15], v[64:65] op_sel_hi:[1,0,1] neg_lo:[1,0,0] neg_hi:[1,0,0]
    v_pk_fma_f32 v[66:67], v[34:35], v[14:15], v[66:67] op_sel_hi:[1,0,1] neg_lo:[1,0,0] neg_hi:[1,0,0]
    v_pk_fma_f32 v[80:81], v[36:37], v[14:15], v[80:81] op_sel_hi:[1,0,1] neg_lo:[1,0,0] neg_hi:[1,0,0]
    v_pk_fma_f32 v[82:83], v[38:39], v[14:15], v[82:83] op_sel_hi:[1,0,1] neg_lo:[1,0,0] neg_hi:[1,0,0]
    ds_read_b128 v[48:51], v27 offset:384
    ds_read_b128 v[52:55], v27 offset:448
    v_pk_mul_f32 v[56:57], v[64:65], v[14:15] op_sel:[0,1] op_sel_hi:[1,1]
    v_pk_mul_f32 v[58:59], v[66:67], v[14:15] op_sel:[0,1] op_sel_hi:[1,1]
    v_pk_mul_f32 v[60:61], v[80:81], v[14:15] op_sel:[0,1] op_sel_hi:[1,1]
    v_pk_mul_f32 v[62:63], v[82:83], v[14:15] op_sel:[0,1] op_sel_hi:[1,1]
    v_exp_f32 v56, v56
    v_exp_f32 v57, v57
    s_waitcnt lgkmcnt(2)
    v_pk_fma_f32 v[68:69], v[40:41], v[14:15], v[68:69] op_sel_hi:[1,0,1] neg_lo:[1,0,0] neg_hi:[1,0,0]
    buffer_load_dwordx4 v[180:183], v21, s[36:39], s54 offen offset:1024 sc1
    v_exp_f32 v58, v58
    v_exp_f32 v59, v59
    v_pk_fma_f32 v[70:71], v[42:43], v[14:15], v[70:71] op_sel_hi:[1,0,1] neg_lo:[1,0,0] neg_hi:[1,0,0]
    v_exp_f32 v60, v60
    v_exp_f32 v61, v61
    v_pk_fma_f32 v[84:85], v[44:45], v[14:15], v[84:85] op_sel_hi:[1,0,1] neg_lo:[1,0,0] neg_hi:[1,0,0]
    v_exp_f32 v62, v62
    v_exp_f32 v63, v63
    v_pk_fma_f32 v[86:87], v[46:47], v[14:15], v[86:87] op_sel_hi:[1,0,1] neg_lo:[1,0,0] neg_hi:[1,0,0]
    v_pk_fma_f32 v[56:57], v[56:57], v[18:19], v[18:19] op_sel:[0,0,0] op_sel_hi:[1,0,0]
    v_pk_fma_f32 v[58:59], v[58:59], v[18:19], v[18:19] op_sel:[0,0,0] op_sel_hi:[1,0,0]
    s_add_u32 s54, s53, 57344
    buffer_load_dwordx4 v[184:187], v21, s[36:39], s54 offen sc1
    v_pk_fma_f32 v[60:61], v[60:61], v[18:19], v[18:19] op_sel:[0,0,0] op_sel_hi:[1,0,0]
    v_pk_fma_f32 v[62:63], v[62:63], v[18:19], v[18:19] op_sel:[0,0,0] op_sel_hi:[1,0,0]
    v_rcp_f32 v56, v56
    v_rcp_f32 v57, v57
    v_pk_mul_f32 v[64:65], v[64:65], v[68:69]
    v_rcp_f32 v58, v58
    v_rcp_f32 v59, v59
    v_pk_mul_f32 v[66:67], v[66:67], v[70:71]
    v_rcp_f32 v60, v60
    v_rcp_f32 v61, v61
    v_pk_mul_f32 v[80:81], v[80:81], v[84:85]
    buffer_load_dwordx4 v[188:191], v21, s[36:39], s54 offen offset:1024 sc1
    v_rcp_f32 v62, v62
    v_rcp_f32 v63, v63
    v_pk_mul_f32 v[82:83], v[82:83], v[86:87]
    v_pk_mul_f32 v[64:65], v[64:65], v[56:57]
    v_pk_mul_f32 v[66:67], v[66:67], v[58:59]
    v_pk_mul_f32 v[80:81], v[80:81], v[60:61]
    v_pk_mul_f32 v[82:83], v[82:83], v[62:63]
    v_cvt_pk_bf16_f32 v84, v64, v65
    v_cvt_pk_bf16_f32 v85, v66, v67
    v_cvt_pk_bf16_f32 v86, v80, v81
    v_cvt_pk_bf16_f32 v87, v82, v83
    s_add_u32 s54, s53, 65536
    buffer_load_dwordx4 v[192:195], v21, s[36:39], s54 offen sc1
    v_min_u32 v84, -2, v84
    buffer_store_dwordx4 v[84:87], v3, s[36:39], s57 offen offset:0 sc1
    v_pk_fma_f32 v[72:73], v[32:33], v[16:17], v[72:73] op_sel_hi:[1,0,1] neg_lo:[1,0,0] neg_hi:[1,0,0]
    v_pk_fma_f32 v[74:75], v[34:35], v[16:17], v[74:75] op_sel_hi:[1,0,1] neg_lo:[1,0,0] neg_hi:[1,0,0]
    v_pk_fma_f32 v[88:89], v[36:37], v[16:17], v[88:89] op_sel_hi:[1,0,1] neg_lo:[1,0,0] neg_hi:[1,0,0]
    v_pk_fma_f32 v[90:91], v[38:39], v[16:17], v[90:91] op_sel_hi:[1,0,1] neg_lo:[1,0,0] neg_hi:[1,0,0]
    v_pk_mul_f32 v[56:57], v[72:73], v[16:17] op_sel:[0,1] op_sel_hi:[1,1]
    v_pk_mul_f32 v[58:59], v[74:75], v[16:17] op_sel:[0,1] op_sel_hi:[1,1]
    v_pk_mul_f32 v[60:61], v[88:89], v[16:17] op_sel:[0,1] op_sel_hi:[1,1]
    v_pk_mul_f32 v[62:63], v[90:91], v[16:17] op_sel:[0,1] op_sel_hi:[1,1]
    v_exp_f32 v56, v56
    v_exp_f32 v57, v57
    v_pk_fma_f32 v[76:77], v[40:41], v[16:17], v[76:77] op_sel_hi:[1,0,1] neg_lo:[1,0,0] neg_hi:[1,0,0]
    buffer_load_dwordx4 v[196:199], v21, s[36:39], s54 offen offset:1024 sc1
    v_exp_f32 v58, v58
    v_exp_f32 v59, v59
    v_pk_fma_f32 v[78:79], v[42:43], v[16:17], v[78:79] op_sel_hi:[1,0,1] neg_lo:[1,0,0] neg_hi:[1,0,0]
    v_exp_f32 v60, v60
    v_exp_f32 v61, v61
    v_pk_fma_f32 v[92:93], v[44:45], v[16:17], v[92:93] op_sel_hi:[1,0,1] neg_lo:[1,0,0] neg_hi:[1,0,0]
    v_exp_f32 v62, v62
    v_exp_f32 v63, v63
    v_pk_fma_f32 v[94:95], v[46:47], v[16:17], v[94:95] op_sel_hi:[1,0,1] neg_lo:[1,0,0] neg_hi:[1,0,0]
    ds_read_b128 v[40:43], v27 offset:896
    ds_read_b128 v[44:47], v27 offset:960
    v_pk_fma_f32 v[56:57], v[56:57], v[18:19], v[18:19] op_sel:[0,1,1] op_sel_hi:[1,1,1]
    v_pk_fma_f32 v[58:59], v[58:59], v[18:19], v[18:19] op_sel:[0,1,1] op_sel_hi:[1,1,1]
    s_add_u32 s54, s53, 73728
    buffer_load_dwordx4 v[200:203], v21, s[36:39], s54 offen sc1
    v_pk_fma_f32 v[60:61], v[60:61], v[18:19], v[18:19] op_sel:[0,1,1] op_sel_hi:[1,1,1]
    v_pk_fma_f32 v[62:63], v[62:63], v[18:19], v[18:19] op_sel:[0,1,1] op_sel_hi:[1,1,1]
    v_rcp_f32 v56, v56
    v_rcp_f32 v57, v57
    v_pk_mul_f32 v[72:73], v[72:73], v[76:77]
    v_rcp_f32 v58, v58
    v_rcp_f32 v59, v59
    v_pk_mul_f32 v[74:75], v[74:75], v[78:79]
    v_rcp_f32 v60, v60
    v_rcp_f32 v61, v61
    v_pk_mul_f32 v[88:89], v[88:89], v[92:93]
    buffer_load_dwordx4 v[204:207], v21, s[36:39], s54 offen offset:1024 sc1
    v_rcp_f32 v62, v62
    v_rcp_f32 v63, v63
    v_pk_mul_f32 v[90:91], v[90:91], v[94:95]
    v_pk_mul_f32 v[72:73], v[72:73], v[56:57]
    v_pk_mul_f32 v[74:75], v[74:75], v[58:59]
    v_pk_mul_f32 v[88:89], v[88:89], v[60:61]
    v_pk_mul_f32 v[90:91], v[90:91], v[62:63]
    v_cvt_pk_bf16_f32 v92, v72, v73
    v_cvt_pk_bf16_f32 v93, v74, v75
    v_cvt_pk_bf16_f32 v94, v88, v89
    v_cvt_pk_bf16_f32 v95, v90, v91
    s_add_u32 s54, s53, 81920
    buffer_load_dwordx4 v[208:211], v21, s[36:39], s54 offen sc1
    v_min_u32 v92, -2, v92
    buffer_store_dwordx4 v[92:95], v3, s[36:39], s57 offen offset:1024 sc1
    s_waitcnt lgkmcnt(2)
    v_pk_fma_f32 v[96:97], v[48:49], v[14:15], v[96:97] op_sel_hi:[1,0,1] neg_lo:[1,0,0] neg_hi:[1,0,0]
    v_pk_fma_f32 v[98:99], v[50:51], v[14:15], v[98:99] op_sel_hi:[1,0,1] neg_lo:[1,0,0] neg_hi:[1,0,0]
    v_pk_fma_f32 v[112:113], v[52:53], v[14:15], v[112:113] op_sel_hi:[1,0,1] neg_lo:[1,0,0] neg_hi:[1,0,0]
    v_pk_fma_f32 v[114:115], v[54:55], v[14:15], v[114:115] op_sel_hi:[1,0,1] neg_lo:[1,0,0] neg_hi:[1,0,0]
    v_pk_mul_f32 v[56:57], v[96:97], v[14:15] op_sel:[0,1] op_sel_hi:[1,1]
    v_pk_mul_f32 v[58:59], v[98:99], v[14:15] op_sel:[0,1] op_sel_hi:[1,1]
    v_pk_mul_f32 v[60:61], v[112:113], v[14:15] op_sel:[0,1] op_sel_hi:[1,1]
    v_pk_mul_f32 v[62:63], v[114:115], v[14:15] op_sel:[0,1] op_sel_hi:[1,1]
    v_exp_f32 v56, v56
    v_exp_f32 v57, v57
    s_waitcnt lgkmcnt(0)
    v_pk_fma_f32 v[100:101], v[40:41], v[14:15], v[100:101] op_sel_hi:[1,0,1] neg_lo:[1,0,0] neg_hi:[1,0,0]
    buffer_load_dwordx4 v[212:215], v21, s[36:39], s54 offen offset:1024 sc1
    v_exp_f32 v58, v58
    v_exp_f32 v59, v59
    v_pk_fma_f32 v[102:103], v[42:43], v[14:15], v[102:103] op_sel_hi:[1,0,1] neg_lo:[1,0,0] neg_hi:[1,0,0]
    v_exp_f32 v60, v60
    v_exp_f32 v61, v61
    v_pk_fma_f32 v[116:117], v[44:45], v[14:15], v[116:117] op_sel_hi:[1,0,1] neg_lo:[1,0,0] neg_hi:[1,0,0]
    v_exp_f32 v62, v62
    v_exp_f32 v63, v63
    v_pk_fma_f32 v[118:119], v[46:47], v[14:15], v[118:119] op_sel_hi:[1,0,1] neg_lo:[1,0,0] neg_hi:[1,0,0]
    v_pk_fma_f32 v[56:57], v[56:57], v[18:19], v[18:19] op_sel:[0,0,0] op_sel_hi:[1,0,0]
    v_pk_fma_f32 v[58:59], v[58:59], v[18:19], v[18:19] op_sel:[0,0,0] op_sel_hi:[1,0,0]
    s_add_u32 s54, s53, 90112
    buffer_load_dwordx4 v[216:219], v21, s[36:39], s54 offen sc1
    v_pk_fma_f32 v[60:61], v[60:61], v[18:19], v[18:19] op_sel:[0,0,0] op_sel_hi:[1,0,0]
    v_pk_fma_f32 v[62:63], v[62:63], v[18:19], v[18:19] op_sel:[0,0,0] op_sel_hi:[1,0,0]
    v_rcp_f32 v56, v56
    v_rcp_f32 v57, v57
    v_pk_mul_f32 v[96:97], v[96:97], v[100:101]
    v_rcp_f32 v58, v58
    v_rcp_f32 v59, v59
    v_pk_mul_f32 v[98:99], v[98:99], v[102:103]
    v_rcp_f32 v60, v60
    v_rcp_f32 v61, v61
    v_pk_mul_f32 v[112:113], v[112:113], v[116:117]
    buffer_load_dwordx4 v[220:223], v21, s[36:39], s54 offen offset:1024 sc1
    v_rcp_f32 v62, v62
    v_rcp_f32 v63, v63
    v_pk_mul_f32 v[114:115], v[114:115], v[118:119]
    v_pk_mul_f32 v[96:97], v[96:97], v[56:57]
    v_pk_mul_f32 v[98:99], v[98:99], v[58:59]
    v_pk_mul_f32 v[112:113], v[112:113], v[60:61]
    v_pk_mul_f32 v[114:115], v[114:115], v[62:63]
    v_cvt_pk_bf16_f32 v116, v96, v97
    v_cvt_pk_bf16_f32 v117, v98, v99
    v_cvt_pk_bf16_f32 v118, v112, v113
    v_cvt_pk_bf16_f32 v119, v114, v115
    s_add_u32 s54, s53, 98304
    buffer_load_dwordx4 v[224:227], v21, s[36:39], s54 offen sc1
    v_min_u32 v116, -2, v116
    buffer_store_dwordx4 v[116:119], v3, s[36:39], s57 offen offset:2048 sc1
    v_pk_fma_f32 v[104:105], v[48:49], v[16:17], v[104:105] op_sel_hi:[1,0,1] neg_lo:[1,0,0] neg_hi:[1,0,0]
    v_pk_fma_f32 v[106:107], v[50:51], v[16:17], v[106:107] op_sel_hi:[1,0,1] neg_lo:[1,0,0] neg_hi:[1,0,0]
    v_pk_fma_f32 v[120:121], v[52:53], v[16:17], v[120:121] op_sel_hi:[1,0,1] neg_lo:[1,0,0] neg_hi:[1,0,0]
    v_pk_fma_f32 v[122:123], v[54:55], v[16:17], v[122:123] op_sel_hi:[1,0,1] neg_lo:[1,0,0] neg_hi:[1,0,0]
    v_pk_mul_f32 v[56:57], v[104:105], v[16:17] op_sel:[0,1] op_sel_hi:[1,1]
    v_pk_mul_f32 v[58:59], v[106:107], v[16:17] op_sel:[0,1] op_sel_hi:[1,1]
    v_pk_mul_f32 v[60:61], v[120:121], v[16:17] op_sel:[0,1] op_sel_hi:[1,1]
    v_pk_mul_f32 v[62:63], v[122:123], v[16:17] op_sel:[0,1] op_sel_hi:[1,1]
    v_exp_f32 v56, v56
    v_exp_f32 v57, v57
    v_pk_fma_f32 v[108:109], v[40:41], v[16:17], v[108:109] op_sel_hi:[1,0,1] neg_lo:[1,0,0] neg_hi:[1,0,0]
    buffer_load_dwordx4 v[228:231], v21, s[36:39], s54 offen offset:1024 sc1
    v_exp_f32 v58, v58
    v_exp_f32 v59, v59
    v_pk_fma_f32 v[110:111], v[42:43], v[16:17], v[110:111] op_sel_hi:[1,0,1] neg_lo:[1,0,0] neg_hi:[1,0,0]
    v_exp_f32 v60, v60
    v_exp_f32 v61, v61
    v_pk_fma_f32 v[124:125], v[44:45], v[16:17], v[124:125] op_sel_hi:[1,0,1] neg_lo:[1,0,0] neg_hi:[1,0,0]
    v_exp_f32 v62, v62
    v_exp_f32 v63, v63
    v_pk_fma_f32 v[126:127], v[46:47], v[16:17], v[126:127] op_sel_hi:[1,0,1] neg_lo:[1,0,0] neg_hi:[1,0,0]
    s_barrier
    ds_read_b64_tr_b16 v[32:33], v4 offset:41600
    ds_read_b64_tr_b16 v[34:35], v4 offset:42112
    ds_read_b64_tr_b16 v[36:37], v4 offset:41632
    ds_read_b64_tr_b16 v[38:39], v4 offset:42144
HOP_7:
    s_cbranch_execz HOP_end
    ds_read_b64_tr_b16 v[40:41], v7 offset:41600
    ds_read_b64_tr_b16 v[42:43], v7 offset:42112
    ds_read_b64_tr_b16 v[44:45], v7 offset:41632
    ds_read_b64_tr_b16 v[46:47], v7 offset:42144
    v_pk_fma_f32 v[56:57], v[56:57], v[18:19], v[18:19] op_sel:[0,1,1] op_sel_hi:[1,1,1]
    v_pk_fma_f32 v[58:59], v[58:59], v[18:19], v[18:19] op_sel:[0,1,1] op_sel_hi:[1,1,1]
    s_add_u32 s54, s53, 106496
    buffer_load_dwordx4 v[232:235], v21, s[36:39], s54 offen sc1
    v_pk_fma_f32 v[60:61], v[60:61], v[18:19], v[18:19] op_sel:[0,1,1] op_sel_hi:[1,1,1]
    v_pk_fma_f32 v[62:63], v[62:63], v[18:19], v[18:19] op_sel:[0,1,1] op_sel_hi:[1,1,1]
    v_rcp_f32 v56, v56
    v_rcp_f32 v57, v57
    v_pk_mul_f32 v[104:105], v[104:105], v[108:109]
    v_rcp_f32 v58, v58
    v_rcp_f32 v59, v59
    v_pk_mul_f32 v[106:107], v[106:107], v[110:111]
    v_rcp_f32 v60, v60
    v_rcp_f32 v61, v61
    v_pk_mul_f32 v[120:121], v[120:121], v[124:125]
    buffer_load_dwordx4 v[236:239], v21, s[36:39], s54 offen offset:1024 sc1
    v_rcp_f32 v62, v62
    v_rcp_f32 v63, v63
    v_pk_mul_f32 v[122:123], v[122:123], v[126:127]
    v_pk_mul_f32 v[104:105], v[104:105], v[56:57]
    v_pk_mul_f32 v[106:107], v[106:107], v[58:59]
    v_pk_mul_f32 v[120:121], v[120:121], v[60:61]
    v_pk_mul_f32 v[122:123], v[122:123], v[62:63]
    v_cvt_pk_bf16_f32 v124, v104, v105
    v_cvt_pk_bf16_f32 v125, v106, v107
    v_cvt_pk_bf16_f32 v126, v120, v121
    v_cvt_pk_bf16_f32 v127, v122, v123
    v_min_u32 v124, -2, v124
    buffer_store_dwordx4 v[124:127], v3, s[36:39], s57 offen offset:3072 sc1
KF_P2:
    s_mov_b32 s62, 0xffff0000
    s_add_u32 s63, s67, 16384
    s_waitcnt vmcnt(30)
    s_waitcnt lgkmcnt(4)
    v_mfma_f32_16x16x32_bf16 v[64:67], v[32:35], v[128:131], 0
    ds_read_b64_tr_b16 v[48:49], v6 offset:16640
    v_mfma_f32_16x16x32_bf16 v[72:75], v[32:35], v[132:135], 0
    ds_read_b64_tr_b16 v[50:51], v6 offset:17152
    v_mfma_f32_16x16x32_bf16 v[68:71], v[36:39], v[128:131], 0
    ds_read_b64_tr_b16 v[52:53], v6 offset:16672
    v_mfma_f32_16x16x32_bf16 v[76:79], v[36:39], v[132:135], 0
    ds_read_b64_tr_b16 v[54:55], v6 offset:17184
    s_waitcnt lgkmcnt(4)
    v_mfma_f32_16x16x32_bf16 v[80:83], v[40:43], v[128:131], 0
    ds_read_b64_tr_b16 v[56:57], v9 offset:16640
    s_waitcnt vmcnt(28)
    v_mfma_f32_16x16x32_bf16 v[88:91], v[40:43], v[132:135], 0
    ds_read_b64_tr_b16 v[58:59], v9 offset:17152
    v_mfma_f32_16x16x32_bf16 v[84:87], v[44:47], v[128:131], 0
    ds_read_b64_tr_b16 v[60:61], v9 offset:16672
    v_mfma_f32_16x16x32_bf16 v[92:95], v[44:47], v[132:135], 0
    ds_read_b64_tr_b16 v[62:63], v9 offset:17184
    s_waitcnt lgkmcnt(4)
    v_mfma_f32_16x16x32_bf16 v[64:67], v[48:51], v[136:139], v[64:67]
    ds_read_b64_tr_b16 v[32:33], v4 offset:49920
    v_mfma_f32_16x16x32_bf16 v[72:75], v[48:51], v[140:143], v[72:75]
    ds_read_b64_tr_b16 v[34:35], v4 offset:50432
    v_mfma_f32_16x16x32_bf16 v[68:71], v[52:55], v[136:139], v[68:71]
    ds_read_b64_tr_b16 v[36:37], v4 offset:49952
    v_mfma_f32_16x16x32_bf16 v[76:79], v[52:55], v[140:143], v[76:79]
    ds_read_b64_tr_b16 v[38:39], v4 offset:50464
    s_waitcnt lgkmcnt(4)
    v_mfma_f32_16x16x32_bf16 v[80:83], v[56:59], v[136:139], v[80:83]
    ds_read_b64_tr_b16 v[40:41], v7 offset:49920
    s_waitcnt vmcnt(26)
    v_mfma_f32_16x16x32_bf16 v[88:91], v[56:59], v[140:143], v[88:91]
    ds_read_b64_tr_b16 v[42:43], v7 offset:50432
    v_mfma_f32_16x16x32_bf16 v[84:87], v[60:63], v[136:139], v[84:87]
    ds_read_b64_tr_b16 v[44:45], v7 offset:49952
    v_mfma_f32_16x16x32_bf16 v[92:95], v[60:63], v[140:143], v[92:95]
    ds_read_b64_tr_b16 v[46:47], v7 offset:50464
    s_barrier
    s_waitcnt lgkmcnt(4)
    v_mfma_f32_16x16x32_bf16 v[64:67], v[32:35], v[144:147], v[64:67]
    ds_read_b64_tr_b16 v[48:49], v6 offset:24960
    v_mfma_f32_16x16x32_bf16 v[72:75], v[32:35], v[148:151], v[72:75]
    ds_read_b64_tr_b16 v[50:51], v6 offset:25472
    v_mfma_f32_16x16x32_bf16 v[68:71], v[36:39], v[144:147], v[68:71]
    ds_read_b64_tr_b16 v[52:53], v6 offset:24992
    v_mfma_f32_16x16x32_bf16 v[76:79], v[36:39], v[148:151], v[76:79]
    ds_read_b64_tr_b16 v[54:55], v6 offset:25504
    s_waitcnt lgkmcnt(4)
    v_mfma_f32_16x16x32_bf16 v[80:83], v[40:43], v[144:147], v[80:83]
    ds_read_b64_tr_b16 v[56:57], v9 offset:24960
    s_waitcnt vmcnt(24)
    v_mfma_f32_16x16x32_bf16 v[88:91], v[40:43], v[148:151], v[88:91]
    ds_read_b64_tr_b16 v[58:59], v9 offset:25472
    v_mfma_f32_16x16x32_bf16 v[84:87], v[44:47], v[144:147], v[84:87]
    ds_read_b64_tr_b16 v[60:61], v9 offset:24992
    v_mfma_f32_16x16x32_bf16 v[92:95], v[44:47], v[148:151], v[92:95]
    ds_read_b64_tr_b16 v[62:63], v9 offset:25504
    s_waitcnt lgkmcnt(4)
    v_mfma_f32_16x16x32_bf16 v[64:67], v[48:51], v[152:155], v[64:67]
    ds_read_b64_tr_b16 v[32:33], v5 offset:0
    v_mfma_f32_16x16x32_bf16 v[72:75], v[48:51], v[156:159], v[72:75]
    ds_read_b64_tr_b16 v[34:35], v5 offset:512
    v_mfma_f32_16x16x32_bf16 v[68:71], v[52:55], v[152:155], v[68:71]
    ds_read_b64_tr_b16 v[36:37], v5 offset:32
    v_mfma_f32_16x16x32_bf16 v[76:79], v[52:55], v[156:159], v[76:79]
    ds_read_b64_tr_b16 v[38:39], v5 offset:544
    s_waitcnt lgkmcnt(4)
    v_mfma_f32_16x16x32_bf16 v[80:83], v[56:59], v[152:155], v[80:83]
    ds_read_b64_tr_b16 v[40:41], v8 offset:0
    s_waitcnt vmcnt(22)
    v_mfma_f32_16x16x32_bf16 v[88:91], v[56:59], v[156:159], v[88:91]
    ds_read_b64_tr_b16 v[42:43], v8 offset:512
    v_mfma_f32_16x16x32_bf16 v[84:87], v[60:63], v[152:155], v[84:87]
    ds_read_b64_tr_b16 v[44:45], v8 offset:32
    v_mfma_f32_16x16x32_bf16 v[92:95], v[60:63], v[156:159], v[92:95]
    ds_read_b64_tr_b16 v[46:47], v8 offset:544
    s_barrier
    s_waitcnt lgkmcnt(4)
    v_mfma_f32_16x16x32_bf16 v[64:67], v[32:35], v[160:163], v[64:67]
    ds_read_b64_tr_b16 v[48:49], v6 offset:33280
    v_mfma_f32_16x16x32_bf16 v[72:75], v[32:35], v[164:167], v[72:75]
    ds_read_b64_tr_b16 v[50:51], v6 offset:33792
    v_mfma_f32_16x16x32_bf16 v[68:71], v[36:39], v[160:163], v[68:71]
    ds_read_b64_tr_b16 v[52:53], v6 offset:33312
    v_mfma_f32_16x16x32_bf16 v[76:79], v[36:39], v[164:167], v[76:79]
    ds_read_b64_tr_b16 v[54:55], v6 offset:33824
    s_waitcnt lgkmcnt(4)
    v_mfma_f32_16x16x32_bf16 v[80:83], v[40:43], v[160:163], v[80:83]
    ds_read_b64_tr_b16 v[56:57], v9 offset:33280
    s_waitcnt vmcnt(20)
    v_mfma_f32_16x16x32_bf16 v[88:91], v[40:43], v[164:167], v[88:91]
    ds_read_b64_tr_b16 v[58:59], v9 offset:33792
    v_mfma_f32_16x16x32_bf16 v[84:87], v[44:47], v[160:163], v[84:87]
    ds_read_b64_tr_b16 v[60:61], v9 offset:33312
    v_mfma_f32_16x16x32_bf16 v[92:95], v[44:47], v[164:167], v[92:95]
    ds_read_b64_tr_b16 v[62:63], v9 offset:33824
    s_waitcnt lgkmcnt(4)
    v_mfma_f32_16x16x32_bf16 v[64:67], v[48:51], v[168:171], v[64:67]
    ds_read_b64_tr_b16 v[32:33], v5 offset:8320
    v_mfma_f32_16x16x32_bf16 v[72:75], v[48:51], v[172:175], v[72:75]
    ds_read_b64_tr_b16 v[34:35], v5 offset:8832
    v_mfma_f32_16x16x32_bf16 v[68:71], v[52:55], v[168:171], v[68:71]
    ds_read_b64_tr_b16 v[36:37], v5 offset:8352
    v_mfma_f32_16x16x32_bf16 v[76:79], v[52:55], v[172:175], v[76:79]
    ds_read_b64_tr_b16 v[38:39], v5 offset:8864
    s_waitcnt lgkmcnt(4)
    v_mfma_f32_16x16x32_bf16 v[80:83], v[56:59], v[168:171], v[80:83]
    ds_read_b64_tr_b16 v[40:41], v8 offset:8320
    s_waitcnt vmcnt(18)
    v_mfma_f32_16x16x32_bf16 v[88:91], v[56:59], v[172:175], v[88:91]
    ds_read_b64_tr_b16 v[42:43], v8 offset:8832
    v_mfma_f32_16x16x32_bf16 v[84:87], v[60:63], v[168:171], v[84:87]
    ds_read_b64_tr_b16 v[44:45], v8 offset:8352
    v_mfma_f32_16x16x32_bf16 v[92:95], v[60:63], v[172:175], v[92:95]
    ds_read_b64_tr_b16 v[46:47], v8 offset:8864
    s_barrier
    s_waitcnt lgkmcnt(4)
    v_mfma_f32_16x16x32_bf16 v[64:67], v[32:35], v[176:179], v[64:67]
    ds_read_b64_tr_b16 v[48:49], v4 offset:0
    v_mfma_f32_16x16x32_bf16 v[72:75], v[32:35], v[180:183], v[72:75]
    ds_read_b64_tr_b16 v[50:51], v4 offset:512
    v_mfma_f32_16x16x32_bf16 v[68:71], v[36:39], v[176:179], v[68:71]
    ds_read_b64_tr_b16 v[52:53], v4 offset:32
    v_mfma_f32_16x16x32_bf16 v[76:79], v[36:39], v[180:183], v[76:79]
    ds_read_b64_tr_b16 v[54:55], v4 offset:544
    s_waitcnt lgkmcnt(4)
    v_mfma_f32_16x16x32_bf16 v[80:83], v[40:43], v[176:179], v[80:83]
    ds_read_b64_tr_b16 v[56:57], v7 offset:0
    s_waitcnt vmcnt(16)
    v_mfma_f32_16x16x32_bf16 v[88:91], v[40:43], v[180:183], v[88:91]
    ds_read_b64_tr_b16 v[58:59], v7 offset:512
    v_mfma_f32_16x16x32_bf16 v[84:87], v[44:47], v[176:179], v[84:87]
    ds_read_b64_tr_b16 v[60:61], v7 offset:32
    v_mfma_f32_16x16x32_bf16 v[92:95], v[44:47], v[180:183], v[92:95]
    ds_read_b64_tr_b16 v[62:63], v7 offset:544
    s_waitcnt lgkmcnt(4)
    v_mfma_f32_16x16x32_bf16 v[64:67], v[48:51], v[184:187], v[64:67]
    ds_read_b64_tr_b16 v[32:33], v5 offset:16640
    v_mfma_f32_16x16x32_bf16 v[72:75], v[48:51], v[188:191], v[72:75]
    ds_read_b64_tr_b16 v[34:35], v5 offset:17152
    v_mfma_f32_16x16x32_bf16 v[68:71], v[52:55], v[184:187], v[68:71]
    ds_read_b64_tr_b16 v[36:37], v5 offset:16672
    v_mfma_f32_16x16x32_bf16 v[76:79], v[52:55], v[188:191], v[76:79]
    ds_read_b64_tr_b16 v[38:39], v5 offset:17184
    s_waitcnt lgkmcnt(4)
    v_mfma_f32_16x16x32_bf16 v[80:83], v[56:59], v[184:187], v[80:83]
    ds_read_b64_tr_b16 v[40:41], v8 offset:16640
    s_waitcnt vmcnt(13)
    v_mfma_f32_16x16x32_bf16 v[88:91], v[56:59], v[188:191], v[88:91]
    ds_read_b64_tr_b16 v[42:43], v8 offset:17152
    v_mfma_f32_16x16x32_bf16 v[84:87], v[60:63], v[184:187], v[84:87]
    ds_read_b64_tr_b16 v[44:45], v8 offset:16672
    v_mfma_f32_16x16x32_bf16 v[92:95], v[60:63], v[188:191], v[92:95]
    ds_read_b64_tr_b16 v[46:47], v8 offset:17184
    s_barrier
    s_waitcnt lgkmcnt(4)
    v_mfma_f32_16x16x32_bf16 v[64:67], v[32:35], v[192:195], v[64:67]
    ds_read_b64_tr_b16 v[48:49], v5 offset:24960
    v_mfma_f32_16x16x32_bf16 v[72:75], v[32:35], v[196:199], v[72:75]
    ds_read_b64_tr_b16 v[50:51], v5 offset:25472
    v_mfma_f32_16x16x32_bf16 v[68:71], v[36:39], v[192:195], v[68:71]
    ds_read_b64_tr_b16 v[52:53], v5 offset:24992
    v_mfma_f32_16x16x32_bf16 v[76:79], v[36:39], v[196:199], v[76:79]
    ds_read_b64_tr_b16 v[54:55], v5 offset:25504
    s_waitcnt lgkmcnt(4)
    v_mfma_f32_16x16x32_bf16 v[80:83], v[40:43], v[192:195], v[80:83]
    ds_read_b64_tr_b16 v[56:57], v8 offset:24960
    s_waitcnt vmcnt(11)
    v_mfma_f32_16x16x32_bf16 v[88:91], v[40:43], v[196:199], v[88:91]
    ds_read_b64_tr_b16 v[58:59], v8 offset:25472
    v_mfma_f32_16x16x32_bf16 v[84:87], v[44:47], v[192:195], v[84:87]
    ds_read_b64_tr_b16 v[60:61], v8 offset:24992
    v_mfma_f32_16x16x32_bf16 v[92:95], v[44:47], v[196:199], v[92:95]
    ds_read_b64_tr_b16 v[62:63], v8 offset:25504
    s_waitcnt lgkmcnt(4)
    v_mfma_f32_16x16x32_bf16 v[64:67], v[48:51], v[200:203], v[64:67]
    ds_read_b64_tr_b16 v[32:33], v5 offset:41600
    s_add_u32 s54, s60, 4096
    buffer_load_dwordx4 v[128:131], v21, s[36:39], s54 offen sc1
    v_mfma_f32_16x16x32_bf16 v[72:75], v[48:51], v[204:207], v[72:75]
    ds_read_b64_tr_b16 v[34:35], v5 offset:42112
    v_mfma_f32_16x16x32_bf16 v[68:71], v[52:55], v[200:203], v[68:71]
    ds_read_b64_tr_b16 v[36:37], v5 offset:41632
    buffer_load_dwordx4 v[132:135], v21, s[36:39], s54 offen offset:1024 sc1
    v_mfma_f32_16x16x32_bf16 v[76:79], v[52:55], v[204:207], v[76:79]
    ds_read_b64_tr_b16 v[38:39], v5 offset:42144
    s_waitcnt lgkmcnt(4)
    v_mfma_f32_16x16x32_bf16 v[80:83], v[56:59], v[200:203], v[80:83]
    ds_read_b64_tr_b16 v[40:41], v8 offset:41600
    s_waitcnt vmcnt(10)
    v_mfma_f32_16x16x32_bf16 v[88:91], v[56:59], v[204:207], v[88:91]
    ds_read_b64_tr_b16 v[42:43], v8 offset:42112
    v_mfma_f32_16x16x32_bf16 v[84:87], v[60:63], v[200:203], v[84:87]
    ds_read_b64_tr_b16 v[44:45], v8 offset:41632
    v_mfma_f32_16x16x32_bf16 v[92:95], v[60:63], v[204:207], v[92:95]
    ds_read_b64_tr_b16 v[46:47], v8 offset:42144
    s_barrier
    s_waitcnt lgkmcnt(4)
    v_mfma_f32_16x16x32_bf16 v[64:67], v[32:35], v[208:211], v[64:67]
    ds_read_b64_tr_b16 v[48:49], v4 offset:8320
    s_add_u32 s54, s60, 12288
    buffer_load_dwordx4 v[136:139], v21, s[36:39], s54 offen sc1
    v_mfma_f32_16x16x32_bf16 v[72:75], v[32:35], v[212:215], v[72:75]
    ds_read_b64_tr_b16 v[50:51], v4 offset:8832
    v_mfma_f32_16x16x32_bf16 v[68:71], v[36:39], v[208:211], v[68:71]
    ds_read_b64_tr_b16 v[52:53], v4 offset:8352
    buffer_load_dwordx4 v[140:143], v21, s[36:39], s54 offen offset:1024 sc1
    v_mfma_f32_16x16x32_bf16 v[76:79], v[36:39], v[212:215], v[76:79]
    ds_read_b64_tr_b16 v[54:55], v4 offset:8864
    s_waitcnt lgkmcnt(4)
    v_mfma_f32_16x16x32_bf16 v[80:83], v[40:43], v[208:211], v[80:83]
    ds_read_b64_tr_b16 v[56:57], v7 offset:8320
    s_waitcnt vmcnt(10)
    v_mfma_f32_16x16x32_bf16 v[88:91], v[40:43], v[212:215], v[88:91]
    ds_read_b64_tr_b16 v[58:59], v7 offset:8832
    v_mfma_f32_16x16x32_bf16 v[84:87], v[44:47], v[208:211], v[84:87]
    ds_read_b64_tr_b16 v[60:61], v7 offset:8352
    v_mfma_f32_16x16x32_bf16 v[92:95], v[44:47], v[212:215], v[92:95]
    ds_read_b64_tr_b16 v[62:63], v7 offset:8864
    s_waitcnt lgkmcnt(4)
    v_mfma_f32_16x16x32_bf16 v[64:67], v[48:51], v[216:219], v[64:67]
    ds_read_b64_tr_b16 v[32:33], v5 offset:33280
    s_add_u32 s54, s60, 20480
    buffer_load_dwordx4 v[144:147], v21, s[36:39], s54 offen sc1
    v_mfma_f32_16x16x32_bf16 v[72:75], v[48:51], v[220:223], v[72:75]
    ds_read_b64_tr_b16 v[34:35], v5 offset:33792
    v_mfma_f32_16x16x32_bf16 v[68:71], v[52:55], v[216:219], v[68:71]
    ds_read_b64_tr_b16 v[36:37], v5 offset:33312
    buffer_load_dwordx4 v[148:151], v21, s[36:39], s54 offen offset:1024 sc1
    v_mfma_f32_16x16x32_bf16 v[76:79], v[52:55], v[220:223], v[76:79]
    ds_read_b64_tr_b16 v[38:39], v5 offset:33824
    s_waitcnt lgkmcnt(4)
    v_mfma_f32_16x16x32_bf16 v[80:83], v[56:59], v[216:219], v[80:83]
    ds_read_b64_tr_b16 v[40:41], v8 offset:33280
    s_waitcnt vmcnt(9)
    v_mfma_f32_16x16x32_bf16 v[88:91], v[56:59], v[220:223], v[88:91]
    ds_read_b64_tr_b16 v[42:43], v8 offset:33792
    v_mfma_f32_16x16x32_bf16 v[84:87], v[60:63], v[216:219], v[84:87]
    ds_read_b64_tr_b16 v[44:45], v8 offset:33312
    v_mfma_f32_16x16x32_bf16 v[92:95], v[60:63], v[220:223], v[92:95]
    ds_read_b64_tr_b16 v[46:47], v8 offset:33824
    s_barrier
    s_waitcnt lgkmcnt(4)
    v_mfma_f32_16x16x32_bf16 v[64:67], v[32:35], v[224:227], v[64:67]
    ds_read_b64_tr_b16 v[48:49], v4 offset:16640
    s_add_u32 s54, s60, 28672
    buffer_load_dwordx4 v[152:155], v21, s[36:39], s54 offen sc1
    v_mfma_f32_16x16x32_bf16 v[72:75], v[32:35], v[228:231], v[72:75]
    ds_read_b64_tr_b16 v[50:51], v4 offset:17152
    v_mfma_f32_16x16x32_bf16 v[68:71], v[36:39], v[224:227], v[68:71]
    ds_read_b64_tr_b16 v[52:53], v4 offset:16672
    buffer_load_dwordx4 v[156:159], v21, s[36:39], s54 offen offset:1024 sc1
    v_mfma_f32_16x16x32_bf16 v[76:79], v[36:39], v[228:231], v[76:79]
    ds_read_b64_tr_b16 v[54:55], v4 offset:17184
    s_waitcnt lgkmcnt(4)
    v_mfma_f32_16x16x32_bf16 v[80:83], v[40:43], v[224:227], v[80:83]
    ds_read_b64_tr_b16 v[56:57], v7 offset:16640
    s_waitcnt vmcnt(9)
    v_mfma_f32_16x16x32_bf16 v[88:91], v[40:43], v[228:231], v[88:91]
    ds_read_b64_tr_b16 v[58:59], v7 offset:17152
    v_mfma_f32_16x16x32_bf16 v[84:87], v[44:47], v[224:227], v[84:87]
    ds_read_b64_tr_b16 v[60:61], v7 offset:16672
    v_mfma_f32_16x16x32_bf16 v[92:95], v[44:47], v[228:231], v[92:95]
    ds_read_b64_tr_b16 v[62:63], v7 offset:17184
    s_waitcnt lgkmcnt(4)
    v_mfma_f32_16x16x32_bf16 v[64:67], v[48:51], v[232:235], v[64:67]
    ds_read_b64_tr_b16 v[32:33], v5 offset:49920
    s_add_u32 s54, s60, 36864
    buffer_load_dwordx4 v[160:163], v21, s[36:39], s54 offen sc1
    v_mfma_f32_16x16x32_bf16 v[72:75], v[48:51], v[236:239], v[72:75]
    ds_read_b64_tr_b16 v[34:35], v5 offset:50432
    v_mfma_f32_16x16x32_bf16 v[68:71], v[52:55], v[232:235], v[68:71]
    ds_read_b64_tr_b16 v[36:37], v5 offset:49952
    buffer_load_dwordx4 v[164:167], v21, s[36:39], s54 offen offset:1024 sc1
    v_mfma_f32_16x16x32_bf16 v[76:79], v[52:55], v[236:239], v[76:79]
    ds_read_b64_tr_b16 v[38:39], v5 offset:50464
    s_waitcnt lgkmcnt(4)
    v_mfma_f32_16x16x32_bf16 v[80:83], v[56:59], v[232:235], v[80:83]
    ds_read_b64_tr_b16 v[40:41], v8 offset:49920
    s_waitcnt vmcnt(8)
    v_mfma_f32_16x16x32_bf16 v[88:91], v[56:59], v[236:239], v[88:91]
    ds_read_b64_tr_b16 v[42:43], v8 offset:50432
    v_max_u32 v30, v128, v132
    v_mfma_f32_16x16x32_bf16 v[84:87], v[60:63], v[232:235], v[84:87]
    ds_read_b64_tr_b16 v[44:45], v8 offset:49952
    v_cmp_eq_u32 vcc, -1, v30
    v_mfma_f32_16x16x32_bf16 v[92:95], v[60:63], v[236:239], v[92:95]
    ds_read_b64_tr_b16 v[46:47], v8 offset:50464
    s_cbranch_vccnz KF_ch14_r
KF_ch14_ok:
    s_barrier
    s_waitcnt lgkmcnt(4)
    v_mfma_f32_16x16x32_bf16 v[64:67], v[32:35], v[128:131], v[64:67]
    ds_read_b64_tr_b16 v[48:49], v4 offset:24960
    s_add_u32 s54, s60, 45056
    buffer_load_dwordx4 v[168:171], v21, s[36:39], s54 offen sc1
    v_mfma_f32_16x16x32_bf16 v[72:75], v[32:35], v[132:135], v[72:75]
    ds_read_b64_tr_b16 v[50:51], v4 offset:25472
    v_mfma_f32_16x16x32_bf16 v[68:71], v[36:39], v[128:131], v[68:71]
    ds_read_b64_tr_b16 v[52:53], v4 offset:24992
    buffer_load_dwordx4 v[172:175], v21, s[36:39], s54 offen offset:1024 sc1
    v_mfma_f32_16x16x32_bf16 v[76:79], v[36:39], v[132:135], v[76:79]
    ds_read_b64_tr_b16 v[54:55], v4 offset:25504
    s_waitcnt lgkmcnt(4)
    v_mfma_f32_16x16x32_bf16 v[80:83], v[40:43], v[128:131], v[80:83]
    ds_read_b64_tr_b16 v[56:57], v7 offset:24960
    s_waitcnt vmcnt(8)
    v_mfma_f32_16x16x32_bf16 v[88:91], v[40:43], v[132:135], v[88:91]
    ds_read_b64_tr_b16 v[58:59], v7 offset:25472
    v_max_u32 v30, v136, v140
    v_mfma_f32_16x16x32_bf16 v[84:87], v[44:47], v[128:131], v[84:87]
    ds_read_b64_tr_b16 v[60:61], v7 offset:24992
    v_cmp_eq_u32 vcc, -1, v30
    v_mfma_f32_16x16x32_bf16 v[92:95], v[44:47], v[132:135], v[92:95]
    ds_read_b64_tr_b16 v[62:63], v7 offset:25504
    s_cbranch_vccnz KF_ch15_r
KF_ch15_ok:
    s_waitcnt lgkmcnt(4)
    v_mfma_f32_16x16x32_bf16 v[64:67], v[48:51], v[136:139], v[64:67]
    ds_read_b64_tr_b16 v[32:33], v6 offset:0
    s_add_u32 s54, s60, 53248
    buffer_load_dwordx4 v[176:179], v21, s[36:39], s54 offen sc1
    v_mfma_f32_16x16x32_bf16 v[72:75], v[48:51], v[140:143], v[72:75]
    ds_read_b64_tr_b16 v[34:35], v6 offset:512
    v_mfma_f32_16x16x32_bf16 v[68:71], v[52:55], v[136:139], v[68:71]
    ds_read_b64_tr_b16 v[36:37], v6 offset:32
    buffer_load_dwordx4 v[180:183], v21, s[36:39], s54 offen offset:1024 sc1
    v_mfma_f32_16x16x32_bf16 v[76:79], v[52:55], v[140:143], v[76:79]
    ds_read_b64_tr_b16 v[38:39], v6 offset:544
    s_waitcnt lgkmcnt(4)
    v_mfma_f32_16x16x32_bf16 v[80:83], v[56:59], v[136:139], v[80:83]
    ds_read_b64_tr_b16 v[40:41], v9 offset:0
    s_waitcnt vmcnt(8)
    v_mfma_f32_16x16x32_bf16 v[88:91], v[56:59], v[140:143], v[88:91]
    ds_read_b64_tr_b16 v[42:43], v9 offset:512
    v_max_u32 v30, v144, v148
    v_mfma_f32_16x16x32_bf16 v[84:87], v[60:63], v[136:139], v[84:87]
    ds_read_b64_tr_b16 v[44:45], v9 offset:32
    v_cmp_eq_u32 vcc, -1, v30
    v_mfma_f32_16x16x32_bf16 v[92:95], v[60:63], v[140:143], v[92:95]
    ds_read_b64_tr_b16 v[46:47], v9 offset:544
    s_cbranch_vccnz KF_ch16_r
KF_ch16_ok:
    s_barrier
    s_waitcnt lgkmcnt(4)
    v_mfma_f32_16x16x32_bf16 v[64:67], v[32:35], v[144:147], v[64:67]
    ds_read_b64_tr_b16 v[48:49], v4 offset:33280
    s_add_u32 s54, s53, 61440
    buffer_load_dwordx4 v[184:187], v21, s[36:39], s54 offen sc1
    v_mfma_f32_16x16x32_bf16 v[72:75], v[32:35], v[148:151], v[72:75]
    ds_read_b64_tr_b16 v[50:51], v4 offset:33792
    v_mfma_f32_16x16x32_bf16 v[68:71], v[36:39], v[144:147], v[68:71]
    ds_read_b64_tr_b16 v[52:53], v4 offset:33312
    buffer_load_dwordx4 v[188:191], v21, s[36:39], s54 offen offset:1024 sc1
    v_mfma_f32_16x16x32_bf16 v[76:79], v[36:39], v[148:151], v[76:79]
    ds_read_b64_tr_b16 v[54:55], v4 offset:33824
    s_waitcnt lgkmcnt(4)
    v_mfma_f32_16x16x32_bf16 v[80:83], v[40:43], v[144:147], v[80:83]
    ds_read_b64_tr_b16 v[56:57], v7 offset:33280
    s_waitcnt vmcnt(8)
    v_mfma_f32_16x16x32_bf16 v[88:91], v[40:43], v[148:151], v[88:91]
    ds_read_b64_tr_b16 v[58:59], v7 offset:33792
    v_max_u32 v30, v152, v156
    v_mfma_f32_16x16x32_bf16 v[84:87], v[44:47], v[144:147], v[84:87]
    ds_read_b64_tr_b16 v[60:61], v7 offset:33312
    v_cmp_eq_u32 vcc, -1, v30
    v_mfma_f32_16x16x32_bf16 v[92:95], v[44:47], v[148:151], v[92:95]
    ds_read_b64_tr_b16 v[62:63], v7 offset:33824
    s_cbranch_vccnz KF_ch17_r
KF_ch17_ok:
    s_waitcnt lgkmcnt(4)
    v_mfma_f32_16x16x32_bf16 v[64:67], v[48:51], v[152:155], v[64:67]
    ds_read_b64_tr_b16 v[32:33], v6 offset:8320
    s_add_u32 s54, s53, 69632
    buffer_load_dwordx4 v[192:195], v21, s[36:39], s54 offen sc1
    v_mfma_f32_16x16x32_bf16 v[72:75], v[48:51], v[156:159], v[72:75]
    ds_read_b64_tr_b16 v[34:35], v6 offset:8832
    v_mfma_f32_16x16x32_bf16 v[68:71], v[52:55], v[152:155], v[68:71]
    ds_read_b64_tr_b16 v[36:37], v6 offset:8352
    buffer_load_dwordx4 v[196:199], v21, s[36:39], s54 offen offset:1024 sc1
    v_mfma_f32_16x16x32_bf16 v[76:79], v[52:55], v[156:159], v[76:79]
    ds_read_b64_tr_b16 v[38:39], v6 offset:8864
    s_waitcnt lgkmcnt(4)
    v_mfma_f32_16x16x32_bf16 v[80:83], v[56:59], v[152:155], v[80:83]
    ds_read_b64_tr_b16 v[40:41], v9 offset:8320
    s_waitcnt vmcnt(8)
    v_mfma_f32_16x16x32_bf16 v[88:91], v[56:59], v[156:159], v[88:91]
    ds_read_b64_tr_b16 v[42:43], v9 offset:8832
    v_max_u32 v30, v160, v164
    v_mfma_f32_16x16x32_bf16 v[84:87], v[60:63], v[152:155], v[84:87]
    ds_read_b64_tr_b16 v[44:45], v9 offset:8352
    v_cmp_eq_u32 vcc, -1, v30
    v_mfma_f32_16x16x32_bf16 v[92:95], v[60:63], v[156:159], v[92:95]
    ds_read_b64_tr_b16 v[46:47], v9 offset:8864
    s_cbranch_vccnz KF_ch18_r
KF_ch18_ok:
    s_barrier
    s_waitcnt lgkmcnt(4)
    v_mfma_f32_16x16x32_bf16 v[64:67], v[32:35], v[160:163], v[64:67]
    ds_read_b64_tr_b16 v[48:49], v4 offset:41600
    s_add_u32 s54, s53, 77824
    buffer_load_dwordx4 v[200:203], v21, s[36:39], s54 offen sc1
    v_mfma_f32_16x16x32_bf16 v[72:75], v[32:35], v[164:167], v[72:75]
    ds_read_b64_tr_b16 v[50:51], v4 offset:42112
    v_mfma_f32_16x16x32_bf16 v[68:71], v[36:39], v[160:163], v[68:71]
    ds_read_b64_tr_b16 v[52:53], v4 offset:41632
    buffer_load_dwordx4 v[204:207], v21, s[36:39], s54 offen offset:1024 sc1
    v_mfma_f32_16x16x32_bf16 v[76:79], v[36:39], v[164:167], v[76:79]
    ds_read_b64_tr_b16 v[54:55], v4 offset:42144
    s_waitcnt lgkmcnt(4)
    v_mfma_f32_16x16x32_bf16 v[80:83], v[40:43], v[160:163], v[80:83]
    ds_read_b64_tr_b16 v[56:57], v7 offset:41600
    s_waitcnt vmcnt(8)
    v_mfma_f32_16x16x32_bf16 v[88:91], v[40:43], v[164:167], v[88:91]
    ds_read_b64_tr_b16 v[58:59], v7 offset:42112
    v_max_u32 v30, v168, v172
    v_mfma_f32_16x16x32_bf16 v[84:87], v[44:47], v[160:163], v[84:87]
    ds_read_b64_tr_b16 v[60:61], v7 offset:41632
    v_cmp_eq_u32 vcc, -1, v30
    v_mfma_f32_16x16x32_bf16 v[92:95], v[44:47], v[164:167], v[92:95]
    ds_read_b64_tr_b16 v[62:63], v7 offset:42144
    s_cbranch_vccnz KF_ch19_r
KF_ch19_ok:
    s_waitcnt lgkmcnt(4)
    v_mfma_f32_16x16x32_bf16 v[64:67], v[48:51], v[168:171], v[64:67]
    ds_read_b64_tr_b16 v[32:33], v6 offset:16640
    s_add_u32 s54, s53, 86016
    buffer_load_dwordx4 v[208:211], v21, s[36:39], s54 offen sc1
    v_mfma_f32_16x16x32_bf16 v[72:75], v[48:51], v[172:175], v[72:75]
    ds_read_b64_tr_b16 v[34:35], v6 offset:17152
    v_mfma_f32_16x16x32_bf16 v[68:71], v[52:55], v[168:171], v[68:71]
    ds_read_b64_tr_b16 v[36:37], v6 offset:16672
    buffer_load_dwordx4 v[212:215], v21, s[36:39], s54 offen offset:1024 sc1
    v_mfma_f32_16x16x32_bf16 v[76:79], v[52:55], v[172:175], v[76:79]
    ds_read_b64_tr_b16 v[38:39], v6 offset:17184
    s_waitcnt lgkmcnt(4)
    v_mfma_f32_16x16x32_bf16 v[80:83], v[56:59], v[168:171], v[80:83]
    ds_read_b64_tr_b16 v[40:41], v9 offset:16640
    s_waitcnt vmcnt(8)
    v_mfma_f32_16x16x32_bf16 v[88:91], v[56:59], v[172:175], v[88:91]
    ds_read_b64_tr_b16 v[42:43], v9 offset:17152
    v_max_u32 v30, v176, v180
    v_mfma_f32_16x16x32_bf16 v[84:87], v[60:63], v[168:171], v[84:87]
    ds_read_b64_tr_b16 v[44:45], v9 offset:16672
    v_cmp_eq_u32 vcc, -1, v30
    v_mfma_f32_16x16x32_bf16 v[92:95], v[60:63], v[172:175], v[92:95]
    ds_read_b64_tr_b16 v[46:47], v9 offset:17184
    s_cbranch_vccnz KF_ch20_r
KF_ch20_ok:
    s_barrier
    s_waitcnt lgkmcnt(4)
    v_mfma_f32_16x16x32_bf16 v[64:67], v[32:35], v[176:179], v[64:67]
    ds_read_b64_tr_b16 v[48:49], v4 offset:49920
    s_add_u32 s54, s53, 94208
    buffer_load_dwordx4 v[216:219], v21, s[36:39], s54 offen sc1
    v_mfma_f32_16x16x32_bf16 v[72:75], v[32:35], v[180:183], v[72:75]
    ds_read_b64_tr_b16 v[50:51], v4 offset:50432
    v_mfma_f32_16x16x32_bf16 v[68:71], v[36:39], v[176:179], v[68:71]
    ds_read_b64_tr_b16 v[52:53], v4 offset:49952
    buffer_load_dwordx4 v[220:223], v21, s[36:39], s54 offen offset:1024 sc1
    v_mfma_f32_16x16x32_bf16 v[76:79], v[36:39], v[180:183], v[76:79]
    ds_read_b64_tr_b16 v[54:55], v4 offset:50464
    s_waitcnt lgkmcnt(4)
    v_mfma_f32_16x16x32_bf16 v[80:83], v[40:43], v[176:179], v[80:83]
    ds_read_b64_tr_b16 v[56:57], v7 offset:49920
    s_waitcnt vmcnt(8)
    v_mfma_f32_16x16x32_bf16 v[88:91], v[40:43], v[180:183], v[88:91]
    ds_read_b64_tr_b16 v[58:59], v7 offset:50432
    v_max_u32 v30, v184, v188
    v_mfma_f32_16x16x32_bf16 v[84:87], v[44:47], v[176:179], v[84:87]
    ds_read_b64_tr_b16 v[60:61], v7 offset:49952
    v_cmp_eq_u32 vcc, -1, v30
    v_mfma_f32_16x16x32_bf16 v[92:95], v[44:47], v[180:183], v[92:95]
    ds_read_b64_tr_b16 v[62:63], v7 offset:50464
    s_cbranch_vccnz KF_ch21_r
KF_ch21_ok:
    s_waitcnt lgkmcnt(4)
    v_mfma_f32_16x16x32_bf16 v[64:67], v[48:51], v[184:187], v[64:67]
    ds_read_b64_tr_b16 v[32:33], v6 offset:24960
    s_add_u32 s54, s53, 102400
    buffer_load_dwordx4 v[224:227], v21, s[36:39], s54 offen sc1
    v_mfma_f32_16x16x32_bf16 v[72:75], v[48:51], v[188:191], v[72:75]
    ds_read_b64_tr_b16 v[34:35], v6 offset:25472
    v_mfma_f32_16x16x32_bf16 v[68:71], v[52:55], v[184:187], v[68:71]
    ds_read_b64_tr_b16 v[36:37], v6 offset:24992
    buffer_load_dwordx4 v[228:231], v21, s[36:39], s54 offen offset:1024 sc1
    v_mfma_f32_16x16x32_bf16 v[76:79], v[52:55], v[188:191], v[76:79]
    ds_read_b64_tr_b16 v[38:39], v6 offset:25504
    s_waitcnt lgkmcnt(4)
    v_mfma_f32_16x16x32_bf16 v[80:83], v[56:59], v[184:187], v[80:83]
    ds_read_b64_tr_b16 v[40:41], v9 offset:24960
    s_waitcnt vmcnt(8)
    v_mfma_f32_16x16x32_bf16 v[88:91], v[56:59], v[188:191], v[88:91]
    ds_read_b64_tr_b16 v[42:43], v9 offset:25472
    v_max_u32 v30, v192, v196
    v_mfma_f32_16x16x32_bf16 v[84:87], v[60:63], v[184:187], v[84:87]
    ds_read_b64_tr_b16 v[44:45], v9 offset:24992
    v_cmp_eq_u32 vcc, -1, v30
    v_mfma_f32_16x16x32_bf16 v[92:95], v[60:63], v[188:191], v[92:95]
    ds_read_b64_tr_b16 v[46:47], v9 offset:25504
    s_cbranch_vccnz KF_ch22_r
KF_ch22_ok:
    s_barrier
    s_waitcnt lgkmcnt(4)
    v_mfma_f32_16x16x32_bf16 v[64:67], v[32:35], v[192:195], v[64:67]
    ds_read_b64_tr_b16 v[48:49], v5 offset:0
    s_add_u32 s54, s53, 110592
    buffer_load_dwordx4 v[232:235], v21, s[36:39], s54 offen sc1
    v_mfma_f32_16x16x32_bf16 v[72:75], v[32:35], v[196:199], v[72:75]
    ds_read_b64_tr_b16 v[50:51], v5 offset:512
    v_mfma_f32_16x16x32_bf16 v[68:71], v[36:39], v[192:195], v[68:71]
    ds_read_b64_tr_b16 v[52:53], v5 offset:32
    buffer_load_dwordx4 v[236:239], v21, s[36:39], s54 offen offset:1024 sc1
    v_mfma_f32_16x16x32_bf16 v[76:79], v[36:39], v[196:199], v[76:79]
    ds_read_b64_tr_b16 v[54:55], v5 offset:544
    s_waitcnt lgkmcnt(4)
    v_mfma_f32_16x16x32_bf16 v[80:83], v[40:43], v[192:195], v[80:83]
    ds_read_b64_tr_b16 v[56:57], v8 offset:0
    s_waitcnt vmcnt(8)
    v_mfma_f32_16x16x32_bf16 v[88:91], v[40:43], v[196:199], v[88:91]
    ds_read_b64_tr_b16 v[58:59], v8 offset:512
    v_max_u32 v30, v200, v204
    v_mfma_f32_16x16x32_bf16 v[84:87], v[44:47], v[192:195], v[84:87]
    ds_read_b64_tr_b16 v[60:61], v8 offset:32
    v_cmp_eq_u32 vcc, -1, v30
    v_mfma_f32_16x16x32_bf16 v[92:95], v[44:47], v[196:199], v[92:95]
    ds_read_b64_tr_b16 v[62:63], v8 offset:544
    s_cbranch_vccnz KF_ch23_r
KF_ch23_ok:
    s_waitcnt lgkmcnt(4)
    v_mfma_f32_16x16x32_bf16 v[64:67], v[48:51], v[200:203], v[64:67]
    ds_read_b64_tr_b16 v[32:33], v6 offset:33280
    v_mfma_f32_16x16x32_bf16 v[72:75], v[48:51], v[204:207], v[72:75]
    ds_read_b64_tr_b16 v[34:35], v6 offset:33792
    v_mfma_f32_16x16x32_bf16 v[68:71], v[52:55], v[200:203], v[68:71]
    ds_read_b64_tr_b16 v[36:37], v6 offset:33312
    v_mfma_f32_16x16x32_bf16 v[76:79], v[52:55], v[204:207], v[76:79]
    ds_read_b64_tr_b16 v[38:39], v6 offset:33824
    s_waitcnt lgkmcnt(4)
    v_mfma_f32_16x16x32_bf16 v[80:83], v[56:59], v[200:203], v[80:83]
    ds_read_b64_tr_b16 v[40:41], v9 offset:33280
    s_waitcnt vmcnt(6)
    v_mfma_f32_16x16x32_bf16 v[88:91], v[56:59], v[204:207], v[88:91]
    ds_read_b64_tr_b16 v[42:43], v9 offset:33792
    v_max_u32 v30, v208, v212
    v_mfma_f32_16x16x32_bf16 v[84:87], v[60:63], v[200:203], v[84:87]
HOP_8:
    s_cbranch_execz HOP_end
    ds_read_b64_tr_b16 v[44:45], v9 offset:33312
    v_cmp_eq_u32 vcc, -1, v30
    v_mfma_f32_16x16x32_bf16 v[92:95], v[60:63], v[204:207], v[92:95]
    ds_read_b64_tr_b16 v[46:47], v9 offset:33824
    s_cbranch_vccnz KF_ch24_r
KF_ch24_ok:
    s_barrier
    s_waitcnt lgkmcnt(4)
    v_mfma_f32_16x16x32_bf16 v[64:67], v[32:35], v[208:211], v[64:67]
    ds_read_b64_tr_b16 v[48:49], v5 offset:8320
    v_mfma_f32_16x16x32_bf16 v[72:75], v[32:35], v[212:215], v[72:75]
    ds_read_b64_tr_b16 v[50:51], v5 offset:8832
    v_mfma_f32_16x16x32_bf16 v[68:71], v[36:39], v[208:211], v[68:71]
    ds_read_b64_tr_b16 v[52:53], v5 offset:8352
    v_mfma_f32_16x16x32_bf16 v[76:79], v[36:39], v[212:215], v[76:79]
    ds_read_b64_tr_b16 v[54:55], v5 offset:8864
    s_waitcnt lgkmcnt(4)
    v_mfma_f32_16x16x32_bf16 v[80:83], v[40:43], v[208:211], v[80:83]
    ds_read_b64_tr_b16 v[56:57], v8 offset:8320
    s_waitcnt vmcnt(4)
    v_mfma_f32_16x16x32_bf16 v[88:91], v[40:43], v[212:215], v[88:91]
    ds_read_b64_tr_b16 v[58:59], v8 offset:8832
    v_max_u32 v30, v216, v220
    v_mfma_f32_16x16x32_bf16 v[84:87], v[44:47], v[208:211], v[84:87]
    ds_read_b64_tr_b16 v[60:61], v8 offset:8352
    v_cmp_eq_u32 vcc, -1, v30
    v_mfma_f32_16x16x32_bf16 v[92:95], v[44:47], v[212:215], v[92:95]
    ds_read_b64_tr_b16 v[62:63], v8 offset:8864
    s_cbranch_vccnz KF_ch25_r
KF_ch25_ok:
    s_waitcnt lgkmcnt(4)
    v_mfma_f32_16x16x32_bf16 v[64:67], v[48:51], v[216:219], v[64:67]
    ds_read_b64_tr_b16 v[32:33], v4 offset:0
    v_mfma_f32_16x16x32_bf16 v[72:75], v[48:51], v[220:223], v[72:75]
    ds_read_b64_tr_b16 v[34:35], v4 offset:512
    v_mfma_f32_16x16x32_bf16 v[68:71], v[52:55], v[216:219], v[68:71]
    ds_read_b64_tr_b16 v[36:37], v4 offset:32
    v_mfma_f32_16x16x32_bf16 v[76:79], v[52:55], v[220:223], v[76:79]
    ds_read_b64_tr_b16 v[38:39], v4 offset:544
    s_waitcnt lgkmcnt(4)
    v_mfma_f32_16x16x32_bf16 v[80:83], v[56:59], v[216:219], v[80:83]
    ds_read_b64_tr_b16 v[40:41], v7 offset:0
    s_waitcnt vmcnt(2)
    v_mfma_f32_16x16x32_bf16 v[88:91], v[56:59], v[220:223], v[88:91]
    ds_read_b64_tr_b16 v[42:43], v7 offset:512
    v_max_u32 v30, v224, v228
    v_mfma_f32_16x16x32_bf16 v[84:87], v[60:63], v[216:219], v[84:87]
    ds_read_b64_tr_b16 v[44:45], v7 offset:32
    v_cmp_eq_u32 vcc, -1, v30
    v_mfma_f32_16x16x32_bf16 v[92:95], v[60:63], v[220:223], v[92:95]
    ds_read_b64_tr_b16 v[46:47], v7 offset:544
    s_cbranch_vccnz KF_ch26_r
KF_ch26_ok:
    s_barrier
    s_waitcnt lgkmcnt(4)
    v_mfma_f32_16x16x32_bf16 v[64:67], v[32:35], v[224:227], v[64:67]
    ds_read_b64_tr_b16 v[96:97], v20 offset:0
    v_mfma_f32_16x16x32_bf16 v[72:75], v[32:35], v[228:231], v[72:75]
    ds_read_b64_tr_b16 v[98:99], v20 offset:512
    ds_read_b64_tr_b16 v[100:101], v20 offset:32
    v_mfma_f32_16x16x32_bf16 v[68:71], v[36:39], v[224:227], v[68:71]
    ds_read_b64_tr_b16 v[102:103], v20 offset:544
    v_mfma_f32_16x16x32_bf16 v[76:79], v[36:39], v[228:231], v[76:79]
    ds_read_b64_tr_b16 v[48:49], v5 offset:16640
    ds_read_b64_tr_b16 v[50:51], v5 offset:17152
    s_waitcnt lgkmcnt(6)
    v_mfma_f32_16x16x32_bf16 v[80:83], v[40:43], v[224:227], v[80:83]
    ds_read_b64_tr_b16 v[52:53], v5 offset:16672
    s_waitcnt vmcnt(0)
    v_mfma_f32_16x16x32_bf16 v[88:91], v[40:43], v[228:231], v[88:91]
    ds_read_b64_tr_b16 v[54:55], v5 offset:17184
    ds_read_b64_tr_b16 v[56:57], v8 offset:16640
    v_max_u32 v30, v232, v236
    v_mfma_f32_16x16x32_bf16 v[84:87], v[44:47], v[224:227], v[84:87]
    ds_read_b64_tr_b16 v[58:59], v8 offset:17152
    v_cmp_eq_u32 vcc, -1, v30
    v_mfma_f32_16x16x32_bf16 v[92:95], v[44:47], v[228:231], v[92:95]
    ds_read_b64_tr_b16 v[60:61], v8 offset:16672
    ds_read_b64_tr_b16 v[62:63], v8 offset:17184
    s_cbranch_vccnz KF_ch27_r
KF_ch27_ok:
    s_waitcnt lgkmcnt(0)
    v_mfma_f32_16x16x32_bf16 v[80:83], v[56:59], v[232:235], v[80:83]
    v_lshlrev_b32 v104, 16, v96
    v_and_b32 v105, s62, v96
    v_mfma_f32_16x16x32_bf16 v[88:91], v[56:59], v[236:239], v[88:91]
    v_lshlrev_b32 v106, 16, v97
    v_and_b32 v107, s62, v97
    v_mfma_f32_16x16x32_bf16 v[84:87], v[60:63], v[232:235], v[84:87]
    v_lshlrev_b32 v108, 16, v98
    v_and_b32 v109, s62, v98
    v_mfma_f32_16x16x32_bf16 v[92:95], v[60:63], v[236:239], v[92:95]
    v_lshlrev_b32 v110, 16, v99
    v_and_b32 v111, s62, v99
    v_mfma_f32_16x16x32_bf16 v[64:67], v[48:51], v[232:235], v[64:67]
    v_lshlrev_b32 v112, 16, v100
    v_and_b32 v113, s62, v100
    v_mfma_f32_16x16x32_bf16 v[72:75], v[48:51], v[236:239], v[72:75]
    v_lshlrev_b32 v114, 16, v101
    v_and_b32 v115, s62, v101
    v_mfma_f32_16x16x32_bf16 v[68:71], v[52:55], v[232:235], v[68:71]
    v_lshlrev_b32 v116, 16, v102
    v_and_b32 v117, s62, v102
    v_mfma_f32_16x16x32_bf16 v[76:79], v[52:55], v[236:239], v[76:79]
    v_lshlrev_b32 v118, 16, v103
    v_and_b32 v119, s62, v103
    ds_write_b128 v22, v[80:83] offset:0
    ds_write_b128 v22, v[84:87] offset:1024
    ds_write_b128 v22, v[88:91] offset:2048
    ds_write_b128 v22, v[92:95] offset:3072
    s_waitcnt lgkmcnt(0)
    s_barrier
    ds_read_b128 v[32:35], v23 offset:0
    ds_read_b128 v[36:39], v23 offset:1024
    ds_read_b128 v[40:43], v23 offset:2048
    ds_read_b128 v[44:47], v23 offset:3072
    s_waitcnt lgkmcnt(2)
    v_pk_add_f32 v[64:65], v[64:65], v[32:33]
    v_pk_add_f32 v[66:67], v[66:67], v[34:35]
    v_pk_add_f32 v[68:69], v[68:69], v[36:37]
    v_pk_add_f32 v[70:71], v[70:71], v[38:39]
    v_cvt_pk_bf16_f32 v96, v64, v65
    v_cvt_pk_bf16_f32 v97, v66, v67
    v_cvt_pk_bf16_f32 v98, v68, v69
    v_cvt_pk_bf16_f32 v99, v70, v71
    v_lshlrev_b32 v64, 16, v96
    v_and_b32 v65, s62, v96
    v_lshlrev_b32 v66, 16, v97
    v_and_b32 v67, s62, v97
    v_lshlrev_b32 v68, 16, v98
    v_and_b32 v69, s62, v98
    v_lshlrev_b32 v70, 16, v99
    v_and_b32 v71, s62, v99
    v_pk_add_f32 v[64:65], v[64:65], v[104:105]
    v_pk_add_f32 v[66:67], v[66:67], v[106:107]
    v_pk_add_f32 v[68:69], v[68:69], v[108:109]
    v_pk_add_f32 v[70:71], v[70:71], v[110:111]
    v_cvt_pk_bf16_f32 v96, v64, v65
    v_cvt_pk_bf16_f32 v97, v66, v67
    v_cvt_pk_bf16_f32 v98, v68, v69
    v_cvt_pk_bf16_f32 v99, v70, v71
    s_nop 0
    v_permlane16_swap_b32 v96, v98
    v_permlane16_swap_b32 v97, v99
    buffer_store_dwordx4 v[96:99], v24, s[44:47], s67 offen
    s_waitcnt lgkmcnt(0)
    v_pk_add_f32 v[72:73], v[72:73], v[40:41]
    v_pk_add_f32 v[74:75], v[74:75], v[42:43]
    v_pk_add_f32 v[76:77], v[76:77], v[44:45]
    v_pk_add_f32 v[78:79], v[78:79], v[46:47]
    v_cvt_pk_bf16_f32 v100, v72, v73
    v_cvt_pk_bf16_f32 v101, v74, v75
    v_cvt_pk_bf16_f32 v102, v76, v77
    v_cvt_pk_bf16_f32 v103, v78, v79
    v_lshlrev_b32 v72, 16, v100
    v_and_b32 v73, s62, v100
    v_lshlrev_b32 v74, 16, v101
    v_and_b32 v75, s62, v101
    v_lshlrev_b32 v76, 16, v102
    v_and_b32 v77, s62, v102
    v_lshlrev_b32 v78, 16, v103
    v_and_b32 v79, s62, v103
    v_pk_add_f32 v[72:73], v[72:73], v[112:113]
    v_pk_add_f32 v[74:75], v[74:75], v[114:115]
    v_pk_add_f32 v[76:77], v[76:77], v[116:117]
    v_pk_add_f32 v[78:79], v[78:79], v[118:119]
    v_cvt_pk_bf16_f32 v100, v72, v73
    v_cvt_pk_bf16_f32 v101, v74, v75
    v_cvt_pk_bf16_f32 v102, v76, v77
    v_cvt_pk_bf16_f32 v103, v78, v79
    s_nop 0
    v_permlane16_swap_b32 v100, v102
    v_permlane16_swap_b32 v101, v103
    buffer_store_dwordx4 v[100:103], v24, s[44:47], s63 offen
    s_endpgm
M_SC:
HOP_9:
    s_cbranch_execz HOP_end
    s_add_u32 s20, s64, 6291456
    s_addc_u32 s21, s65, 0
    s_mov_b32 s22, 2097152
    s_mov_b32 s23, 0x20000
M_S:
    s_and_b32 s14, s2, 3
    s_lshl_b32 s14, s14, 3
    s_and_b32 s54, s2, 4
    s_add_u32 s14, s14, s54
    s_and_b32 s54, s66, 3
    s_add_u32 s14, s14, s54
    v_lshrrev_b32 v30, 3, v2
    v_and_b32 v31, 7, v2
    v_lshrrev_b32 v29, 2, v2
    v_and_b32 v29, 4, v29
    v_xor_b32 v31, v31, v29
    v_lshlrev_b32 v31, 4, v31
    v_lshl_add_u32 v30, v30, 12, v31
    s_lshl_b32 s63, s3, 18
    s_lshl_b32 s61, s14, 7
    s_add_u32 s63, s63, s61
    s_lshl_b32 s62, s3, 13
KF_sld:
    s_mov_b32 s54, s63
    s_mov_b32 m0, s62
    s_nop 0
    buffer_load_dwordx4 v30, s[20:23], s54 offen sc1 lds
    s_add_u32 s54, s54, 0x8000
    s_add_u32 m0, m0, 1024
    s_nop 0
    buffer_load_dwordx4 v30, s[20:23], s54 offen sc1 lds
    s_add_u32 s54, s54, 0x8000
    s_add_u32 m0, m0, 1024
    s_nop 0
    buffer_load_dwordx4 v30, s[20:23], s54 offen sc1 lds
    s_add_u32 s54, s54, 0x8000
    s_add_u32 m0, m0, 1024
    s_nop 0
    buffer_load_dwordx4 v30, s[20:23], s54 offen sc1 lds
    s_add_u32 s54, s54, 0x8000
    s_add_u32 m0, m0, 1024
    s_nop 0
    buffer_load_dwordx4 v30, s[20:23], s54 offen sc1 lds
    s_add_u32 s54, s54, 0x8000
    s_add_u32 m0, m0, 1024
    s_nop 0
    buffer_load_dwordx4 v30, s[20:23], s54 offen sc1 lds
    s_add_u32 s54, s54, 0x8000
    s_add_u32 m0, m0, 1024
    s_nop 0
    buffer_load_dwordx4 v30, s[20:23], s54 offen sc1 lds
    s_add_u32 s54, s54, 0x8000
    s_add_u32 m0, m0, 1024
    s_nop 0
    buffer_load_dwordx4 v30, s[20:23], s54 offen sc1 lds
    v_bfe_u32 v96, v2, 2, 2
    v_lshrrev_b32 v97, 5, v2
    v_lshrrev_b32 v98, 1, v96
    v_xor_b32 v97, v97, v98
    v_lshlrev_b32 v96, 7, v96
    v_lshl_add_u32 v96, v97, 6, v96
    v_bfe_u32 v97, v2, 4, 1
    v_lshl_add_u32 v96, v97, 5, v96
    v_and_b32 v97, 3, v2
    v_lshl_add_u32 v96, v97, 3, v96
    v_add_u32 v96, s62, v96
    v_mov_b32 v99, 0x3f803f80
    s_add_u32 s68, s68, 1
    v_mov_b32 v100, 0
    v_mov_b32 v101, 0
    v_mov_b32 v102, 0
    v_mov_b32 v103, 0
    s_waitcnt vmcnt(7)
    ds_read_b64_tr_b16 v[64:65], v96 offset:0
    ds_read_b64_tr_b16 v[66:67], v96 offset:512
    s_waitcnt vmcnt(6)
    ds_read_b64_tr_b16 v[68:69], v96 offset:1024
    ds_read_b64_tr_b16 v[70:71], v96 offset:1536
    s_waitcnt lgkmcnt(2)
    v_dot2c_f32_bf16 v100, v99, v64
    v_dot2c_f32_bf16 v101, v64, v64
    v_dot2c_f32_bf16 v102, v99, v65
    v_dot2c_f32_bf16 v103, v65, v65
    v_dot2c_f32_bf16 v100, v99, v66
    v_dot2c_f32_bf16 v101, v66, v66
    v_dot2c_f32_bf16 v102, v99, v67
    v_dot2c_f32_bf16 v103, v67, v67
    s_waitcnt vmcnt(5)
    ds_read_b64_tr_b16 v[72:73], v96 offset:2048
    ds_read_b64_tr_b16 v[74:75], v96 offset:2560
    s_waitcnt lgkmcnt(2)
    v_dot2c_f32_bf16 v100, v99, v68
    v_dot2c_f32_bf16 v101, v68, v68
    v_dot2c_f32_bf16 v102, v99, v69
    v_dot2c_f32_bf16 v103, v69, v69
    v_dot2c_f32_bf16 v100, v99, v70
    v_dot2c_f32_bf16 v101, v70, v70
    v_dot2c_f32_bf16 v102, v99, v71
    v_dot2c_f32_bf16 v103, v71, v71
    s_waitcnt vmcnt(4)
    ds_read_b64_tr_b16 v[76:77], v96 offset:3072
    ds_read_b64_tr_b16 v[78:79], v96 offset:3584
    s_waitcnt lgkmcnt(2)
    v_dot2c_f32_bf16 v100, v99, v72
    v_dot2c_f32_bf16 v101, v72, v72
    v_dot2c_f32_bf16 v102, v99, v73
    v_dot2c_f32_bf16 v103, v73, v73
    v_dot2c_f32_bf16 v100, v99, v74
    v_dot2c_f32_bf16 v101, v74, v74
    v_dot2c_f32_bf16 v102, v99, v75
    v_dot2c_f32_bf16 v103, v75, v75
    s_waitcnt vmcnt(3)
    ds_read_b64_tr_b16 v[80:81], v96 offset:4096
    ds_read_b64_tr_b16 v[82:83], v96 offset:4608
    s_waitcnt lgkmcnt(2)
    v_dot2c_f32_bf16 v100, v99, v76
    v_dot2c_f32_bf16 v101, v76, v76
    v_dot2c_f32_bf16 v102, v99, v77
    v_dot2c_f32_bf16 v103, v77, v77
    v_dot2c_f32_bf16 v100, v99, v78
    v_dot2c_f32_bf16 v101, v78, v78
    v_dot2c_f32_bf16 v102, v99, v79
    v_dot2c_f32_bf16 v103, v79, v79
    s_waitcnt vmcnt(2)
    ds_read_b64_tr_b16 v[84:85], v96 offset:5120
    ds_read_b64_tr_b16 v[86:87], v96 offset:5632
    s_waitcnt lgkmcnt(2)
    v_dot2c_f32_bf16 v100, v99, v80
    v_dot2c_f32_bf16 v101, v80, v80
    v_dot2c_f32_bf16 v102, v99, v81
    v_dot2c_f32_bf16 v103, v81, v81
    v_dot2c_f32_bf16 v100, v99, v82
    v_dot2c_f32_bf16 v101, v82, v82
    v_dot2c_f32_bf16 v102, v99, v83
    v_dot2c_f32_bf16 v103, v83, v83
    s_waitcnt vmcnt(1)
    ds_read_b64_tr_b16 v[88:89], v96 offset:6144
    ds_read_b64_tr_b16 v[90:91], v96 offset:6656
    s_waitcnt lgkmcnt(2)
    v_dot2c_f32_bf16 v100, v99, v84
    v_dot2c_f32_bf16 v101, v84, v84
    v_dot2c_f32_bf16 v102, v99, v85
    v_dot2c_f32_bf16 v103, v85, v85
    v_dot2c_f32_bf16 v100, v99, v86
    v_dot2c_f32_bf16 v101, v86, v86
    v_dot2c_f32_bf16 v102, v99, v87
    v_dot2c_f32_bf16 v103, v87, v87
    s_waitcnt vmcnt(0)
    ds_read_b64_tr_b16 v[92:93], v96 offset:7168
    ds_read_b64_tr_b16 v[94:95], v96 offset:7680
    s_waitcnt lgkmcnt(2)
    v_dot2c_f32_bf16 v100, v99, v88
    v_dot2c_f32_bf16 v101, v88, v88
    v_dot2c_f32_bf16 v102, v99, v89
    v_dot2c_f32_bf16 v103, v89, v89
    v_dot2c_f32_bf16 v100, v99, v90
    v_dot2c_f32_bf16 v101, v90, v90
    v_dot2c_f32_bf16 v102, v99, v91
    v_dot2c_f32_bf16 v103, v91, v91
    s_waitcnt lgkmcnt(0)
    v_dot2c_f32_bf16 v100, v99, v92
    v_dot2c_f32_bf16 v101, v92, v92
    v_dot2c_f32_bf16 v102, v99, v93
    v_dot2c_f32_bf16 v103, v93, v93
    v_dot2c_f32_bf16 v100, v99, v94
    v_dot2c_f32_bf16 v101, v94, v94
    v_dot2c_f32_bf16 v102, v99, v95
    v_dot2c_f32_bf16 v103, v95, v95
    v_lshlrev_b32 v31, 3, v2
    s_lshl_b32 s54, s3, 9
    s_add_u32 s54, s54, 159104
    v_add_u32 v29, s54, v31
    v_pk_add_f32 v[100:101], v[100:101], v[102:103]
    v_cmp_u_f32 vcc, v101, v101
    s_cmp_gt_u32 s68, 0x10000
    s_cbranch_scc1 KF_sok
    s_nop 3
    s_cbranch_vccnz KF_sld
KF_sok:
    ds_write_b64 v29, v[100:101]
    v_add_u32 v29, 159104, v31
    s_waitcnt lgkmcnt(0)
    s_barrier
    s_cmp_lg_u32 s3, 0
    s_cbranch_scc1 KF_sdone
    ds_read_b64 v[64:65], v29 offset:0
    ds_read_b64 v[66:67], v29 offset:512
    ds_read_b64 v[68:69], v29 offset:1024
    ds_read_b64 v[70:71], v29 offset:1536
    ds_read_b64 v[72:73], v29 offset:2048
    ds_read_b64 v[74:75], v29 offset:2560
    ds_read_b64 v[76:77], v29 offset:3072
    ds_read_b64 v[78:79], v29 offset:3584
    s_lshl_b32 s54, s14, 9
    s_add_u32 s54, s54, 131072
    s_mov_b32 s62, 0x3b000000
    s_waitcnt lgkmcnt(0)
    v_pk_add_f32 v[64:65], v[64:65], v[66:67]
    v_pk_add_f32 v[68:69], v[68:69], v[70:71]
    v_pk_add_f32 v[72:73], v[72:73], v[74:75]
    v_pk_add_f32 v[76:77], v[76:77], v[78:79]
    v_pk_add_f32 v[64:65], v[64:65], v[68:69]
    v_pk_add_f32 v[72:73], v[72:73], v[76:77]
    v_pk_add_f32 v[64:65], v[64:65], v[72:73]
    v_mul_f32 v64, s62, v64
    v_mul_f32 v65, s62, v65
    v_fma_f32 v65, -v64, v64, v65
    v_max_f32 v65, 0, v65
    v_cvt_pk_bf16_f32 v66, v64, v65
    v_lshlrev_b32 v64, 16, v66
    v_and_b32 v65, 0xffff0000, v66
    v_add_f32 v65, 0x3727c5ac, v65
    v_cvt_pk_bf16_f32 v65, v65, v65
    v_lshlrev_b32 v65, 16, v65
    v_sqrt_f32 v65, v65
    s_nop 0
    v_cvt_pk_bf16_f32 v65, v65, v65
    v_lshlrev_b32 v65, 16, v65
    buffer_store_dwordx2 v[64:65], v31, s[40:43], s54 offen sc1
KF_sdone:
    s_waitcnt vmcnt(0)
    s_barrier
    s_cmp_lt_u32 s3, 4
    s_cbranch_scc0 M_SL2
    s_and_b32 s61, s2, 3
    s_bfe_u32 s62, s2, 0x10002
    s_lshl_b32 s18, s61, 3
    s_and_b32 s54, s66, 7
    s_add_u32 s18, s18, s54
    s_lshl_b32 s19, s62, 2
    s_lshr_b32 s54, s66, 3
    s_add_u32 s19, s19, s54
    s_lshl_b32 s50, s19, 7
    s_mov_b32 s68, 0
    s_add_u32 s36, s64, 9437184
    s_addc_u32 s37, s65, 0
    s_mov_b32 s38, 7340032
    s_mov_b32 s39, 0x20000
    s_add_u32 s40, s64, 8388608
    s_addc_u32 s41, s65, 0
    s_mov_b32 s42, 1048576
    s_mov_b32 s43, 0x20000
    s_mov_b32 s44, s10
    s_mov_b32 s45, s11
    s_mov_b32 s46, 2097152
    s_mov_b32 s47, 0x20000
    v_bfe_u32 v25, v2, 4, 1
    v_bfe_u32 v26, v2, 3, 1
    v_lshl_add_u32 v25, v25, 1, v26
    v_bfe_u32 v26, v2, 2, 1
    v_lshrrev_b32 v27, 5, v2
    v_and_b32 v28, 3, v2
    v_mul_u32_u24 v29, 2080, v25
    v_lshl_add_u32 v29, v26, 7, v29
    v_lshl_add_u32 v29, v28, 3, v29
    s_lshr_b32 s62, s12, 1
    s_and_b32 s61, s12, 1
    s_lshl_b32 s54, s61, 10
    v_lshl_add_u32 v13, v27, 8, v29
    v_add_u32 v13, s54, v13
    s_lshl_b32 s30, s61, 6
    s_xor_b32 s31, s30, 64
    s_lshl_b32 s54, s62, 6
    s_add_u32 s54, s54, 83200
    v_add_u32 v20, s54, v13
    s_mul_i32 s63, s62, -91520
    s_add_u32 s63, s63, 99840
    s_lshl_b32 s54, s61, 12
    s_add_u32 s58, s63, s54
    v_lshl_add_u32 v22, v2, 4, s58
    s_xor_b32 s54, s54, 4096
    s_add_u32 s58, s63, s54
    v_lshl_add_u32 v23, v2, 4, s58
    v_and_b32 v24, 15, v2
    v_lshlrev_b32 v24, 10, v24
    v_lshl_add_u32 v24, v27, 4, v24
    v_bfe_u32 v30, v2, 4, 1
    v_lshl_add_u32 v24, v30, 5, v24
    s_lshl_b32 s63, s18, 16
    s_lshl_b32 s54, s62, 15
    s_add_u32 s63, s63, s54
    s_add_u32 s63, s63, s50
    s_add_u32 s63, s63, s30
    s_bfe_u32 s59, s2, 0x10002
    s_mul_i32 s58, s59, 57344
    s_mul_i32 s60, s18, 229376
    s_sub_u32 s53, s60, s58
    s_add_u32 s60, s60, s58
    s_mul_i32 s54, s62, 114688
    s_lshl_b32 s58, s61, 11
    s_add_u32 s54, s54, s58
    v_lshl_add_u32 v21, v2, 4, s54
    s_lshl_b32 s54, s18, 1
    s_add_u32 s59, s59, s54
    s_lshl_b32 s59, s59, 8
    s_add_u32 s59, s59, 147456
    s_xor_b32 s55, s59, 256
    s_mov_b32 s67, s63
    v_mov_b32 v28, 0
    v_add_u32 v4, s30, v13
    v_add_u32 v7, s31, v13
    v_add_u32 v5, 58240, v4
    v_add_u32 v6, 116480, v4
    v_add_u32 v8, 58240, v7
    v_add_u32 v9, 116480, v7
    s_mov_b64 exec, 1
    buffer_load_dword v29, v28, s[40:43], s59 offen sc1
    s_mov_b64 exec, -1
    s_waitcnt vmcnt(0)
    s_mov_b64 exec, 1
    v_cmp_ne_u32 vcc, 14, v29
    s_nop 4
    s_cbranch_vccz KF_ps_ok
KF_ps_lp:
    s_sleep 16
    buffer_load_dword v29, v28, s[40:43], s59 offen sc1
    s_add_u32 s68, s68, 1
    s_waitcnt vmcnt(0)
    v_cmp_ne_u32 vcc, 14, v29
    s_cmp_gt_u32 s68, 0x20000
    s_cbranch_scc1 KF_ps_ok
    s_nop 3
    s_cbranch_vccnz KF_ps_lp
KF_ps_ok:
    s_mov_b64 exec, -1
    s_mov_b64 exec, 1
    buffer_load_dword v29, v28, s[40:43], s55 offen sc1
    s_mov_b64 exec, -1
    s_waitcnt vmcnt(0)
    s_mov_b64 exec, 1
    v_cmp_ne_u32 vcc, 14, v29
    s_nop 4
    s_cbranch_vccz KF_pt_ok
KF_pt_lp:
    s_sleep 6
    buffer_load_dword v29, v28, s[40:43], s55 offen sc1
    s_add_u32 s68, s68, 1
    s_waitcnt vmcnt(0)
    v_cmp_ne_u32 vcc, 14, v29
    s_cmp_gt_u32 s68, 0x20000
    s_cbranch_scc1 KF_pt_ok
    s_nop 3
    s_cbranch_vccnz KF_pt_lp
KF_pt_ok:
    s_mov_b64 exec, -1
    s_add_u32 s54, s60, 0
    buffer_load_dwordx4 v[128:131], v21, s[36:39], s54 offen sc1
    buffer_load_dwordx4 v[132:135], v21, s[36:39], s54 offen offset:1024 sc1
    s_add_u32 s54, s60, 8192
    buffer_load_dwordx4 v[136:139], v21, s[36:39], s54 offen sc1
    buffer_load_dwordx4 v[140:143], v21, s[36:39], s54 offen offset:1024 sc1
    s_add_u32 s54, s60, 16384
    buffer_load_dwordx4 v[144:147], v21, s[36:39], s54 offen sc1
    buffer_load_dwordx4 v[148:151], v21, s[36:39], s54 offen offset:1024 sc1
    s_add_u32 s54, s60, 24576
    buffer_load_dwordx4 v[152:155], v21, s[36:39], s54 offen sc1
    buffer_load_dwordx4 v[156:159], v21, s[36:39], s54 offen offset:1024 sc1
    s_add_u32 s54, s60, 32768
    buffer_load_dwordx4 v[160:163], v21, s[36:39], s54 offen sc1
    buffer_load_dwordx4 v[164:167], v21, s[36:39], s54 offen offset:1024 sc1
    s_add_u32 s54, s60, 40960
    buffer_load_dwordx4 v[168:171], v21, s[36:39], s54 offen sc1
    buffer_load_dwordx4 v[172:175], v21, s[36:39], s54 offen offset:1024 sc1
    s_add_u32 s54, s60, 49152
    buffer_load_dwordx4 v[176:179], v21, s[36:39], s54 offen sc1
    buffer_load_dwordx4 v[180:183], v21, s[36:39], s54 offen offset:1024 sc1
    s_add_u32 s54, s53, 57344
    buffer_load_dwordx4 v[184:187], v21, s[36:39], s54 offen sc1
    buffer_load_dwordx4 v[188:191], v21, s[36:39], s54 offen offset:1024 sc1
    s_add_u32 s54, s53, 65536
    buffer_load_dwordx4 v[192:195], v21, s[36:39], s54 offen sc1
    buffer_load_dwordx4 v[196:199], v21, s[36:39], s54 offen offset:1024 sc1
    s_add_u32 s54, s53, 73728
    buffer_load_dwordx4 v[200:203], v21, s[36:39], s54 offen sc1
    buffer_load_dwordx4 v[204:207], v21, s[36:39], s54 offen offset:1024 sc1
    s_add_u32 s54, s53, 81920
    buffer_load_dwordx4 v[208:211], v21, s[36:39], s54 offen sc1
    buffer_load_dwordx4 v[212:215], v21, s[36:39], s54 offen offset:1024 sc1
    s_add_u32 s54, s53, 90112
    buffer_load_dwordx4 v[216:219], v21, s[36:39], s54 offen sc1
    buffer_load_dwordx4 v[220:223], v21, s[36:39], s54 offen offset:1024 sc1
    s_add_u32 s54, s53, 98304
    buffer_load_dwordx4 v[224:227], v21, s[36:39], s54 offen sc1
    buffer_load_dwordx4 v[228:231], v21, s[36:39], s54 offen offset:1024 sc1
    s_add_u32 s54, s53, 106496
    buffer_load_dwordx4 v[232:235], v21, s[36:39], s54 offen sc1
    buffer_load_dwordx4 v[236:239], v21, s[36:39], s54 offen offset:1024 sc1
    s_waitcnt vmcnt(0)
    s_barrier
    s_barrier
    ds_read_b64_tr_b16 v[32:33], v4 offset:41600
    ds_read_b64_tr_b16 v[34:35], v4 offset:42112
    ds_read_b64_tr_b16 v[36:37], v4 offset:41632
    ds_read_b64_tr_b16 v[38:39], v4 offset:42144
    ds_read_b64_tr_b16 v[40:41], v7 offset:41600
    ds_read_b64_tr_b16 v[42:43], v7 offset:42112
    ds_read_b64_tr_b16 v[44:45], v7 offset:41632
    ds_read_b64_tr_b16 v[46:47], v7 offset:42144
    s_branch KF_P2
M_SL2:
    s_and_b32 s61, s2, 3
    s_bfe_u32 s62, s2, 0x10002
    s_lshl_b32 s18, s61, 3
    s_and_b32 s54, s66, 7
    s_add_u32 s18, s18, s54
    s_lshl_b32 s19, s62, 2
    s_lshr_b32 s54, s66, 3
    s_add_u32 s19, s19, s54
    s_lshl_b32 s50, s19, 7
    s_mov_b32 s68, 0
    s_add_u32 s36, s64, 9437184
    s_addc_u32 s37, s65, 0
    s_mov_b32 s38, 7340032
    s_mov_b32 s39, 0x20000
    s_add_u32 s40, s64, 8388608
    s_addc_u32 s41, s65, 0
    s_mov_b32 s42, 1048576
    s_mov_b32 s43, 0x20000
    s_mov_b32 s32, s8
    s_mov_b32 s33, s9
    s_mov_b32 s34, 1835008
    s_mov_b32 s35, 0x20000
    s_mul_i32 s53, s12, 2080
    v_lshrrev_b32 v30, 4, v2
    v_bfe_u32 v29, v2, 3, 1
    v_lshl_add_u32 v30, v30, 3, v29
    s_lshl_b32 s54, s12, 1
    v_add_u32 v30, s54, v30
    v_and_b32 v31, 7, v2
    v_lshlrev_b32 v31, 4, v31
    v_lshl_add_u32 v13, v30, 10, v31
    v_add_u32 v14, 31744, v13
    v_lshl_add_u32 v16, v30, 12, v31
    v_add_u32 v17, 130048, v16
    s_lshl_b32 s55, s19, 18
    s_lshl_b32 s54, s18, 7
    s_add_u32 s55, s55, s54
    v_mov_b32 v28, 0
    s_bfe_u32 s54, s2, 0x10002
    s_mul_i32 s58, s54, 917504
    s_sub_u32 s56, s50, s58
    s_add_u32 s50, s50, s58
    s_mul_i32 s58, s54, 57344
    s_mul_i32 s51, s18, 229376
    s_sub_u32 s57, s51, s58
    s_add_u32 s51, s51, s58
    s_lshr_b32 s54, s12, 1
    s_mul_i32 s54, s54, 114688
    s_and_b32 s58, s12, 1
    s_lshl_b32 s58, s58, 11
    s_add_u32 s54, s54, s58
    v_lshl_add_u32 v15, v2, 4, s54
    s_bfe_u32 s59, s2, 0x10002
    s_lshl_b32 s54, s18, 1
    s_add_u32 s59, s59, s54
    s_lshl_b32 s59, s59, 8
    s_add_u32 s59, s59, 147456
    s_xor_b32 s58, s59, 256
    v_lshl_add_u32 v18, v2, 4, s53
    v_add_u32 v19, 58240, v18
    v_add_u32 v20, 116480, v18
    s_add_u32 m0, s53, 41600
    s_add_u32 s54, s50, 0
    buffer_load_dwordx4 v13, s[32:35], s54 offen lds
    buffer_load_dwordx4 v14, s[32:35], s54 offen offset:1024 lds
    s_add_u32 m0, s53, 133120
    s_add_u32 s54, s50, 131072
    buffer_load_dwordx4 v13, s[32:35], s54 offen lds
    buffer_load_dwordx4 v14, s[32:35], s54 offen offset:1024 lds
    s_add_u32 m0, s53, 49920
    s_add_u32 s54, s50, 262144
    buffer_load_dwordx4 v13, s[32:35], s54 offen lds
    buffer_load_dwordx4 v14, s[32:35], s54 offen offset:1024 lds
    s_add_u32 m0, s53, 141440
    s_add_u32 s54, s50, 393216
    buffer_load_dwordx4 v13, s[32:35], s54 offen lds
    buffer_load_dwordx4 v14, s[32:35], s54 offen offset:1024 lds
    s_add_u32 m0, s53, 58240
    s_add_u32 s54, s50, 524288
    buffer_load_dwordx4 v13, s[32:35], s54 offen lds
    buffer_load_dwordx4 v14, s[32:35], s54 offen offset:1024 lds
    s_add_u32 m0, s53, 149760
    s_add_u32 s54, s50, 655360
    buffer_load_dwordx4 v13, s[32:35], s54 offen lds
    buffer_load_dwordx4 v14, s[32:35], s54 offen offset:1024 lds
    s_add_u32 m0, s53, 66560
    s_add_u32 s54, s50, 786432
    buffer_load_dwordx4 v13, s[32:35], s54 offen lds
    buffer_load_dwordx4 v14, s[32:35], s54 offen offset:1024 lds
    s_add_u32 m0, s53, 0
    s_add_u32 s54, s56, 917504
    buffer_load_dwordx4 v13, s[32:35], s54 offen lds
    buffer_load_dwordx4 v14, s[32:35], s54 offen offset:1024 lds
    s_add_u32 m0, s53, 74880
    s_add_u32 s54, s56, 1048576
    buffer_load_dwordx4 v13, s[32:35], s54 offen lds
    buffer_load_dwordx4 v14, s[32:35], s54 offen offset:1024 lds
    s_add_u32 m0, s53, 83200
    s_add_u32 s54, s56, 1179648
    buffer_load_dwordx4 v13, s[32:35], s54 offen lds
    buffer_load_dwordx4 v14, s[32:35], s54 offen offset:1024 lds
    s_add_u32 m0, s53, 99840
    s_add_u32 s54, s56, 1310720
    buffer_load_dwordx4 v13, s[32:35], s54 offen lds
    buffer_load_dwordx4 v14, s[32:35], s54 offen offset:1024 lds
    s_add_u32 m0, s53, 8320
    s_add_u32 s54, s56, 1441792
    buffer_load_dwordx4 v13, s[32:35], s54 offen lds
    buffer_load_dwordx4 v14, s[32:35], s54 offen offset:1024 lds
    s_add_u32 m0, s53, 91520
    s_add_u32 s54, s56, 1572864
HOP_10:
    s_cbranch_execz HOP_end
    buffer_load_dwordx4 v13, s[32:35], s54 offen lds
    buffer_load_dwordx4 v14, s[32:35], s54 offen offset:1024 lds
    s_add_u32 m0, s53, 16640
    s_add_u32 s54, s56, 1703936
    buffer_load_dwordx4 v13, s[32:35], s54 offen lds
    buffer_load_dwordx4 v14, s[32:35], s54 offen offset:1024 lds
    s_add_u32 m0, s53, 108160
    s_add_u32 s54, s50, 65536
    buffer_load_dwordx4 v13, s[32:35], s54 offen lds
    buffer_load_dwordx4 v14, s[32:35], s54 offen offset:1024 lds
    s_add_u32 m0, s53, 24960
    s_add_u32 s54, s50, 196608
    buffer_load_dwordx4 v13, s[32:35], s54 offen lds
    buffer_load_dwordx4 v14, s[32:35], s54 offen offset:1024 lds
    s_add_u32 m0, s53, 116480
    s_add_u32 s54, s50, 327680
    buffer_load_dwordx4 v13, s[32:35], s54 offen lds
    buffer_load_dwordx4 v14, s[32:35], s54 offen offset:1024 lds
    s_and_b32 s61, s66, 3
    s_lshl_b32 s61, s61, 2
    s_add_u32 s61, s61, s12
    s_cmp_lt_u32 s61, 7
    s_cselect_b32 s54, s50, s56
    s_lshl_b32 s62, s61, 17
    s_add_u32 s54, s54, s62
    s_add_u32 s54, s54, 65536
    v_lshlrev_b32 v30, 10, v2
    s_cmp_lt_u32 s61, 3
    s_cbranch_scc1 KF_ntw
    s_cmp_ge_u32 s61, 14
    s_cbranch_scc1 KF_ntw
    buffer_load_dword v32, v30, s[32:35], s54 offen
    s_sub_u32 s54, s54, 128
KF_ntw:
    s_waitcnt vmcnt(0)
    s_barrier
    s_branch KF_L33
KF_ckh0_r:
    s_add_u32 m0, s52, 83200
    s_add_u32 s54, s48, 0
    buffer_load_dwordx4 v10, s[20:23], s54 offen sc1 lds
    buffer_load_dwordx4 v11, s[20:23], s54 offen offset:1024 sc1 lds
    s_add_u32 m0, s52, 91520
    s_add_u32 s54, s48, 131072
    buffer_load_dwordx4 v10, s[20:23], s54 offen sc1 lds
    buffer_load_dwordx4 v11, s[20:23], s54 offen offset:1024 sc1 lds
    s_add_u32 m0, s52, 108160
    s_add_u32 s54, s48, 262144
    buffer_load_dwordx4 v10, s[20:23], s54 offen sc1 lds
    buffer_load_dwordx4 v11, s[20:23], s54 offen offset:1024 sc1 lds
    s_add_u32 m0, s52, 116480
    s_add_u32 s54, s48, 393216
    buffer_load_dwordx4 v10, s[20:23], s54 offen sc1 lds
    buffer_load_dwordx4 v11, s[20:23], s54 offen offset:1024 sc1 lds
    s_add_u32 m0, s52, 124800
    s_add_u32 s54, s48, 524288
    buffer_load_dwordx4 v10, s[20:23], s54 offen sc1 lds
    buffer_load_dwordx4 v11, s[20:23], s54 offen offset:1024 sc1 lds
    s_waitcnt vmcnt(8)
    ds_read2st64_b32 v[46:47], v50 offset0:0 offset1:4
    s_add_u32 s68, s68, 1
    s_waitcnt lgkmcnt(0)
    v_max_u32 v46, v46, v47
    v_cmp_eq_u32 vcc, -1, v46
    s_cmp_gt_u32 s68, 0x20000
    s_cbranch_scc1 KF_ckh0_ok
    s_nop 3
    s_cbranch_vccnz KF_ckh0_r
    s_branch KF_ckh0_ok
KF_ckh1_r:
    s_add_u32 m0, s52, 91520
    s_add_u32 s54, s48, 131072
    buffer_load_dwordx4 v10, s[20:23], s54 offen sc1 lds
    buffer_load_dwordx4 v11, s[20:23], s54 offen offset:1024 sc1 lds
    s_waitcnt vmcnt(0)
    ds_read2st64_b32 v[46:47], v50 offset0:0 offset1:4
    s_add_u32 s68, s68, 1
    s_waitcnt lgkmcnt(0)
    v_max_u32 v46, v46, v47
    v_cmp_eq_u32 vcc, -1, v46
    s_cmp_gt_u32 s68, 0x20000
    s_cbranch_scc1 KF_ckh1_ok
    s_nop 3
    s_cbranch_vccnz KF_ckh1_r
    s_branch KF_ckh1_ok
KF_ckh2_r:
    s_add_u32 m0, s52, 108160
    s_add_u32 s54, s48, 262144
    buffer_load_dwordx4 v10, s[20:23], s54 offen sc1 lds
    buffer_load_dwordx4 v11, s[20:23], s54 offen offset:1024 sc1 lds
    s_waitcnt vmcnt(0)
    ds_read2st64_b32 v[46:47], v50 offset0:0 offset1:4
    s_add_u32 s68, s68, 1
    s_waitcnt lgkmcnt(0)
    v_max_u32 v46, v46, v47
    v_cmp_eq_u32 vcc, -1, v46
    s_cmp_gt_u32 s68, 0x20000
    s_cbranch_scc1 KF_ckh2_ok
    s_nop 3
    s_cbranch_vccnz KF_ckh2_r
    s_branch KF_ckh2_ok
KF_ckh3_r:
    s_add_u32 m0, s52, 116480
    s_add_u32 s54, s48, 393216
    buffer_load_dwordx4 v10, s[20:23], s54 offen sc1 lds
    buffer_load_dwordx4 v11, s[20:23], s54 offen offset:1024 sc1 lds
    s_add_u32 m0, s52, 124800
    s_add_u32 s54, s48, 524288
    buffer_load_dwordx4 v10, s[20:23], s54 offen sc1 lds
    buffer_load_dwordx4 v11, s[20:23], s54 offen offset:1024 sc1 lds
    s_waitcnt vmcnt(0)
    ds_read2st64_b32 v[46:47], v50 offset0:0 offset1:4
    ds_read2st64_b32 v[48:49], v51 offset0:0 offset1:4
    s_add_u32 s68, s68, 1
    s_waitcnt lgkmcnt(0)
    v_max3_u32 v46, v46, v48, v49
    v_max_u32 v46, v46, v47
    v_cmp_eq_u32 vcc, -1, v46
    s_cmp_gt_u32 s68, 0x20000
    s_cbranch_scc1 KF_ckh3_ok
    s_nop 3
    s_cbranch_vccnz KF_ckh3_r
    s_branch KF_ckh3_ok
KF_ckh5_r:
    s_add_u32 m0, s52, 133120
    s_add_u32 s54, s48, 655360
    buffer_load_dwordx4 v10, s[20:23], s54 offen sc1 lds
    buffer_load_dwordx4 v11, s[20:23], s54 offen offset:1024 sc1 lds
    s_add_u32 m0, s52, 141440
    s_add_u32 s54, s48, 786432
    buffer_load_dwordx4 v10, s[20:23], s54 offen sc1 lds
    buffer_load_dwordx4 v11, s[20:23], s54 offen offset:1024 sc1 lds
    s_waitcnt vmcnt(0)
    ds_read2st64_b32 v[46:47], v50 offset0:0 offset1:4
    ds_read2st64_b32 v[48:49], v51 offset0:0 offset1:4
    s_add_u32 s68, s68, 1
    s_waitcnt lgkmcnt(0)
    v_max3_u32 v46, v46, v48, v49
    v_max_u32 v46, v46, v47
    v_cmp_eq_u32 vcc, -1, v46
    s_cmp_gt_u32 s68, 0x20000
    s_cbranch_scc1 KF_ckh5_ok
    s_nop 3
    s_cbranch_vccnz KF_ckh5_r
    s_branch KF_ckh5_ok
KF_ckh7_r:
    s_add_u32 m0, s52, 149760
    s_add_u32 s54, s48, 917504
    buffer_load_dwordx4 v10, s[20:23], s54 offen sc1 lds
    buffer_load_dwordx4 v11, s[20:23], s54 offen offset:1024 sc1 lds
    s_add_u32 m0, s52, 0
    s_add_u32 s54, s48, 1048576
    buffer_load_dwordx4 v10, s[20:23], s54 offen sc1 lds
    buffer_load_dwordx4 v11, s[20:23], s54 offen offset:1024 sc1 lds
    s_waitcnt vmcnt(0)
    ds_read2st64_b32 v[46:47], v50 offset0:0 offset1:4
    ds_read2st64_b32 v[48:49], v51 offset0:0 offset1:4
    s_add_u32 s68, s68, 1
    s_waitcnt lgkmcnt(0)
    v_max3_u32 v46, v46, v48, v49
    v_max_u32 v46, v46, v47
    v_cmp_eq_u32 vcc, -1, v46
    s_cmp_gt_u32 s68, 0x20000
    s_cbranch_scc1 KF_ckh7_ok
    s_nop 3
    s_cbranch_vccnz KF_ckh7_r
    s_branch KF_ckh7_ok
KF_ckh9_r:
    s_add_u32 m0, s52, 83200
    s_add_u32 s54, s48, 1179648
    buffer_load_dwordx4 v10, s[20:23], s54 offen sc1 lds
    buffer_load_dwordx4 v11, s[20:23], s54 offen offset:1024 sc1 lds
    s_add_u32 m0, s52, 8320
    s_add_u32 s54, s48, 1310720
    buffer_load_dwordx4 v10, s[20:23], s54 offen sc1 lds
    buffer_load_dwordx4 v11, s[20:23], s54 offen offset:1024 sc1 lds
    s_waitcnt vmcnt(0)
    ds_read2st64_b32 v[46:47], v50 offset0:0 offset1:4
    ds_read2st64_b32 v[48:49], v51 offset0:0 offset1:4
    s_add_u32 s68, s68, 1
    s_waitcnt lgkmcnt(0)
    v_max3_u32 v46, v46, v48, v49
    v_max_u32 v46, v46, v47
    v_cmp_eq_u32 vcc, -1, v46
    s_cmp_gt_u32 s68, 0x20000
    s_cbranch_scc1 KF_ckh9_ok
    s_nop 3
    s_cbranch_vccnz KF_ckh9_r
    s_branch KF_ckh9_ok
KF_ckh11_r:
    s_add_u32 m0, s52, 91520
    s_add_u32 s54, s48, 1441792
    buffer_load_dwordx4 v10, s[20:23], s54 offen sc1 lds
    buffer_load_dwordx4 v11, s[20:23], s54 offen offset:1024 sc1 lds
    s_add_u32 m0, s52, 108160
    s_add_u32 s54, s48, 1572864
    buffer_load_dwordx4 v10, s[20:23], s54 offen sc1 lds
    buffer_load_dwordx4 v11, s[20:23], s54 offen offset:1024 sc1 lds
    s_waitcnt vmcnt(0)
    ds_read2st64_b32 v[46:47], v50 offset0:0 offset1:4
    ds_read2st64_b32 v[48:49], v51 offset0:0 offset1:4
    s_add_u32 s68, s68, 1
    s_waitcnt lgkmcnt(0)
    v_max3_u32 v46, v46, v48, v49
    v_max_u32 v46, v46, v47
    v_cmp_eq_u32 vcc, -1, v46
    s_cmp_gt_u32 s68, 0x20000
    s_cbranch_scc1 KF_ckh11_ok
    s_nop 3
    s_cbranch_vccnz KF_ckh11_r
    s_branch KF_ckh11_ok
KF_ckh13_r:
    s_add_u32 m0, s52, 116480
    s_add_u32 s54, s48, 1703936
    buffer_load_dwordx4 v10, s[20:23], s54 offen sc1 lds
    buffer_load_dwordx4 v11, s[20:23], s54 offen offset:1024 sc1 lds
    s_add_u32 m0, s52, 124800
    s_add_u32 s54, s48, 1835008
    buffer_load_dwordx4 v10, s[20:23], s54 offen sc1 lds
    buffer_load_dwordx4 v11, s[20:23], s54 offen offset:1024 sc1 lds
    s_waitcnt vmcnt(0)
    ds_read2st64_b32 v[46:47], v50 offset0:0 offset1:4
    ds_read2st64_b32 v[48:49], v51 offset0:0 offset1:4
    s_add_u32 s68, s68, 1
    s_waitcnt lgkmcnt(0)
    v_max3_u32 v46, v46, v48, v49
    v_max_u32 v46, v46, v47
    v_cmp_eq_u32 vcc, -1, v46
    s_cmp_gt_u32 s68, 0x20000
    s_cbranch_scc1 KF_ckh13_ok
    s_nop 3
    s_cbranch_vccnz KF_ckh13_r
    s_branch KF_ckh13_ok
KF_ckh15_r:
    s_add_u32 m0, s52, 133120
    s_add_u32 s54, s48, 1966080
    buffer_load_dwordx4 v10, s[20:23], s54 offen sc1 lds
    buffer_load_dwordx4 v11, s[20:23], s54 offen offset:1024 sc1 lds
    s_waitcnt vmcnt(0)
    ds_read2st64_b32 v[46:47], v50 offset0:0 offset1:4
    s_add_u32 s68, s68, 1
    s_waitcnt lgkmcnt(0)
    v_max_u32 v46, v46, v47
    v_cmp_eq_u32 vcc, -1, v46
    s_cmp_gt_u32 s68, 0x20000
    s_cbranch_scc1 KF_ckh15_ok
    s_nop 3
    s_cbranch_vccnz KF_ckh15_r
    s_branch KF_ckh15_ok
KF_ch14_r:
    s_sleep 4
    s_add_u32 s54, s60, 4096
    buffer_load_dwordx4 v[128:131], v21, s[36:39], s54 offen sc1
    buffer_load_dwordx4 v[132:135], v21, s[36:39], s54 offen offset:1024 sc1
    s_add_u32 s68, s68, 1
    s_waitcnt vmcnt(0)
    v_max_u32 v30, v128, v132
    v_cmp_eq_u32 vcc, -1, v30
    s_cmp_gt_u32 s68, 0x20000
    s_cbranch_scc1 KF_ch14_ok
    s_nop 3
    s_cbranch_vccnz KF_ch14_r
    s_add_u32 s54, s60, 12288
    buffer_load_dwordx4 v[136:139], v21, s[36:39], s54 offen sc1
    buffer_load_dwordx4 v[140:143], v21, s[36:39], s54 offen offset:1024 sc1
    s_add_u32 s54, s60, 20480
    buffer_load_dwordx4 v[144:147], v21, s[36:39], s54 offen sc1
    buffer_load_dwordx4 v[148:151], v21, s[36:39], s54 offen offset:1024 sc1
    s_add_u32 s54, s60, 28672
    buffer_load_dwordx4 v[152:155], v21, s[36:39], s54 offen sc1
    buffer_load_dwordx4 v[156:159], v21, s[36:39], s54 offen offset:1024 sc1
    s_add_u32 s54, s60, 36864
    buffer_load_dwordx4 v[160:163], v21, s[36:39], s54 offen sc1
    buffer_load_dwordx4 v[164:167], v21, s[36:39], s54 offen offset:1024 sc1
    s_branch KF_ch14_ok
KF_ch15_r:
    s_sleep 4
    s_add_u32 s54, s60, 12288
    buffer_load_dwordx4 v[136:139], v21, s[36:39], s54 offen sc1
    buffer_load_dwordx4 v[140:143], v21, s[36:39], s54 offen offset:1024 sc1
    s_add_u32 s68, s68, 1
    s_waitcnt vmcnt(0)
    v_max_u32 v30, v136, v140
    v_cmp_eq_u32 vcc, -1, v30
    s_cmp_gt_u32 s68, 0x20000
    s_cbranch_scc1 KF_ch15_ok
    s_nop 3
    s_cbranch_vccnz KF_ch15_r
    s_add_u32 s54, s60, 20480
    buffer_load_dwordx4 v[144:147], v21, s[36:39], s54 offen sc1
    buffer_load_dwordx4 v[148:151], v21, s[36:39], s54 offen offset:1024 sc1
    s_add_u32 s54, s60, 28672
    buffer_load_dwordx4 v[152:155], v21, s[36:39], s54 offen sc1
    buffer_load_dwordx4 v[156:159], v21, s[36:39], s54 offen offset:1024 sc1
    s_add_u32 s54, s60, 36864
    buffer_load_dwordx4 v[160:163], v21, s[36:39], s54 offen sc1
    buffer_load_dwordx4 v[164:167], v21, s[36:39], s54 offen offset:1024 sc1
    s_add_u32 s54, s60, 45056
    buffer_load_dwordx4 v[168:171], v21, s[36:39], s54 offen sc1
    buffer_load_dwordx4 v[172:175], v21, s[36:39], s54 offen offset:1024 sc1
    s_branch KF_ch15_ok
KF_ch16_r:
    s_sleep 4
    s_add_u32 s54, s60, 20480
    buffer_load_dwordx4 v[144:147], v21, s[36:39], s54 offen sc1
    buffer_load_dwordx4 v[148:151], v21, s[36:39], s54 offen offset:1024 sc1
    s_add_u32 s68, s68, 1
    s_waitcnt vmcnt(0)
    v_max_u32 v30, v144, v148
    v_cmp_eq_u32 vcc, -1, v30
    s_cmp_gt_u32 s68, 0x20000
    s_cbranch_scc1 KF_ch16_ok
    s_nop 3
    s_cbranch_vccnz KF_ch16_r
    s_add_u32 s54, s60, 28672
    buffer_load_dwordx4 v[152:155], v21, s[36:39], s54 offen sc1
    buffer_load_dwordx4 v[156:159], v21, s[36:39], s54 offen offset:1024 sc1
    s_add_u32 s54, s60, 36864
    buffer_load_dwordx4 v[160:163], v21, s[36:39], s54 offen sc1
    buffer_load_dwordx4 v[164:167], v21, s[36:39], s54 offen offset:1024 sc1
    s_add_u32 s54, s60, 45056
    buffer_load_dwordx4 v[168:171], v21, s[36:39], s54 offen sc1
    buffer_load_dwordx4 v[172:175], v21, s[36:39], s54 offen offset:1024 sc1
    s_add_u32 s54, s60, 53248
    buffer_load_dwordx4 v[176:179], v21, s[36:39], s54 offen sc1
    buffer_load_dwordx4 v[180:183], v21, s[36:39], s54 offen offset:1024 sc1
    s_branch KF_ch16_ok
KF_ch17_r:
    s_sleep 4
    s_add_u32 s54, s60, 28672
    buffer_load_dwordx4 v[152:155], v21, s[36:39], s54 offen sc1
    buffer_load_dwordx4 v[156:159], v21, s[36:39], s54 offen offset:1024 sc1
    s_add_u32 s68, s68, 1
    s_waitcnt vmcnt(0)
    v_max_u32 v30, v152, v156
    v_cmp_eq_u32 vcc, -1, v30
    s_cmp_gt_u32 s68, 0x20000
    s_cbranch_scc1 KF_ch17_ok
    s_nop 3
    s_cbranch_vccnz KF_ch17_r
    s_add_u32 s54, s60, 36864
    buffer_load_dwordx4 v[160:163], v21, s[36:39], s54 offen sc1
    buffer_load_dwordx4 v[164:167], v21, s[36:39], s54 offen offset:1024 sc1
    s_add_u32 s54, s60, 45056
    buffer_load_dwordx4 v[168:171], v21, s[36:39], s54 offen sc1
    buffer_load_dwordx4 v[172:175], v21, s[36:39], s54 offen offset:1024 sc1
    s_add_u32 s54, s60, 53248
    buffer_load_dwordx4 v[176:179], v21, s[36:39], s54 offen sc1
    buffer_load_dwordx4 v[180:183], v21, s[36:39], s54 offen offset:1024 sc1
    s_add_u32 s54, s53, 61440
    buffer_load_dwordx4 v[184:187], v21, s[36:39], s54 offen sc1
    buffer_load_dwordx4 v[188:191], v21, s[36:39], s54 offen offset:1024 sc1
    s_branch KF_ch17_ok
KF_ch18_r:
    s_sleep 4
    s_add_u32 s54, s60, 36864
    buffer_load_dwordx4 v[160:163], v21, s[36:39], s54 offen sc1
    buffer_load_dwordx4 v[164:167], v21, s[36:39], s54 offen offset:1024 sc1
    s_add_u32 s68, s68, 1
    s_waitcnt vmcnt(0)
    v_max_u32 v30, v160, v164
    v_cmp_eq_u32 vcc, -1, v30
    s_cmp_gt_u32 s68, 0x20000
    s_cbranch_scc1 KF_ch18_ok
    s_nop 3
    s_cbranch_vccnz KF_ch18_r
    s_add_u32 s54, s60, 45056
    buffer_load_dwordx4 v[168:171], v21, s[36:39], s54 offen sc1
    buffer_load_dwordx4 v[172:175], v21, s[36:39], s54 offen offset:1024 sc1
    s_add_u32 s54, s60, 53248
    buffer_load_dwordx4 v[176:179], v21, s[36:39], s54 offen sc1
    buffer_load_dwordx4 v[180:183], v21, s[36:39], s54 offen offset:1024 sc1
    s_add_u32 s54, s53, 61440
    buffer_load_dwordx4 v[184:187], v21, s[36:39], s54 offen sc1
    buffer_load_dwordx4 v[188:191], v21, s[36:39], s54 offen offset:1024 sc1
    s_add_u32 s54, s53, 69632
    buffer_load_dwordx4 v[192:195], v21, s[36:39], s54 offen sc1
    buffer_load_dwordx4 v[196:199], v21, s[36:39], s54 offen offset:1024 sc1
    s_branch KF_ch18_ok
KF_ch19_r:
    s_sleep 4
    s_add_u32 s54, s60, 45056
    buffer_load_dwordx4 v[168:171], v21, s[36:39], s54 offen sc1
    buffer_load_dwordx4 v[172:175], v21, s[36:39], s54 offen offset:1024 sc1
    s_add_u32 s68, s68, 1
    s_waitcnt vmcnt(0)
    v_max_u32 v30, v168, v172
    v_cmp_eq_u32 vcc, -1, v30
    s_cmp_gt_u32 s68, 0x20000
    s_cbranch_scc1 KF_ch19_ok
    s_nop 3
    s_cbranch_vccnz KF_ch19_r
    s_add_u32 s54, s60, 53248
    buffer_load_dwordx4 v[176:179], v21, s[36:39], s54 offen sc1
    buffer_load_dwordx4 v[180:183], v21, s[36:39], s54 offen offset:1024 sc1
    s_add_u32 s54, s53, 61440
    buffer_load_dwordx4 v[184:187], v21, s[36:39], s54 offen sc1
    buffer_load_dwordx4 v[188:191], v21, s[36:39], s54 offen offset:1024 sc1
    s_add_u32 s54, s53, 69632
    buffer_load_dwordx4 v[192:195], v21, s[36:39], s54 offen sc1
    buffer_load_dwordx4 v[196:199], v21, s[36:39], s54 offen offset:1024 sc1
    s_add_u32 s54, s53, 77824
    buffer_load_dwordx4 v[200:203], v21, s[36:39], s54 offen sc1
    buffer_load_dwordx4 v[204:207], v21, s[36:39], s54 offen offset:1024 sc1
    s_branch KF_ch19_ok
KF_ch20_r:
    s_sleep 4
    s_add_u32 s54, s60, 53248
    buffer_load_dwordx4 v[176:179], v21, s[36:39], s54 offen sc1
    buffer_load_dwordx4 v[180:183], v21, s[36:39], s54 offen offset:1024 sc1
    s_add_u32 s68, s68, 1
    s_waitcnt vmcnt(0)
    v_max_u32 v30, v176, v180
    v_cmp_eq_u32 vcc, -1, v30
    s_cmp_gt_u32 s68, 0x20000
    s_cbranch_scc1 KF_ch20_ok
    s_nop 3
    s_cbranch_vccnz KF_ch20_r
    s_add_u32 s54, s53, 61440
    buffer_load_dwordx4 v[184:187], v21, s[36:39], s54 offen sc1
    buffer_load_dwordx4 v[188:191], v21, s[36:39], s54 offen offset:1024 sc1
    s_add_u32 s54, s53, 69632
    buffer_load_dwordx4 v[192:195], v21, s[36:39], s54 offen sc1
    buffer_load_dwordx4 v[196:199], v21, s[36:39], s54 offen offset:1024 sc1
    s_add_u32 s54, s53, 77824
    buffer_load_dwordx4 v[200:203], v21, s[36:39], s54 offen sc1
    buffer_load_dwordx4 v[204:207], v21, s[36:39], s54 offen offset:1024 sc1
    s_add_u32 s54, s53, 86016
    buffer_load_dwordx4 v[208:211], v21, s[36:39], s54 offen sc1
    buffer_load_dwordx4 v[212:215], v21, s[36:39], s54 offen offset:1024 sc1
    s_branch KF_ch20_ok
KF_ch21_r:
    s_sleep 4
    s_add_u32 s54, s53, 61440
    buffer_load_dwordx4 v[184:187], v21, s[36:39], s54 offen sc1
    buffer_load_dwordx4 v[188:191], v21, s[36:39], s54 offen offset:1024 sc1
    s_add_u32 s68, s68, 1
    s_waitcnt vmcnt(0)
    v_max_u32 v30, v184, v188
    v_cmp_eq_u32 vcc, -1, v30
    s_cmp_gt_u32 s68, 0x20000
    s_cbranch_scc1 KF_ch21_ok
    s_nop 3
    s_cbranch_vccnz KF_ch21_r
    s_add_u32 s54, s53, 69632
    buffer_load_dwordx4 v[192:195], v21, s[36:39], s54 offen sc1
    buffer_load_dwordx4 v[196:199], v21, s[36:39], s54 offen offset:1024 sc1
    s_add_u32 s54, s53, 77824
    buffer_load_dwordx4 v[200:203], v21, s[36:39], s54 offen sc1
    buffer_load_dwordx4 v[204:207], v21, s[36:39], s54 offen offset:1024 sc1
    s_add_u32 s54, s53, 86016
    buffer_load_dwordx4 v[208:211], v21, s[36:39], s54 offen sc1
    buffer_load_dwordx4 v[212:215], v21, s[36:39], s54 offen offset:1024 sc1
    s_add_u32 s54, s53, 94208
    buffer_load_dwordx4 v[216:219], v21, s[36:39], s54 offen sc1
    buffer_load_dwordx4 v[220:223], v21, s[36:39], s54 offen offset:1024 sc1
    s_branch KF_ch21_ok
KF_ch22_r:
    s_sleep 4
    s_add_u32 s54, s53, 69632
    buffer_load_dwordx4 v[192:195], v21, s[36:39], s54 offen sc1
    buffer_load_dwordx4 v[196:199], v21, s[36:39], s54 offen offset:1024 sc1
    s_add_u32 s68, s68, 1
    s_waitcnt vmcnt(0)
    v_max_u32 v30, v192, v196
    v_cmp_eq_u32 vcc, -1, v30
    s_cmp_gt_u32 s68, 0x20000
    s_cbranch_scc1 KF_ch22_ok
    s_nop 3
    s_cbranch_vccnz KF_ch22_r
    s_add_u32 s54, s53, 77824
    buffer_load_dwordx4 v[200:203], v21, s[36:39], s54 offen sc1
    buffer_load_dwordx4 v[204:207], v21, s[36:39], s54 offen offset:1024 sc1
    s_add_u32 s54, s53, 86016
    buffer_load_dwordx4 v[208:211], v21, s[36:39], s54 offen sc1
    buffer_load_dwordx4 v[212:215], v21, s[36:39], s54 offen offset:1024 sc1
    s_add_u32 s54, s53, 94208
    buffer_load_dwordx4 v[216:219], v21, s[36:39], s54 offen sc1
    buffer_load_dwordx4 v[220:223], v21, s[36:39], s54 offen offset:1024 sc1
    s_add_u32 s54, s53, 102400
    buffer_load_dwordx4 v[224:227], v21, s[36:39], s54 offen sc1
    buffer_load_dwordx4 v[228:231], v21, s[36:39], s54 offen offset:1024 sc1
    s_branch KF_ch22_ok
KF_ch23_r:
    s_sleep 4
    s_add_u32 s54, s53, 77824
    buffer_load_dwordx4 v[200:203], v21, s[36:39], s54 offen sc1
    buffer_load_dwordx4 v[204:207], v21, s[36:39], s54 offen offset:1024 sc1
    s_add_u32 s68, s68, 1
    s_waitcnt vmcnt(0)
    v_max_u32 v30, v200, v204
    v_cmp_eq_u32 vcc, -1, v30
    s_cmp_gt_u32 s68, 0x20000
    s_cbranch_scc1 KF_ch23_ok
    s_nop 3
    s_cbranch_vccnz KF_ch23_r
    s_add_u32 s54, s53, 86016
    buffer_load_dwordx4 v[208:211], v21, s[36:39], s54 offen sc1
    buffer_load_dwordx4 v[212:215], v21, s[36:39], s54 offen offset:1024 sc1
    s_add_u32 s54, s53, 94208
    buffer_load_dwordx4 v[216:219], v21, s[36:39], s54 offen sc1
    buffer_load_dwordx4 v[220:223], v21, s[36:39], s54 offen offset:1024 sc1
    s_add_u32 s54, s53, 102400
    buffer_load_dwordx4 v[224:227], v21, s[36:39], s54 offen sc1
    buffer_load_dwordx4 v[228:231], v21, s[36:39], s54 offen offset:1024 sc1
    s_add_u32 s54, s53, 110592
    buffer_load_dwordx4 v[232:235], v21, s[36:39], s54 offen sc1
    buffer_load_dwordx4 v[236:239], v21, s[36:39], s54 offen offset:1024 sc1
    s_branch KF_ch23_ok
KF_ch24_r:
    s_sleep 4
    s_add_u32 s54, s53, 86016
    buffer_load_dwordx4 v[208:211], v21, s[36:39], s54 offen sc1
    buffer_load_dwordx4 v[212:215], v21, s[36:39], s54 offen offset:1024 sc1
    s_add_u32 s68, s68, 1
    s_waitcnt vmcnt(0)
    v_max_u32 v30, v208, v212
    v_cmp_eq_u32 vcc, -1, v30
    s_cmp_gt_u32 s68, 0x20000
    s_cbranch_scc1 KF_ch24_ok
    s_nop 3
    s_cbranch_vccnz KF_ch24_r
    s_add_u32 s54, s53, 94208
    buffer_load_dwordx4 v[216:219], v21, s[36:39], s54 offen sc1
    buffer_load_dwordx4 v[220:223], v21, s[36:39], s54 offen offset:1024 sc1
    s_add_u32 s54, s53, 102400
    buffer_load_dwordx4 v[224:227], v21, s[36:39], s54 offen sc1
    buffer_load_dwordx4 v[228:231], v21, s[36:39], s54 offen offset:1024 sc1
    s_add_u32 s54, s53, 110592
    buffer_load_dwordx4 v[232:235], v21, s[36:39], s54 offen sc1
    buffer_load_dwordx4 v[236:239], v21, s[36:39], s54 offen offset:1024 sc1
    s_branch KF_ch24_ok
KF_ch25_r:
    s_sleep 4
    s_add_u32 s54, s53, 94208
    buffer_load_dwordx4 v[216:219], v21, s[36:39], s54 offen sc1
    buffer_load_dwordx4 v[220:223], v21, s[36:39], s54 offen offset:1024 sc1
    s_add_u32 s68, s68, 1
    s_waitcnt vmcnt(0)
    v_max_u32 v30, v216, v220
    v_cmp_eq_u32 vcc, -1, v30
    s_cmp_gt_u32 s68, 0x20000
    s_cbranch_scc1 KF_ch25_ok
    s_nop 3
    s_cbranch_vccnz KF_ch25_r
    s_add_u32 s54, s53, 102400
    buffer_load_dwordx4 v[224:227], v21, s[36:39], s54 offen sc1
    buffer_load_dwordx4 v[228:231], v21, s[36:39], s54 offen offset:1024 sc1
    s_add_u32 s54, s53, 110592
    buffer_load_dwordx4 v[232:235], v21, s[36:39], s54 offen sc1
    buffer_load_dwordx4 v[236:239], v21, s[36:39], s54 offen offset:1024 sc1
    s_branch KF_ch25_ok
KF_ch26_r:
    s_sleep 4
    s_add_u32 s54, s53, 102400
    buffer_load_dwordx4 v[224:227], v21, s[36:39], s54 offen sc1
    buffer_load_dwordx4 v[228:231], v21, s[36:39], s54 offen offset:1024 sc1
    s_add_u32 s68, s68, 1
    s_waitcnt vmcnt(0)
    v_max_u32 v30, v224, v228
    v_cmp_eq_u32 vcc, -1, v30
    s_cmp_gt_u32 s68, 0x20000
    s_cbranch_scc1 KF_ch26_ok
    s_nop 3
    s_cbranch_vccnz KF_ch26_r
    s_add_u32 s54, s53, 110592
    buffer_load_dwordx4 v[232:235], v21, s[36:39], s54 offen sc1
    buffer_load_dwordx4 v[236:239], v21, s[36:39], s54 offen offset:1024 sc1
    s_branch KF_ch26_ok
KF_ch27_r:
    s_sleep 4
    s_add_u32 s54, s53, 110592
    buffer_load_dwordx4 v[232:235], v21, s[36:39], s54 offen sc1
    buffer_load_dwordx4 v[236:239], v21, s[36:39], s54 offen offset:1024 sc1
    s_add_u32 s68, s68, 1
    s_waitcnt vmcnt(0)
    v_max_u32 v30, v232, v236
    v_cmp_eq_u32 vcc, -1, v30
    s_cmp_gt_u32 s68, 0x20000
    s_cbranch_scc1 KF_ch27_ok
    s_nop 3
    s_cbranch_vccnz KF_ch27_r
    s_branch KF_ch27_ok
M_done:
    s_endpgm
.section .rodata,"a"
.p2align 6
.amdhsa_kernel sequential_preLN__ssm_conv_s4d__glu_gated_swiglu__prompt_kernel
  .amdhsa_next_free_vgpr 256
  .amdhsa_next_free_sgpr 90
  .amdhsa_accum_offset 256
  .amdhsa_group_segment_fixed_size 0
  .amdhsa_kernarg_size 112
  .amdhsa_user_sgpr_count 2
  .amdhsa_user_sgpr_kernarg_segment_ptr 1
  .amdhsa_system_sgpr_workgroup_id_x 1
.end_amdhsa_kernel
```
